```python
import torch

def _softmax(x, axis=-1):
    return torch.softmax(x, dim=axis)
def _gelu(x):
    return torch.nn.functional.gelu(x, approximate="tanh")
def _silu(x):
    return torch.nn.functional.silu(x)
def _sigmoid(x):
    return torch.sigmoid(x)
def _layernorm(x, axis=-1, eps=1e-5):
    m = x.mean(dim=axis, keepdim=True)
    v = x.var(dim=axis, keepdim=True, unbiased=False)
    return (x - m) / torch.sqrt(v + eps)
def _scatter_add(tgt, idx, src, axis=0):
    return tgt.clone().index_add_(axis, idx, src)
def _segment_sum(src, seg, n):
    out = torch.zeros((n,) + src.shape[1:], dtype=src.dtype)
    return out.index_add_(0, seg, src)
def _pad(x, pw):
    flat = tuple(v for pair in reversed(pw) for v in pair)
    return torch.nn.functional.pad(x, flat)

kernel_name = 'sequential_preLN__ssm_conv_s4d__mixer_token_mlp__prompt'

def setup_inputs():

    _w = (lambda a: (lambda t: t.to(torch.bfloat16) if t.is_floating_point() else t)(torch.as_tensor(a)))
    def _A_setup():
        Bsz, L, D, N = 1, 2048, 640, 128
        return {
            "u": _w((lambda *s: torch.randn(*s, dtype=torch.bfloat16) * 0.05)(Bsz, L, D)),
            "log_A_real": _w((lambda *s: torch.randn(*s, dtype=torch.bfloat16) * 6.4)(D, N) * 0.5),
            "A_imag": _w((lambda *s: torch.randn(*s, dtype=torch.bfloat16) * 0.05)(D, N) * 3.14),
            "C_real": _w((lambda *s: torch.randn(*s, dtype=torch.bfloat16) * 0.05)(D, N) / N ** 0.5),
            "C_imag": _w((lambda *s: torch.randn(*s, dtype=torch.bfloat16) * 0.05)(D, N) / N ** 0.5),
            "log_dt": _w((lambda *s: torch.randn(*s, dtype=torch.bfloat16) * 0.05)(D) * 0.5 - 4.0),
            "D_skip": _w((lambda *s: torch.randn(*s, dtype=torch.bfloat16) * 0.05)(D)),
        }
    _A_in = _A_setup()

    def _B_setup():
        B, S, D, F = 1, 2048, 640, 1728
        return {
            "x": _w((lambda *s: torch.randn(*s, dtype=torch.bfloat16) * 0.05)(B, S, D)),
            "w1": _w((lambda *s: torch.randn(*s, dtype=torch.bfloat16) * 0.4)(S, F) * (S ** -0.5)),
            "b1": _w((lambda *s: torch.randn(*s, dtype=torch.bfloat16) * 12.8)(F) * 0.02),
            "w2": _w((lambda *s: torch.randn(*s, dtype=torch.bfloat16) * 0.2)(F, S) * (F ** -0.5)),
            "b2": _w((lambda *s: torch.randn(*s, dtype=torch.bfloat16) * 3.2)(S) * 0.02),
        }
    _B_in = _B_setup()

    return {
        "A_u": _A_in["u"],
        "A_log_A_real": _A_in["log_A_real"],
        "A_A_imag": _A_in["A_imag"],
        "A_C_real": _A_in["C_real"],
        "A_C_imag": _A_in["C_imag"],
        "A_log_dt": _A_in["log_dt"],
        "A_D_skip": _A_in["D_skip"],
        "B_x": _B_in["x"],
        "B_w1": _B_in["w1"],
        "B_b1": _B_in["b1"],
        "B_w2": _B_in["w2"],
        "B_b2": _B_in["b2"],
    }

def reference(A_u, A_log_A_real, A_A_imag, A_C_real, A_C_imag, A_log_dt, A_D_skip, B_x, B_w1, B_b1, B_w2, B_b2):
    def _A_ref(u, log_A_real, A_imag, C_real, C_imag, log_dt, D_skip):
        L = u.shape[1]
        dt = torch.exp(log_dt)
        A = -torch.exp(log_A_real) + 1j * A_imag
        C = (C_real + 1j * C_imag) * dt[:, None]
        pos = (lambda x, dt: x.to(dt))(torch.arange(L), log_dt.dtype)
        P = torch.exp((A * dt[:, None])[:, :, None] * pos[None, None, :])
        K = 2.0 * torch.einsum("dn,dnl->dl", C, P).real
        L2 = 2 * L
        u_t = (lambda x, *d: x.permute(*d))(u, 0, 2, 1)
        Kf = (lambda x, *a, **k: torch.fft.rfft(x.float(), *a, **k))(K, L2)
        Uf = (lambda x, *a, **k: torch.fft.rfft(x.float(), *a, **k))(u_t, L2)
        y = (lambda x, *a, **k: torch.fft.irfft(x, *a, **k).to(torch.bfloat16))(Uf * Kf[None, :, :], L2)[:, :, :L]
        y = (lambda x, *d: x.permute(*d))(y, 0, 2, 1)
        return y + u * D_skip[None, None, :]

    def _B_ref(x, w1, b1, w2, b2):
        B, S, D = x.shape
        h = _layernorm(x, axis=-1)
        u = torch.einsum("bsd,sf->bdf", h, w1) + b1
        u = _gelu(u)
        y = torch.einsum("bdf,fs->bds", u, w2) + b2
        return (lambda x, *d: x.permute(*d))(y, 0, 2, 1)

    x = A_u
    h = x + _A_ref(_layernorm(x, axis=-1), A_log_A_real, A_A_imag, A_C_real, A_C_imag, A_log_dt, A_D_skip)
    h2 = h + _B_ref(_layernorm(h, axis=-1), B_w1, B_b1, B_w2, B_b2)
    return h2
```

```asm
; @launch grid=(256,1,1) block=(256,1,1) lds=163840
.amdgcn_target "amdgcn-amd-amdhsa--gfx950"
.text
.globl sequential_preLN__ssm_conv_s4d__mixer_token_mlp__prompt_kernel
.p2align 8
.type sequential_preLN__ssm_conv_s4d__mixer_token_mlp__prompt_kernel,@function
sequential_preLN__ssm_conv_s4d__mixer_token_mlp__prompt_kernel:
    s_cmp_ge_u32 s2, 256
    s_cbranch_scc1 L_end
    s_load_dwordx16 s[16:31], s[0:1], 0
    s_load_dwordx8 s[32:39], s[0:1], 64
    s_load_dwordx4 s[40:43], s[0:1], 96
    s_load_dwordx2 s[44:45], s[0:1], 112
    s_getpc_b64 s[94:95]
L_pc:
    v_lshrrev_b32 v2, 6, v0
    v_and_b32 v1, 63, v0
    v_readfirstlane_b32 s3, v2
    s_and_b32 s4, s2, 7
    s_lshr_b32 s5, s2, 3
    s_lshl_b32 s6, s4, 5
    s_add_u32 s6, s6, s5
    s_lshl_b32 s54, s5, 4
    v_add_u32 v3, s54, v0
    v_lshlrev_b32 v3, 7, v3
    v_min_u32 v3, (L_codeend-L_pc-4), v3
    v_cmp_gt_u32 vcc, 16, v0
    s_nop 0
    s_and_saveexec_b64 s[54:55], vcc
    s_cbranch_execz L_cpf_1
    global_load_dword v254, v3, s[94:95]
L_cpf_1:
    s_mov_b64 exec, -1
    s_mul_i32 s54, s4, 80
    s_min_u32 s55, s5, 26
    s_mul_i32 s55, s55, 3
    s_add_u32 s7, s54, s55
    s_lshl_b32 s54, s6, 3
    s_lshl_b32 s55, s3, 1
    s_add_u32 s54, s54, s55
    v_lshrrev_b32 v9, 5, v1
    v_add_u32 v4, s54, v9
    v_mul_u32_u24 v4, 1280, v4
    v_and_b32 v5, 31, v1
    v_lshl_add_u32 v4, v5, 3, v4
    v_add_u32 v9, s55, v9
    v_mul_u32_u24 v8, 1344, v9
    v_lshl_add_u32 v8, v5, 3, v8
    v_add_u32 v8, 139904, v8
    s_min_u32 s56, s3, 2
    s_add_u32 s56, s56, s7
    s_min_u32 s56, s56, 639
    s_lshl_b32 s57, s56, 8
    v_lshl_add_u32 v6, v1, 2, s57
    v_lshlrev_b32 v7, 1, v0
    v_min_u32 v181, 159, v0
    v_lshrrev_b32 v182, 2, v181
    v_mul_u32_u24 v183, 13108, v182
    v_lshrrev_b32 v183, 16, v183
    v_mul_u32_u24 v183, 27, v183
    v_add3_u32 v182, v182, v183, 27
    v_and_b32 v181, 3, v181
    v_lshlrev_b32 v181, 2, v181
    v_lshl_add_u32 v233, v182, 7, v181
    v_add_u32 v233, 0x8000, v233
    s_mul_i32 s61, s4, 27
    s_add_u32 s62, s61, 26
    s_lshr_b32 s61, s61, 3
    s_lshr_b32 s62, s62, 3
    v_and_b32 v231, 7, v1
    v_add_u32 v231, s61, v231
    v_min_u32 v231, s62, v231
    s_lshl_b32 s61, s3, 9
    s_lshl_b32 s62, s5, 3
    s_add_u32 s61, s61, s62
    v_lshrrev_b32 v232, 3, v1
    v_add_u32 v232, s61, v232
    v_mul_u32_u24 v232, 3456, v232
    v_lshl_add_u32 v231, v231, 7, v232
    s_mul_i32 s61, s3, 448
    s_min_u32 s61, s61, 1312
    s_mul_i32 s62, s5, 5
    s_add_u32 s61, s61, s62
    v_lshrrev_b32 v232, 2, v1
    v_min_u32 v232, 4, v232
    v_add_u32 v232, s61, v232
    v_lshlrev_b32 v232, 12, v232
    v_and_b32 v183, 3, v1
    v_lshl_add_u32 v232, v183, 7, v232
    s_lshl_b32 s61, s4, 9
    v_add_u32 v232, s61, v232
    s_waitcnt lgkmcnt(0)
    global_load_dwordx2 v[10:11], v4, s[16:17] offset:0
    global_load_dwordx2 v[12:13], v4, s[16:17] offset:256
    global_load_dwordx2 v[14:15], v4, s[16:17] offset:512
    global_load_dwordx2 v[16:17], v4, s[16:17] offset:768
    global_load_dwordx2 v[18:19], v4, s[16:17] offset:1024
    global_load_ushort v228, v7, s[28:29]
    global_load_ushort v229, v7, s[28:29] offset:512
    v_min_u32 v7, 254, v7
    global_load_ushort v230, v7, s[28:29] offset:1024
    global_load_dword v224, v6, s[18:19]
    global_load_dword v225, v6, s[20:21]
    global_load_dword v226, v6, s[22:23]
    global_load_dword v227, v6, s[24:25]
    s_load_dword s10, s[44:45], 0
    s_lshl_b32 s57, s56, 1
    s_and_b32 s57, s57, 0xfffffffc
    s_load_dword s59, s[26:27], s57
    s_add_u32 s46, s44, 0x600000
    s_addc_u32 s47, s45, 0
    s_add_u32 s48, s44, 0x900000
    s_addc_u32 s49, s45, 0
    s_add_u32 s50, s44, 0xb80000
    s_addc_u32 s51, s45, 0
    s_add_u32 s52, s44, 0x10000
    s_addc_u32 s53, s45, 0
    s_add_u32 s12, s44, 0x100000
    s_addc_u32 s13, s45, 0
    s_add_u32 s14, s44, 0x380000
    s_addc_u32 s15, s45, 0
    s_lshl_b32 s54, s6, 7
    v_and_b32 v2, 7, v1
    v_lshlrev_b32 v2, 15, v2
    v_add_u32 v2, s54, v2
    s_mov_b64 exec, 0x3f
    global_load_dword v254, v2, s[52:53] sc1
    s_mov_b64 exec, -1
    s_mul_i32 s54, s4, 27
    s_min_u32 s55, s5, 26
    s_add_u32 s54, s54, s55
    s_lshr_b32 s77, s54, 3
    s_and_b32 s76, s54, 7
    s_lshl_b32 s54, s4, 2
    s_lshr_b32 s55, s5, 3
    s_add_u32 s78, s54, s55
    s_and_b32 s75, s5, 7
    s_mov_b32 s79, 1
    s_cmp_ge_u32 s5, 27
    s_cmov_b32 s79, 0
    s_mul_i32 s92, s3, 14
    s_lshr_b32 s93, s3, 1
    s_cmp_eq_u32 s3, 3
    s_cmov_b32 s92, 41
    v_mov_b32 v184, v8
    v_mov_b32 v185, v9
    s_lshl_b32 s90, s3, 9
    s_lshl_b32 s91, s77, 7
    v_lshrrev_b32 v2, 3, v1
    v_and_b32 v3, 7, v1
    v_and_b32 v4, 2, v2
    v_xor_b32 v3, v3, v4
    v_mul_u32_u24 v2, 3456, v2
    v_lshl_add_u32 v234, v3, 4, v2
    v_xor_b32 v3, 4, v3
    v_lshl_add_u32 v235, v3, 4, v2
    v_add_u32 v235, 26624, v235
    v_add_u32 v236, 53248, v234
    v_add_u32 v237, 53248, v235
    s_mul_i32 s54, s90, 3456
    s_add_u32 s54, s54, s91
    s_add_u32 s80, s32, s54
    s_addc_u32 s81, s33, 0
    v_lshrrev_b32 v2, 4, v1
    v_bfe_u32 v3, v1, 2, 2
    v_lshl_add_u32 v4, v2, 3, v3
    v_lshlrev_b32 v4, 7, v4
    v_and_b32 v5, 3, v1
    v_lshl_add_u32 v4, v5, 3, v4
    s_mul_i32 s54, s3, 16384
    v_add_u32 v4, s54, v4
    v_lshrrev_b32 v3, 1, v3
    v_and_b32 v2, 1, v2
    v_lshl_add_u32 v2, v2, 1, v3
    s_add_u32 s54, s3, 0
    s_and_b32 s54, s54, 3
    v_xor_b32 v3, s54, v2
    v_lshl_add_u32 v238, v3, 5, v4
    s_add_u32 s54, s3, 1
    s_and_b32 s54, s54, 3
    v_xor_b32 v3, s54, v2
    v_lshl_add_u32 v239, v3, 5, v4
    s_add_u32 s54, s3, 2
    s_and_b32 s54, s54, 3
    v_xor_b32 v3, s54, v2
    v_lshl_add_u32 v240, v3, 5, v4
    s_add_u32 s54, s3, 3
    s_and_b32 s54, s54, 3
    v_xor_b32 v3, s54, v2
    v_lshl_add_u32 v241, v3, 5, v4
    v_and_b32 v2, 15, v1
    v_lshrrev_b32 v3, 4, v1
    v_and_b32 v4, 3, v1
    v_bfe_u32 v5, v1, 2, 2
    v_mul_u32_u24 v6, 4640, v4
    v_lshl_add_u32 v6, v3, 4, v6
    v_lshlrev_b32 v7, 7, v5
    v_sub_u32 v6, v6, v7
    v_add_u32 v6, 85056, v6
    v_lshlrev_b32 v7, 3, v2
    v_lshl_add_u32 v7, v3, 4, v7
    v_add_u32 v7, 140360, v7
    s_mul_i32 s54, s3, 6
    s_add_u32 s54, s54, 1
    s_lshr_b32 s55, s54, 3
    s_and_b32 s54, s54, 7
    s_lshl_b32 s54, s54, 6
    s_mul_i32 s60, s55, 18560
    s_sub_u32 s60, s60, s54
    v_add_u32 v194, s60, v6
    s_mul_i32 s60, s55, 4224
    s_sub_u32 s60, s60, s54
    v_add_u32 v195, s60, v7
    s_mul_i32 s54, s3, 6
    s_add_u32 s54, s54, 3
    s_lshr_b32 s55, s54, 3
    s_and_b32 s54, s54, 7
    s_lshl_b32 s54, s54, 6
    s_mul_i32 s60, s55, 18560
    s_sub_u32 s60, s60, s54
    v_add_u32 v196, s60, v6
    s_mul_i32 s60, s55, 4224
    s_sub_u32 s60, s60, s54
    v_add_u32 v197, s60, v7
    s_mul_i32 s54, s3, 6
    s_add_u32 s54, s54, 5
    s_lshr_b32 s55, s54, 3
    s_and_b32 s54, s54, 7
    s_lshl_b32 s54, s54, 6
    s_mul_i32 s60, s55, 18560
    s_sub_u32 s60, s60, s54
    v_add_u32 v198, s60, v6
    s_mul_i32 s60, s55, 4224
    s_sub_u32 s60, s60, s54
    v_add_u32 v199, s60, v7
    v_lshrrev_b32 v2, 1, v1
    v_mul_u32_u24 v2, 48, v2
    v_and_b32 v3, 1, v1
    v_mul_u32_u24 v3, 12352, v3
    s_min_u32 s54, s3, 2
    s_lshl_b32 s54, s54, 4
    s_add_u32 s54, s54, 84224
    s_add_u32 s55, s54, 24704
    s_cmp_eq_u32 s3, 3
    s_cmov_b32 s54, s55
    v_add3_u32 v242, v2, v3, s54
    s_sub_u32 s55, s55, 16
    v_add3_u32 v243, v2, v3, s55
    v_add_u32 v2, 0, v0
    v_mul_u32_u24 v3, 21846, v2
    v_lshrrev_b32 v3, 16, v3
    v_mul_u32_u24 v4, 3, v3
    v_sub_u32 v2, v2, v4
    v_lshlrev_b32 v2, 2, v2
    v_add_u32 v244, 152704, v2
    v_add_u32 v2, 256, v0
    v_mul_u32_u24 v3, 21846, v2
    v_lshrrev_b32 v3, 16, v3
    v_mul_u32_u24 v4, 3, v3
    v_sub_u32 v2, v2, v4
    v_lshlrev_b32 v2, 2, v2
    v_add_u32 v245, 152704, v2
    v_add_u32 v2, 512, v0
    v_mul_u32_u24 v3, 21846, v2
    v_lshrrev_b32 v3, 16, v3
    v_mul_u32_u24 v4, 3, v3
    v_sub_u32 v2, v2, v4
    v_lshlrev_b32 v2, 2, v2
    v_add_u32 v246, 152704, v2
    v_accvgpr_write_b32 a240, v194
    v_accvgpr_write_b32 a241, v195
    v_accvgpr_write_b32 a242, v196
    v_accvgpr_write_b32 a243, v197
    v_accvgpr_write_b32 a244, v198
    v_accvgpr_write_b32 a245, v199
    v_accvgpr_write_b32 a246, v242
    v_accvgpr_write_b32 a247, v243
    v_accvgpr_write_b32 a248, v244
    v_accvgpr_write_b32 a249, v245
    v_accvgpr_write_b32 a250, v246
    s_mul_i32 s55, s6, 48
    v_add_u32 v5, 0, v0
    v_mul_u32_u24 v6, 820, v5
    v_lshrrev_b32 v6, 16, v6
    v_mul_u32_u24 v7, 80, v6
    v_sub_u32 v7, v5, v7
    v_mul_u32_u24 v8, 21846, v7
    v_lshrrev_b32 v8, 16, v8
    v_lshl_add_u32 v6, v6, 5, v8
    v_mul_u32_u24 v8, 3, v8
    v_sub_u32 v7, v7, v8
    v_mul_u32_u24 v6, 12288, v6
    v_lshl_add_u32 v6, v7, 4, v6
    v_add_u32 v170, s55, v6
    v_add_u32 v5, 256, v0
    v_mul_u32_u24 v6, 820, v5
    v_lshrrev_b32 v6, 16, v6
    v_mul_u32_u24 v7, 80, v6
    v_sub_u32 v7, v5, v7
    v_mul_u32_u24 v8, 21846, v7
    v_lshrrev_b32 v8, 16, v8
    v_lshl_add_u32 v6, v6, 5, v8
    v_mul_u32_u24 v8, 3, v8
    v_sub_u32 v7, v7, v8
    v_mul_u32_u24 v6, 12288, v6
    v_lshl_add_u32 v6, v7, 4, v6
    v_add_u32 v171, s55, v6
    v_add_u32 v5, 512, v0
    v_min_u32 v5, 639, v5
    v_mul_u32_u24 v6, 820, v5
    v_lshrrev_b32 v6, 16, v6
    v_mul_u32_u24 v7, 80, v6
    v_sub_u32 v7, v5, v7
    v_mul_u32_u24 v8, 21846, v7
    v_lshrrev_b32 v8, 16, v8
    v_lshl_add_u32 v6, v6, 5, v8
    v_mul_u32_u24 v8, 3, v8
    v_sub_u32 v7, v7, v8
    v_mul_u32_u24 v6, 12288, v6
    v_lshl_add_u32 v6, v7, 4, v6
    v_add_u32 v172, s55, v6
    s_lshl_b32 s54, s6, 8
    v_lshrrev_b32 v2, 4, v0
    v_lshlrev_b32 v2, 16, v2
    v_and_b32 v3, 15, v0
    v_lshl_add_u32 v2, v3, 4, v2
    v_add_u32 v173, s54, v2
    v_add_u32 v174, 0x100000, v173
    v_add_u32 v175, 0x200000, v173
    s_mul_i32 s54, s6, 10240
    v_lshl_add_u32 v176, v0, 4, s54
    v_add_u32 v177, 4096, v176
    v_add_u32 v178, 8192, v176
    v_lshlrev_b32 v179, 2, v0
    v_add_u32 v179, 160000, v179
    v_lshlrev_b32 v180, 2, v1
    v_add_u32 v180, 160000, v180
    v_accvgpr_write_b32 a224, v170
    v_accvgpr_write_b32 a225, v171
    v_accvgpr_write_b32 a226, v172
    v_accvgpr_write_b32 a227, v173
    v_accvgpr_write_b32 a228, v174
    v_accvgpr_write_b32 a229, v175
    v_accvgpr_write_b32 a230, v176
    v_accvgpr_write_b32 a231, v177
    v_accvgpr_write_b32 a232, v178
    v_accvgpr_write_b32 a233, v179
    v_accvgpr_write_b32 a234, v180
    v_mov_b32 v8, v184
    v_mov_b32 v9, v185
    v_mov_b32 v24, 0
    v_mov_b32 v25, 0
    v_mov_b32 v26, 0x3f803f80
    v_bfe_u32 v27, v1, 2, 2
    v_mul_u32_u24 v27, 1344, v27
    v_lshrrev_b32 v28, 4, v0
    v_lshl_add_u32 v27, v28, 5, v27
    v_and_b32 v28, 3, v1
    v_lshl_add_u32 v27, v28, 3, v27
    v_add_u32 v27, 139904, v27
    v_lshlrev_b32 v29, 2, v9
    v_add_u32 v29, 152576, v29
    v_mov_b32 v30, 152576
    s_mul_i32 s58, s6, 10240
    v_lshl_add_u32 v2, v0, 4, s58
    v_add_u32 v3, 4096, v2
    v_add_u32 v4, 8192, v2
    s_waitcnt vmcnt(8) lgkmcnt(0)
    ds_write_b64 v8, v[10:11] offset:0
    ds_write_b64 v8, v[12:13] offset:256
    ds_write_b64 v8, v[14:15] offset:512
    ds_write_b64 v8, v[16:17] offset:768
    ds_write_b64 v8, v[18:19] offset:1024
    v_dot2_f32_bf16 v24, v10, v26, v24
    v_dot2_f32_bf16 v25, v10, v10, v25
    v_dot2_f32_bf16 v24, v11, v26, v24
    v_dot2_f32_bf16 v25, v11, v11, v25
    v_dot2_f32_bf16 v24, v12, v26, v24
    v_dot2_f32_bf16 v25, v12, v12, v25
    v_dot2_f32_bf16 v24, v13, v26, v24
    v_dot2_f32_bf16 v25, v13, v13, v25
    v_dot2_f32_bf16 v24, v14, v26, v24
    v_dot2_f32_bf16 v25, v14, v14, v25
    v_dot2_f32_bf16 v24, v15, v26, v24
    v_dot2_f32_bf16 v25, v15, v15, v25
    v_dot2_f32_bf16 v24, v16, v26, v24
    v_dot2_f32_bf16 v25, v16, v16, v25
    v_dot2_f32_bf16 v24, v17, v26, v24
    v_dot2_f32_bf16 v25, v17, v17, v25
    v_dot2_f32_bf16 v24, v18, v26, v24
    v_dot2_f32_bf16 v25, v18, v18, v25
    v_dot2_f32_bf16 v24, v19, v26, v24
    v_dot2_f32_bf16 v25, v19, v19, v25
    s_mul_i32 s10, s10, 1664525
    s_add_u32 s10, s10, 1013904223
    s_nop 1
    v_add_f32_dpp v24, v24, v24 quad_perm:[1,0,3,2] row_mask:0xf bank_mask:0xf
    v_add_f32_dpp v25, v25, v25 quad_perm:[1,0,3,2] row_mask:0xf bank_mask:0xf
    s_nop 0
    v_add_f32_dpp v24, v24, v24 quad_perm:[2,3,0,1] row_mask:0xf bank_mask:0xf
    v_add_f32_dpp v25, v25, v25 quad_perm:[2,3,0,1] row_mask:0xf bank_mask:0xf
    s_nop 0
    v_add_f32_dpp v24, v24, v24 row_half_mirror row_mask:0xf bank_mask:0xf
    v_add_f32_dpp v25, v25, v25 row_half_mirror row_mask:0xf bank_mask:0xf
    s_nop 0
    v_add_f32_dpp v24, v24, v24 row_mirror row_mask:0xf bank_mask:0xf
    v_add_f32_dpp v25, v25, v25 row_mirror row_mask:0xf bank_mask:0xf
    v_mov_b32 v31, v24
    v_mov_b32 v32, v25
    s_nop 0
    v_permlane16_swap_b32 v24, v31
    v_permlane16_swap_b32 v25, v32
    v_add_f32 v24, v24, v31
    v_add_f32 v25, v25, v32
    v_mul_f32 v24, 0x3acccccd, v24
    v_mul_f32 v25, 0x3acccccd, v25
    v_fma_f32 v25, -v24, v24, v25
    v_max_f32 v25, 0, v25
    v_cvt_pk_bf16_f32 v25, v25, v25
    v_and_b32 v25, 0xffff0000, v25
    v_cvt_pk_bf16_f32 v24, v24, v24
    v_and_b32 v24, 0xffff0000, v24
    v_add_f32 v25, 0x3727c5ac, v25
    v_cvt_pk_bf16_f32 v25, v25, v25
    v_and_b32 v25, 0xffff0000, v25
    v_sqrt_f32 v25, v25
    s_nop 0
    v_cvt_pk_bf16_f32 v25, v25, v25
    v_and_b32 v25, 0xffff0000, v25
    v_rcp_f32 v25, v25
    ds_write_b32 v29, v24
    ds_write_b32 v29, v25 offset:32
    s_waitcnt lgkmcnt(0)
    s_barrier
    ds_read_b64_tr_b16 v[200:201], v27 offset:0
    ds_read_b64_tr_b16 v[202:203], v27 offset:5376
    ds_read_b64_tr_b16 v[204:205], v27 offset:512
    ds_read_b64_tr_b16 v[206:207], v27 offset:5888
    ds_read_b64_tr_b16 v[208:209], v27 offset:1024
    ds_read_b64_tr_b16 v[210:211], v27 offset:6400
    ds_read_b128 v[32:35], v30 offset:0
    ds_read_b128 v[36:39], v30 offset:16
    ds_read_b128 v[40:43], v30 offset:32
    ds_read_b128 v[44:47], v30 offset:48
    s_waitcnt lgkmcnt(4)
    v_lshlrev_b32 v48, 16, v200
    v_and_b32 v49, 0xffff0000, v200
    v_lshlrev_b32 v50, 16, v201
    v_and_b32 v51, 0xffff0000, v201
    v_lshlrev_b32 v52, 16, v202
    v_and_b32 v53, 0xffff0000, v202
    v_lshlrev_b32 v54, 16, v203
    v_and_b32 v55, 0xffff0000, v203
    v_lshlrev_b32 v56, 16, v204
    v_and_b32 v57, 0xffff0000, v204
    v_lshlrev_b32 v58, 16, v205
    v_and_b32 v59, 0xffff0000, v205
    v_lshlrev_b32 v60, 16, v206
    v_and_b32 v61, 0xffff0000, v206
    v_lshlrev_b32 v62, 16, v207
    v_and_b32 v63, 0xffff0000, v207
    v_lshlrev_b32 v64, 16, v208
    v_and_b32 v65, 0xffff0000, v208
    v_lshlrev_b32 v66, 16, v209
    v_and_b32 v67, 0xffff0000, v209
    v_lshlrev_b32 v68, 16, v210
    v_and_b32 v69, 0xffff0000, v210
    v_lshlrev_b32 v70, 16, v211
    v_and_b32 v71, 0xffff0000, v211
    s_waitcnt lgkmcnt(0)
    v_pk_add_f32 v[48:49], v[48:49], v[32:33] neg_lo:[0,1] neg_hi:[0,1]
    v_pk_add_f32 v[50:51], v[50:51], v[34:35] neg_lo:[0,1] neg_hi:[0,1]
    v_pk_add_f32 v[52:53], v[52:53], v[36:37] neg_lo:[0,1] neg_hi:[0,1]
    v_pk_add_f32 v[54:55], v[54:55], v[38:39] neg_lo:[0,1] neg_hi:[0,1]
    v_pk_add_f32 v[56:57], v[56:57], v[32:33] neg_lo:[0,1] neg_hi:[0,1]
    v_pk_add_f32 v[58:59], v[58:59], v[34:35] neg_lo:[0,1] neg_hi:[0,1]
    v_pk_add_f32 v[60:61], v[60:61], v[36:37] neg_lo:[0,1] neg_hi:[0,1]
    v_pk_add_f32 v[62:63], v[62:63], v[38:39] neg_lo:[0,1] neg_hi:[0,1]
    v_pk_add_f32 v[64:65], v[64:65], v[32:33] neg_lo:[0,1] neg_hi:[0,1]
    v_pk_add_f32 v[66:67], v[66:67], v[34:35] neg_lo:[0,1] neg_hi:[0,1]
    v_pk_add_f32 v[68:69], v[68:69], v[36:37] neg_lo:[0,1] neg_hi:[0,1]
    v_pk_add_f32 v[70:71], v[70:71], v[38:39] neg_lo:[0,1] neg_hi:[0,1]
    v_cvt_pk_bf16_f32 v72, v48, v49
    v_cvt_pk_bf16_f32 v73, v50, v51
    v_cvt_pk_bf16_f32 v74, v52, v53
    v_cvt_pk_bf16_f32 v75, v54, v55
    v_cvt_pk_bf16_f32 v76, v56, v57
    v_cvt_pk_bf16_f32 v77, v58, v59
    v_cvt_pk_bf16_f32 v78, v60, v61
    v_cvt_pk_bf16_f32 v79, v62, v63
    v_cvt_pk_bf16_f32 v80, v64, v65
    v_cvt_pk_bf16_f32 v81, v66, v67
    v_cvt_pk_bf16_f32 v82, v68, v69
    v_cvt_pk_bf16_f32 v83, v70, v71
    v_lshlrev_b32 v48, 16, v72
    v_and_b32 v49, 0xffff0000, v72
    v_lshlrev_b32 v50, 16, v73
    v_and_b32 v51, 0xffff0000, v73
    v_lshlrev_b32 v52, 16, v74
    v_and_b32 v53, 0xffff0000, v74
    v_lshlrev_b32 v54, 16, v75
    v_and_b32 v55, 0xffff0000, v75
    v_lshlrev_b32 v56, 16, v76
    v_and_b32 v57, 0xffff0000, v76
    v_lshlrev_b32 v58, 16, v77
    v_and_b32 v59, 0xffff0000, v77
    v_lshlrev_b32 v60, 16, v78
    v_and_b32 v61, 0xffff0000, v78
    v_lshlrev_b32 v62, 16, v79
    v_and_b32 v63, 0xffff0000, v79
    v_lshlrev_b32 v64, 16, v80
    v_and_b32 v65, 0xffff0000, v80
    v_lshlrev_b32 v66, 16, v81
    v_and_b32 v67, 0xffff0000, v81
    v_lshlrev_b32 v68, 16, v82
    v_and_b32 v69, 0xffff0000, v82
    v_lshlrev_b32 v70, 16, v83
    v_and_b32 v71, 0xffff0000, v83
    v_pk_mul_f32 v[48:49], v[48:49], v[40:41]
    v_pk_mul_f32 v[50:51], v[50:51], v[42:43]
    v_pk_mul_f32 v[52:53], v[52:53], v[44:45]
    v_pk_mul_f32 v[54:55], v[54:55], v[46:47]
    v_pk_mul_f32 v[56:57], v[56:57], v[40:41]
    v_pk_mul_f32 v[58:59], v[58:59], v[42:43]
    v_pk_mul_f32 v[60:61], v[60:61], v[44:45]
    v_pk_mul_f32 v[62:63], v[62:63], v[46:47]
    v_pk_mul_f32 v[64:65], v[64:65], v[40:41]
    v_pk_mul_f32 v[66:67], v[66:67], v[42:43]
    v_pk_mul_f32 v[68:69], v[68:69], v[44:45]
    v_pk_mul_f32 v[70:71], v[70:71], v[46:47]
    v_cvt_pk_bf16_f32 v72, v48, v49
    v_cvt_pk_bf16_f32 v73, v50, v51
    v_cvt_pk_bf16_f32 v74, v52, v53
    v_cvt_pk_bf16_f32 v75, v54, v55
    v_cvt_pk_bf16_f32 v76, v56, v57
    v_cvt_pk_bf16_f32 v77, v58, v59
    v_cvt_pk_bf16_f32 v78, v60, v61
    v_cvt_pk_bf16_f32 v79, v62, v63
    v_cvt_pk_bf16_f32 v80, v64, v65
    v_cvt_pk_bf16_f32 v81, v66, v67
    v_cvt_pk_bf16_f32 v82, v68, v69
    v_cvt_pk_bf16_f32 v83, v70, v71
    v_lshlrev_b32 v48, 16, v72
    v_and_b32 v49, 0xffff0000, v72
    v_lshlrev_b32 v50, 16, v73
    v_and_b32 v51, 0xffff0000, v73
    v_lshlrev_b32 v52, 16, v74
    v_and_b32 v53, 0xffff0000, v74
    v_lshlrev_b32 v54, 16, v75
    v_and_b32 v55, 0xffff0000, v75
    v_lshlrev_b32 v56, 16, v76
    v_and_b32 v57, 0xffff0000, v76
    v_lshlrev_b32 v58, 16, v77
    v_and_b32 v59, 0xffff0000, v77
    v_lshlrev_b32 v60, 16, v78
    v_and_b32 v61, 0xffff0000, v78
    v_lshlrev_b32 v62, 16, v79
    v_and_b32 v63, 0xffff0000, v79
    v_lshlrev_b32 v64, 16, v80
    v_and_b32 v65, 0xffff0000, v80
    v_lshlrev_b32 v66, 16, v81
    v_and_b32 v67, 0xffff0000, v81
    v_lshlrev_b32 v68, 16, v82
    v_and_b32 v69, 0xffff0000, v82
    v_lshlrev_b32 v70, 16, v83
    v_and_b32 v71, 0xffff0000, v83
    v_cvt_pk_f16_f32 v84, v48, v49
    v_cvt_pk_f16_f32 v85, v50, v51
    v_cvt_pk_f16_f32 v86, v52, v53
    v_cvt_pk_f16_f32 v87, v54, v55
    v_cvt_pk_f16_f32 v88, v56, v57
    v_cvt_pk_f16_f32 v89, v58, v59
    v_cvt_pk_f16_f32 v90, v60, v61
    v_cvt_pk_f16_f32 v91, v62, v63
    v_cvt_pk_f16_f32 v92, v64, v65
    v_cvt_pk_f16_f32 v93, v66, v67
    v_cvt_pk_f16_f32 v94, v68, v69
    v_cvt_pk_f16_f32 v95, v70, v71
    s_waitcnt vmcnt(1)
    global_store_dwordx4 v2, v[84:87], s[12:13] sc1
    global_store_dwordx4 v3, v[88:91], s[12:13] sc1
    s_cmp_ge_u32 s3, 2
    s_cbranch_scc1 L_ut3_2
    global_store_dwordx4 v4, v[92:95], s[12:13] sc1
L_ut3_2:
    v_lshlrev_b32 v100, 16, v228
    v_lshlrev_b32 v102, 16, v229
    v_lshlrev_b32 v104, 16, v230
    v_pk_mul_f32 v[48:49], v[48:49], v[100:101] op_sel_hi:[1,0]
    v_pk_mul_f32 v[50:51], v[50:51], v[100:101] op_sel_hi:[1,0]
    v_pk_mul_f32 v[52:53], v[52:53], v[100:101] op_sel_hi:[1,0]
    v_pk_mul_f32 v[54:55], v[54:55], v[100:101] op_sel_hi:[1,0]
    v_pk_mul_f32 v[56:57], v[56:57], v[102:103] op_sel_hi:[1,0]
    v_pk_mul_f32 v[58:59], v[58:59], v[102:103] op_sel_hi:[1,0]
    v_pk_mul_f32 v[60:61], v[60:61], v[102:103] op_sel_hi:[1,0]
    v_pk_mul_f32 v[62:63], v[62:63], v[102:103] op_sel_hi:[1,0]
    v_pk_mul_f32 v[64:65], v[64:65], v[104:105] op_sel_hi:[1,0]
    v_pk_mul_f32 v[66:67], v[66:67], v[104:105] op_sel_hi:[1,0]
    v_pk_mul_f32 v[68:69], v[68:69], v[104:105] op_sel_hi:[1,0]
    v_pk_mul_f32 v[70:71], v[70:71], v[104:105] op_sel_hi:[1,0]
    v_cvt_pk_bf16_f32 v212, v48, v49
    v_cvt_pk_bf16_f32 v213, v50, v51
    v_cvt_pk_bf16_f32 v214, v52, v53
    v_cvt_pk_bf16_f32 v215, v54, v55
    v_cvt_pk_bf16_f32 v216, v56, v57
    v_cvt_pk_bf16_f32 v217, v58, v59
    v_cvt_pk_bf16_f32 v218, v60, v61
    v_cvt_pk_bf16_f32 v219, v62, v63
    v_cvt_pk_bf16_f32 v220, v64, v65
    v_cvt_pk_bf16_f32 v221, v66, v67
    v_cvt_pk_bf16_f32 v222, v68, v69
    v_cvt_pk_bf16_f32 v223, v70, v71
    s_cmp_ge_u32 s5, 27
    s_cbranch_scc1 L_helper
    s_cmp_eq_u32 s3, 3
    s_cbranch_scc1 L_w3_3
    s_and_b32 s57, s56, 1
    s_lshl_b32 s57, s57, 4
    s_lshr_b32 s59, s59, s57
    s_lshl_b32 s59, s59, 16
    v_mov_b32 v242, 0x3fb8aa3b
    v_mul_f32 v242, s59, v242
    v_exp_f32 v242, v242
    v_and_b32 v243, 0x7fff7fff, v226
    v_and_b32 v244, 0x7fff7fff, v227
    v_pk_max_u16 v243, v243, v244
    v_lshlrev_b32 v244, 16, v243
    v_max_u32 v243, v243, v244
    v_cvt_pk_bf16_f32 v242, v242, v242
    v_and_b32 v242, 0xffff0000, v242
    v_lshlrev_b32 v246, 16, v224
    v_and_b32 v250, 0xffff0000, v224
    v_max_u32_dpp v243, v243, v243 quad_perm:[1,0,3,2] row_mask:0xf bank_mask:0xf
    v_mul_f32 v246, 0x3fb8aa3b, v246
    v_mul_f32 v250, 0x3fb8aa3b, v250
    v_max_u32_dpp v243, v243, v243 quad_perm:[2,3,0,1] row_mask:0xf bank_mask:0xf
    v_exp_f32 v246, v246
    v_exp_f32 v250, v250
    v_max_u32_dpp v243, v243, v243 row_half_mirror row_mask:0xf bank_mask:0xf
    v_lshlrev_b32 v247, 16, v225
    v_and_b32 v251, 0xffff0000, v225
    v_max_u32_dpp v243, v243, v243 row_mirror row_mask:0xf bank_mask:0xf
    v_mul_f32 v247, v247, v242
    v_mul_f32 v251, v251, v242
    v_mov_b32 v244, v243
    v_lshlrev_b32 v248, 16, v226
    v_and_b32 v252, 0xffff0000, v226
    v_permlane16_swap_b32 v243, v244
    v_max_u32 v243, v243, v244
    v_mov_b32 v244, v243
    v_lshlrev_b32 v249, 16, v227
    v_and_b32 v253, 0xffff0000, v227
    v_permlane32_swap_b32 v243, v244
    v_max_u32 v243, v243, v244
    v_cvt_pk_bf16_f32 v246, v246, v246
    v_and_b32 v246, 0xffff0000, v246
    v_cvt_pk_bf16_f32 v250, v250, v250
    v_and_b32 v250, 0xffff0000, v250
    v_mul_f32 v247, 0x3e22f983, v247
    v_mul_f32 v251, 0x3e22f983, v251
    v_mul_f32 v246, v246, v242
    v_mul_f32 v250, v250, v242
    v_mul_f32 v246, 0xbfb8aa3b, v246
    v_mul_f32 v250, 0xbfb8aa3b, v250
    v_mul_f32 v180, 0x41000000, v246
    v_mul_f32 v181, 0x41000000, v247
    v_mul_f32 v182, 0x41000000, v250
    v_mul_f32 v183, 0x41000000, v251
    v_mul_f32 v184, 0x3f800000, v246
    v_mul_f32 v185, 0x3f800000, v247
    v_mul_f32 v186, 0x3f800000, v250
    v_mul_f32 v187, 0x3f800000, v251
    v_mul_f32 v188, 0x43800000, v246
    v_mul_f32 v189, 0x43800000, v247
    v_mul_f32 v190, 0x43800000, v250
    v_mul_f32 v191, 0x43800000, v251
    v_exp_f32 v180, v180
    v_fract_f32 v181, v181
    v_exp_f32 v182, v182
    v_fract_f32 v183, v183
    v_exp_f32 v184, v184
    v_fract_f32 v185, v185
    v_exp_f32 v186, v186
    v_fract_f32 v187, v187
    v_exp_f32 v188, v188
    v_fract_f32 v189, v189
    v_exp_f32 v190, v190
    v_fract_f32 v191, v191
    v_cos_f32 v12, v181
    v_sin_f32 v13, v181
    v_cos_f32 v102, v183
    v_sin_f32 v103, v183
    v_cos_f32 v76, v185
    v_sin_f32 v77, v185
    v_cos_f32 v166, v187
    v_sin_f32 v167, v187
    v_cos_f32 v82, v189
    v_sin_f32 v83, v189
    v_cos_f32 v172, v191
    v_sin_f32 v173, v191
    v_pk_mul_f32 v[12:13], v[180:181], v[12:13] op_sel:[0,0] op_sel_hi:[0,1]
    v_pk_mul_f32 v[102:103], v[182:183], v[102:103] op_sel:[0,0] op_sel_hi:[0,1]
    v_pk_mul_f32 v[76:77], v[184:185], v[76:77] op_sel:[0,0] op_sel_hi:[0,1]
    v_pk_mul_f32 v[166:167], v[186:187], v[166:167] op_sel:[0,0] op_sel_hi:[0,1]
    v_pk_mul_f32 v[82:83], v[188:189], v[82:83] op_sel:[0,0] op_sel_hi:[0,1]
    v_pk_mul_f32 v[172:173], v[190:191], v[172:173] op_sel:[0,0] op_sel_hi:[0,1]
    v_and_b32 v243, 0x7f800000, v243
    v_max_u32 v243, 0x00800000, v243
    v_min_u32 v243, 0x7e800000, v243
    v_sub_u32 v244, 0x7f800000, v243
    v_mul_f32 v245, v243, v242
    v_mul_f32 v248, v248, v244
    v_mul_f32 v249, v249, v244
    v_mul_f32 v252, v252, v244
    v_mul_f32 v253, v253, v244
    s_lshl_b32 s54, s3, 2
    s_add_u32 s54, s54, 152704
    v_mov_b32 v5, s54
    ds_write_b32 v5, v245
    s_mul_i32 s60, s3, 27984
    v_lshl_add_u32 v6, v1, 3, s60
    s_lshl_b32 s54, s6, 7
    s_lshl_b32 s55, s3, 2
    s_add_u32 s54, s54, s55
    v_mov_b32 v2, s54
    v_mov_b32 v3, s10
    s_waitcnt vmcnt(0)
    s_mov_b64 exec, 1
    global_store_dword v2, v3, s[52:53] sc1
    s_mov_b64 exec, -1
    global_load_dword v254, v231, s[32:33]
    v_add_u32 v231, 884736, v231
    v_mov_b32 v196, 0x00003c00
    v_mov_b32 v197, 0x00003c00
    ds_write_b64 v6, v[196:197] offset:11088
    v_pk_mul_f32 v[14:15], v[12:13], v[12:13] op_sel:[0,0] op_sel_hi:[0,1]
    v_pk_mul_f32 v[104:105], v[102:103], v[102:103] op_sel:[0,0] op_sel_hi:[0,1]
    v_pk_mul_f32 v[78:79], v[76:77], v[76:77] op_sel:[0,0] op_sel_hi:[0,1]
    v_pk_mul_f32 v[168:169], v[166:167], v[166:167] op_sel:[0,0] op_sel_hi:[0,1]
    v_pk_mul_f32 v[84:85], v[82:83], v[82:83] op_sel:[0,0] op_sel_hi:[0,1]
    v_pk_mul_f32 v[174:175], v[172:173], v[172:173] op_sel:[0,0] op_sel_hi:[0,1]
    v_pk_fma_f32 v[14:15], v[12:13], v[12:13], v[14:15] op_sel:[1,1,0] op_sel_hi:[1,0,1] neg_lo:[0,1,0]
    v_pk_fma_f32 v[104:105], v[102:103], v[102:103], v[104:105] op_sel:[1,1,0] op_sel_hi:[1,0,1] neg_lo:[0,1,0]
    v_pk_fma_f32 v[78:79], v[76:77], v[76:77], v[78:79] op_sel:[1,1,0] op_sel_hi:[1,0,1] neg_lo:[0,1,0]
    v_pk_fma_f32 v[168:169], v[166:167], v[166:167], v[168:169] op_sel:[1,1,0] op_sel_hi:[1,0,1] neg_lo:[0,1,0]
    v_pk_fma_f32 v[84:85], v[82:83], v[82:83], v[84:85] op_sel:[1,1,0] op_sel_hi:[1,0,1] neg_lo:[0,1,0]
    v_pk_fma_f32 v[174:175], v[172:173], v[172:173], v[174:175] op_sel:[1,1,0] op_sel_hi:[1,0,1] neg_lo:[0,1,0]
    v_pk_mul_f32 v[18:19], v[14:15], v[14:15] op_sel:[0,0] op_sel_hi:[0,1]
    v_pk_mul_f32 v[108:109], v[104:105], v[104:105] op_sel:[0,0] op_sel_hi:[0,1]
    v_pk_mul_f32 v[16:17], v[12:13], v[14:15] op_sel:[0,0] op_sel_hi:[0,1]
    v_pk_mul_f32 v[106:107], v[102:103], v[104:105] op_sel:[0,0] op_sel_hi:[0,1]
    v_pk_mul_f32 v[80:81], v[78:79], v[78:79] op_sel:[0,0] op_sel_hi:[0,1]
    v_pk_mul_f32 v[170:171], v[168:169], v[168:169] op_sel:[0,0] op_sel_hi:[0,1]
    v_pk_mul_f32 v[86:87], v[84:85], v[84:85] op_sel:[0,0] op_sel_hi:[0,1]
    v_pk_mul_f32 v[176:177], v[174:175], v[174:175] op_sel:[0,0] op_sel_hi:[0,1]
    v_pk_fma_f32 v[18:19], v[14:15], v[14:15], v[18:19] op_sel:[1,1,0] op_sel_hi:[1,0,1] neg_lo:[0,1,0]
    v_pk_fma_f32 v[108:109], v[104:105], v[104:105], v[108:109] op_sel:[1,1,0] op_sel_hi:[1,0,1] neg_lo:[0,1,0]
    v_pk_fma_f32 v[16:17], v[12:13], v[14:15], v[16:17] op_sel:[1,1,0] op_sel_hi:[1,0,1] neg_lo:[0,1,0]
    v_pk_fma_f32 v[106:107], v[102:103], v[104:105], v[106:107] op_sel:[1,1,0] op_sel_hi:[1,0,1] neg_lo:[0,1,0]
    v_pk_fma_f32 v[80:81], v[78:79], v[78:79], v[80:81] op_sel:[1,1,0] op_sel_hi:[1,0,1] neg_lo:[0,1,0]
    v_pk_fma_f32 v[170:171], v[168:169], v[168:169], v[170:171] op_sel:[1,1,0] op_sel_hi:[1,0,1] neg_lo:[0,1,0]
    v_pk_fma_f32 v[86:87], v[84:85], v[84:85], v[86:87] op_sel:[1,1,0] op_sel_hi:[1,0,1] neg_lo:[0,1,0]
    v_pk_fma_f32 v[176:177], v[174:175], v[174:175], v[176:177] op_sel:[1,1,0] op_sel_hi:[1,0,1] neg_lo:[0,1,0]
    v_pk_mul_f32 v[26:27], v[18:19], v[18:19] op_sel:[0,0] op_sel_hi:[0,1]
    v_pk_mul_f32 v[116:117], v[108:109], v[108:109] op_sel:[0,0] op_sel_hi:[0,1]
    v_cvt_pk_f16_f32 v188, v12, v13
    v_cvt_pk_f16_f32 v189, v102, v103
    ds_write_b64 v6, v[188:189] offset:11616
    v_pk_mul_f32 v[20:21], v[12:13], v[18:19] op_sel:[0,0] op_sel_hi:[0,1]
    v_pk_mul_f32 v[110:111], v[102:103], v[108:109] op_sel:[0,0] op_sel_hi:[0,1]
    v_pk_mul_f32 v[22:23], v[14:15], v[18:19] op_sel:[0,0] op_sel_hi:[0,1]
    v_pk_mul_f32 v[112:113], v[104:105], v[108:109] op_sel:[0,0] op_sel_hi:[0,1]
    v_cvt_pk_f16_f32 v190, v14, v15
    v_cvt_pk_f16_f32 v191, v104, v105
    ds_write_b64 v6, v[190:191] offset:12144
    v_pk_mul_f32 v[24:25], v[16:17], v[18:19] op_sel:[0,0] op_sel_hi:[0,1]
    v_pk_mul_f32 v[114:115], v[106:107], v[108:109] op_sel:[0,0] op_sel_hi:[0,1]
    v_pk_mul_f32 v[88:89], v[86:87], v[86:87] op_sel:[0,0] op_sel_hi:[0,1]
    v_pk_mul_f32 v[178:179], v[176:177], v[176:177] op_sel:[0,0] op_sel_hi:[0,1]
    v_cvt_pk_f16_f32 v192, v16, v17
    v_cvt_pk_f16_f32 v193, v106, v107
    ds_write_b64 v6, v[192:193] offset:12672
    v_pk_fma_f32 v[26:27], v[18:19], v[18:19], v[26:27] op_sel:[1,1,0] op_sel_hi:[1,0,1] neg_lo:[0,1,0]
    v_pk_fma_f32 v[116:117], v[108:109], v[108:109], v[116:117] op_sel:[1,1,0] op_sel_hi:[1,0,1] neg_lo:[0,1,0]
    v_pk_fma_f32 v[20:21], v[12:13], v[18:19], v[20:21] op_sel:[1,1,0] op_sel_hi:[1,0,1] neg_lo:[0,1,0]
    v_pk_fma_f32 v[110:111], v[102:103], v[108:109], v[110:111] op_sel:[1,1,0] op_sel_hi:[1,0,1] neg_lo:[0,1,0]
    v_cvt_pk_f16_f32 v194, v18, v19
    v_cvt_pk_f16_f32 v195, v108, v109
    ds_write_b64 v6, v[194:195] offset:13200
    v_pk_fma_f32 v[22:23], v[14:15], v[18:19], v[22:23] op_sel:[1,1,0] op_sel_hi:[1,0,1] neg_lo:[0,1,0]
    v_pk_fma_f32 v[112:113], v[104:105], v[108:109], v[112:113] op_sel:[1,1,0] op_sel_hi:[1,0,1] neg_lo:[0,1,0]
    v_pk_fma_f32 v[24:25], v[16:17], v[18:19], v[24:25] op_sel:[1,1,0] op_sel_hi:[1,0,1] neg_lo:[0,1,0]
    v_pk_fma_f32 v[114:115], v[106:107], v[108:109], v[114:115] op_sel:[1,1,0] op_sel_hi:[1,0,1] neg_lo:[0,1,0]
    v_cvt_pk_f16_f32 v196, v248, -v249
    v_cvt_pk_f16_f32 v197, v252, -v253
    ds_write_b64 v6, v[196:197] offset:0
    v_pk_fma_f32 v[88:89], v[86:87], v[86:87], v[88:89] op_sel:[1,1,0] op_sel_hi:[1,0,1] neg_lo:[0,1,0]
    v_pk_fma_f32 v[178:179], v[176:177], v[176:177], v[178:179] op_sel:[1,1,0] op_sel_hi:[1,0,1] neg_lo:[0,1,0]
    v_pk_mul_f32 v[42:43], v[26:27], v[26:27] op_sel:[0,0] op_sel_hi:[0,1]
    v_pk_mul_f32 v[132:133], v[116:117], v[116:117] op_sel:[0,0] op_sel_hi:[0,1]
    v_pk_mul_f32 v[28:29], v[12:13], v[26:27] op_sel:[0,0] op_sel_hi:[0,1]
    v_pk_mul_f32 v[118:119], v[102:103], v[116:117] op_sel:[0,0] op_sel_hi:[0,1]
    v_cvt_pk_f16_f32 v198, v20, v21
    v_cvt_pk_f16_f32 v199, v110, v111
    ds_write_b64 v6, v[198:199] offset:13728
    v_pk_mul_f32 v[30:31], v[14:15], v[26:27] op_sel:[0,0] op_sel_hi:[0,1]
    v_pk_mul_f32 v[120:121], v[104:105], v[116:117] op_sel:[0,0] op_sel_hi:[0,1]
    v_pk_mul_f32 v[32:33], v[16:17], v[26:27] op_sel:[0,0] op_sel_hi:[0,1]
    v_pk_mul_f32 v[122:123], v[106:107], v[116:117] op_sel:[0,0] op_sel_hi:[0,1]
    v_pk_mul_f32 v[34:35], v[18:19], v[26:27] op_sel:[0,0] op_sel_hi:[0,1]
    v_pk_mul_f32 v[124:125], v[108:109], v[116:117] op_sel:[0,0] op_sel_hi:[0,1]
    v_pk_mul_f32 v[36:37], v[20:21], v[26:27] op_sel:[0,0] op_sel_hi:[0,1]
    v_pk_mul_f32 v[126:127], v[110:111], v[116:117] op_sel:[0,0] op_sel_hi:[0,1]
    v_cvt_pk_f16_f32 v188, v22, v23
    v_cvt_pk_f16_f32 v189, v112, v113
    ds_write_b64 v6, v[188:189] offset:14256
    v_pk_mul_f32 v[38:39], v[22:23], v[26:27] op_sel:[0,0] op_sel_hi:[0,1]
    v_pk_mul_f32 v[128:129], v[112:113], v[116:117] op_sel:[0,0] op_sel_hi:[0,1]
    v_pk_mul_f32 v[40:41], v[24:25], v[26:27] op_sel:[0,0] op_sel_hi:[0,1]
    v_pk_mul_f32 v[130:131], v[114:115], v[116:117] op_sel:[0,0] op_sel_hi:[0,1]
    v_pk_fma_f32 v[42:43], v[26:27], v[26:27], v[42:43] op_sel:[1,1,0] op_sel_hi:[1,0,1] neg_lo:[0,1,0]
    v_pk_fma_f32 v[132:133], v[116:117], v[116:117], v[132:133] op_sel:[1,1,0] op_sel_hi:[1,0,1] neg_lo:[0,1,0]
    v_pk_fma_f32 v[28:29], v[12:13], v[26:27], v[28:29] op_sel:[1,1,0] op_sel_hi:[1,0,1] neg_lo:[0,1,0]
    v_pk_fma_f32 v[118:119], v[102:103], v[116:117], v[118:119] op_sel:[1,1,0] op_sel_hi:[1,0,1] neg_lo:[0,1,0]
    v_cvt_pk_f16_f32 v190, v24, v25
    v_cvt_pk_f16_f32 v191, v114, v115
    ds_write_b64 v6, v[190:191] offset:14784
    v_pk_fma_f32 v[30:31], v[14:15], v[26:27], v[30:31] op_sel:[1,1,0] op_sel_hi:[1,0,1] neg_lo:[0,1,0]
    v_pk_fma_f32 v[120:121], v[104:105], v[116:117], v[120:121] op_sel:[1,1,0] op_sel_hi:[1,0,1] neg_lo:[0,1,0]
    v_pk_fma_f32 v[32:33], v[16:17], v[26:27], v[32:33] op_sel:[1,1,0] op_sel_hi:[1,0,1] neg_lo:[0,1,0]
    v_pk_fma_f32 v[122:123], v[106:107], v[116:117], v[122:123] op_sel:[1,1,0] op_sel_hi:[1,0,1] neg_lo:[0,1,0]
    v_pk_fma_f32 v[34:35], v[18:19], v[26:27], v[34:35] op_sel:[1,1,0] op_sel_hi:[1,0,1] neg_lo:[0,1,0]
    v_pk_fma_f32 v[124:125], v[108:109], v[116:117], v[124:125] op_sel:[1,1,0] op_sel_hi:[1,0,1] neg_lo:[0,1,0]
    v_pk_fma_f32 v[36:37], v[20:21], v[26:27], v[36:37] op_sel:[1,1,0] op_sel_hi:[1,0,1] neg_lo:[0,1,0]
    v_pk_fma_f32 v[126:127], v[110:111], v[116:117], v[126:127] op_sel:[1,1,0] op_sel_hi:[1,0,1] neg_lo:[0,1,0]
    v_cvt_pk_f16_f32 v192, v26, v27
    v_cvt_pk_f16_f32 v193, v116, v117
    ds_write_b64 v6, v[192:193] offset:15312
    v_pk_fma_f32 v[38:39], v[22:23], v[26:27], v[38:39] op_sel:[1,1,0] op_sel_hi:[1,0,1] neg_lo:[0,1,0]
    v_pk_fma_f32 v[128:129], v[112:113], v[116:117], v[128:129] op_sel:[1,1,0] op_sel_hi:[1,0,1] neg_lo:[0,1,0]
    v_pk_fma_f32 v[40:41], v[24:25], v[26:27], v[40:41] op_sel:[1,1,0] op_sel_hi:[1,0,1] neg_lo:[0,1,0]
    v_pk_fma_f32 v[130:131], v[114:115], v[116:117], v[130:131] op_sel:[1,1,0] op_sel_hi:[1,0,1] neg_lo:[0,1,0]
    v_pk_mul_f32 v[46:47], v[12:13], v[42:43] op_sel:[0,0] op_sel_hi:[0,1]
    v_pk_mul_f32 v[136:137], v[102:103], v[132:133] op_sel:[0,0] op_sel_hi:[0,1]
    v_pk_mul_f32 v[48:49], v[14:15], v[42:43] op_sel:[0,0] op_sel_hi:[0,1]
    v_cvt_pk_f16_f32 v194, v28, v29
    v_cvt_pk_f16_f32 v195, v118, v119
    ds_write_b64 v6, v[194:195] offset:15840
    v_pk_mul_f32 v[138:139], v[104:105], v[132:133] op_sel:[0,0] op_sel_hi:[0,1]
    v_pk_mul_f32 v[50:51], v[16:17], v[42:43] op_sel:[0,0] op_sel_hi:[0,1]
    v_pk_mul_f32 v[140:141], v[106:107], v[132:133] op_sel:[0,0] op_sel_hi:[0,1]
    v_pk_mul_f32 v[52:53], v[18:19], v[42:43] op_sel:[0,0] op_sel_hi:[0,1]
    v_pk_mul_f32 v[142:143], v[108:109], v[132:133] op_sel:[0,0] op_sel_hi:[0,1]
    v_pk_mul_f32 v[54:55], v[20:21], v[42:43] op_sel:[0,0] op_sel_hi:[0,1]
    v_pk_mul_f32 v[144:145], v[110:111], v[132:133] op_sel:[0,0] op_sel_hi:[0,1]
    v_pk_mul_f32 v[56:57], v[22:23], v[42:43] op_sel:[0,0] op_sel_hi:[0,1]
    v_cvt_pk_f16_f32 v196, v30, v31
    v_cvt_pk_f16_f32 v197, v120, v121
    ds_write_b64 v6, v[196:197] offset:16368
    v_pk_mul_f32 v[146:147], v[112:113], v[132:133] op_sel:[0,0] op_sel_hi:[0,1]
    v_pk_mul_f32 v[58:59], v[24:25], v[42:43] op_sel:[0,0] op_sel_hi:[0,1]
    v_pk_mul_f32 v[148:149], v[114:115], v[132:133] op_sel:[0,0] op_sel_hi:[0,1]
    v_pk_mul_f32 v[60:61], v[26:27], v[42:43] op_sel:[0,0] op_sel_hi:[0,1]
    v_pk_mul_f32 v[150:151], v[116:117], v[132:133] op_sel:[0,0] op_sel_hi:[0,1]
    v_pk_mul_f32 v[62:63], v[28:29], v[42:43] op_sel:[0,0] op_sel_hi:[0,1]
    v_pk_mul_f32 v[152:153], v[118:119], v[132:133] op_sel:[0,0] op_sel_hi:[0,1]
    v_cvt_pk_f16_f32 v198, v32, v33
    v_cvt_pk_f16_f32 v199, v122, v123
    ds_write_b64 v6, v[198:199] offset:16896
    v_pk_mul_f32 v[64:65], v[30:31], v[42:43] op_sel:[0,0] op_sel_hi:[0,1]
    v_pk_mul_f32 v[154:155], v[120:121], v[132:133] op_sel:[0,0] op_sel_hi:[0,1]
    v_pk_mul_f32 v[66:67], v[32:33], v[42:43] op_sel:[0,0] op_sel_hi:[0,1]
    v_pk_mul_f32 v[156:157], v[122:123], v[132:133] op_sel:[0,0] op_sel_hi:[0,1]
    v_pk_mul_f32 v[68:69], v[34:35], v[42:43] op_sel:[0,0] op_sel_hi:[0,1]
    v_pk_mul_f32 v[158:159], v[124:125], v[132:133] op_sel:[0,0] op_sel_hi:[0,1]
    v_pk_mul_f32 v[70:71], v[36:37], v[42:43] op_sel:[0,0] op_sel_hi:[0,1]
    v_pk_mul_f32 v[160:161], v[126:127], v[132:133] op_sel:[0,0] op_sel_hi:[0,1]
    v_cvt_pk_f16_f32 v188, v34, v35
    v_cvt_pk_f16_f32 v189, v124, v125
    ds_write_b64 v6, v[188:189] offset:17424
    v_pk_mul_f32 v[72:73], v[38:39], v[42:43] op_sel:[0,0] op_sel_hi:[0,1]
    v_pk_mul_f32 v[162:163], v[128:129], v[132:133] op_sel:[0,0] op_sel_hi:[0,1]
    v_pk_mul_f32 v[74:75], v[40:41], v[42:43] op_sel:[0,0] op_sel_hi:[0,1]
    v_pk_mul_f32 v[164:165], v[130:131], v[132:133] op_sel:[0,0] op_sel_hi:[0,1]
    v_pk_fma_f32 v[46:47], v[12:13], v[42:43], v[46:47] op_sel:[1,1,0] op_sel_hi:[1,0,1] neg_lo:[0,1,0]
    v_pk_fma_f32 v[136:137], v[102:103], v[132:133], v[136:137] op_sel:[1,1,0] op_sel_hi:[1,0,1] neg_lo:[0,1,0]
    v_pk_fma_f32 v[48:49], v[14:15], v[42:43], v[48:49] op_sel:[1,1,0] op_sel_hi:[1,0,1] neg_lo:[0,1,0]
    v_cvt_pk_f16_f32 v190, v36, v37
    v_cvt_pk_f16_f32 v191, v126, v127
    ds_write_b64 v6, v[190:191] offset:17952
    v_pk_fma_f32 v[138:139], v[104:105], v[132:133], v[138:139] op_sel:[1,1,0] op_sel_hi:[1,0,1] neg_lo:[0,1,0]
    v_pk_fma_f32 v[50:51], v[16:17], v[42:43], v[50:51] op_sel:[1,1,0] op_sel_hi:[1,0,1] neg_lo:[0,1,0]
    v_pk_fma_f32 v[140:141], v[106:107], v[132:133], v[140:141] op_sel:[1,1,0] op_sel_hi:[1,0,1] neg_lo:[0,1,0]
    v_pk_fma_f32 v[52:53], v[18:19], v[42:43], v[52:53] op_sel:[1,1,0] op_sel_hi:[1,0,1] neg_lo:[0,1,0]
    v_pk_fma_f32 v[142:143], v[108:109], v[132:133], v[142:143] op_sel:[1,1,0] op_sel_hi:[1,0,1] neg_lo:[0,1,0]
    v_pk_fma_f32 v[54:55], v[20:21], v[42:43], v[54:55] op_sel:[1,1,0] op_sel_hi:[1,0,1] neg_lo:[0,1,0]
    v_pk_fma_f32 v[144:145], v[110:111], v[132:133], v[144:145] op_sel:[1,1,0] op_sel_hi:[1,0,1] neg_lo:[0,1,0]
    v_pk_fma_f32 v[56:57], v[22:23], v[42:43], v[56:57] op_sel:[1,1,0] op_sel_hi:[1,0,1] neg_lo:[0,1,0]
    v_cvt_pk_f16_f32 v192, v38, v39
    v_cvt_pk_f16_f32 v193, v128, v129
    ds_write_b64 v6, v[192:193] offset:18480
    v_pk_fma_f32 v[146:147], v[112:113], v[132:133], v[146:147] op_sel:[1,1,0] op_sel_hi:[1,0,1] neg_lo:[0,1,0]
    v_pk_fma_f32 v[58:59], v[24:25], v[42:43], v[58:59] op_sel:[1,1,0] op_sel_hi:[1,0,1] neg_lo:[0,1,0]
    v_pk_fma_f32 v[148:149], v[114:115], v[132:133], v[148:149] op_sel:[1,1,0] op_sel_hi:[1,0,1] neg_lo:[0,1,0]
    v_pk_fma_f32 v[60:61], v[26:27], v[42:43], v[60:61] op_sel:[1,1,0] op_sel_hi:[1,0,1] neg_lo:[0,1,0]
    v_pk_fma_f32 v[150:151], v[116:117], v[132:133], v[150:151] op_sel:[1,1,0] op_sel_hi:[1,0,1] neg_lo:[0,1,0]
    v_pk_fma_f32 v[62:63], v[28:29], v[42:43], v[62:63] op_sel:[1,1,0] op_sel_hi:[1,0,1] neg_lo:[0,1,0]
    v_pk_fma_f32 v[152:153], v[118:119], v[132:133], v[152:153] op_sel:[1,1,0] op_sel_hi:[1,0,1] neg_lo:[0,1,0]
    v_cvt_pk_f16_f32 v194, v40, v41
    v_cvt_pk_f16_f32 v195, v130, v131
    ds_write_b64 v6, v[194:195] offset:19008
    v_pk_fma_f32 v[64:65], v[30:31], v[42:43], v[64:65] op_sel:[1,1,0] op_sel_hi:[1,0,1] neg_lo:[0,1,0]
    v_pk_fma_f32 v[154:155], v[120:121], v[132:133], v[154:155] op_sel:[1,1,0] op_sel_hi:[1,0,1] neg_lo:[0,1,0]
    v_pk_fma_f32 v[66:67], v[32:33], v[42:43], v[66:67] op_sel:[1,1,0] op_sel_hi:[1,0,1] neg_lo:[0,1,0]
    v_pk_fma_f32 v[156:157], v[122:123], v[132:133], v[156:157] op_sel:[1,1,0] op_sel_hi:[1,0,1] neg_lo:[0,1,0]
    v_pk_fma_f32 v[68:69], v[34:35], v[42:43], v[68:69] op_sel:[1,1,0] op_sel_hi:[1,0,1] neg_lo:[0,1,0]
    v_pk_fma_f32 v[158:159], v[124:125], v[132:133], v[158:159] op_sel:[1,1,0] op_sel_hi:[1,0,1] neg_lo:[0,1,0]
    v_pk_fma_f32 v[70:71], v[36:37], v[42:43], v[70:71] op_sel:[1,1,0] op_sel_hi:[1,0,1] neg_lo:[0,1,0]
    v_pk_fma_f32 v[160:161], v[126:127], v[132:133], v[160:161] op_sel:[1,1,0] op_sel_hi:[1,0,1] neg_lo:[0,1,0]
    v_cvt_pk_f16_f32 v196, v42, v43
    v_cvt_pk_f16_f32 v197, v132, v133
    ds_write_b64 v6, v[196:197] offset:19536
    v_pk_fma_f32 v[72:73], v[38:39], v[42:43], v[72:73] op_sel:[1,1,0] op_sel_hi:[1,0,1] neg_lo:[0,1,0]
    v_pk_fma_f32 v[162:163], v[128:129], v[132:133], v[162:163] op_sel:[1,1,0] op_sel_hi:[1,0,1] neg_lo:[0,1,0]
    v_pk_fma_f32 v[74:75], v[40:41], v[42:43], v[74:75] op_sel:[1,1,0] op_sel_hi:[1,0,1] neg_lo:[0,1,0]
    v_pk_fma_f32 v[164:165], v[130:131], v[132:133], v[164:165] op_sel:[1,1,0] op_sel_hi:[1,0,1] neg_lo:[0,1,0]
    v_pk_mul_f32 v[12:13], v[248:249], v[76:77] op_sel:[0,0] op_sel_hi:[0,1]
    v_pk_mul_f32 v[102:103], v[252:253], v[166:167] op_sel:[0,0] op_sel_hi:[0,1]
    v_cvt_pk_f16_f32 v198, v46, v47
    v_cvt_pk_f16_f32 v199, v136, v137
    ds_write_b64 v6, v[198:199] offset:20064
    v_pk_mul_f32 v[14:15], v[248:249], v[78:79] op_sel:[0,0] op_sel_hi:[0,1]
    v_pk_mul_f32 v[104:105], v[252:253], v[168:169] op_sel:[0,0] op_sel_hi:[0,1]
    v_pk_mul_f32 v[18:19], v[248:249], v[80:81] op_sel:[0,0] op_sel_hi:[0,1]
    v_pk_mul_f32 v[108:109], v[252:253], v[170:171] op_sel:[0,0] op_sel_hi:[0,1]
    v_cvt_pk_f16_f32 v188, v48, v49
    v_cvt_pk_f16_f32 v189, v138, v139
    ds_write_b64 v6, v[188:189] offset:20592
    v_pk_mul_f32 v[26:27], v[248:249], v[82:83] op_sel:[0,0] op_sel_hi:[0,1]
    v_pk_mul_f32 v[116:117], v[252:253], v[172:173] op_sel:[0,0] op_sel_hi:[0,1]
    v_pk_mul_f32 v[34:35], v[248:249], v[84:85] op_sel:[0,0] op_sel_hi:[0,1]
    v_pk_mul_f32 v[124:125], v[252:253], v[174:175] op_sel:[0,0] op_sel_hi:[0,1]
    v_cvt_pk_f16_f32 v190, v50, v51
    v_cvt_pk_f16_f32 v191, v140, v141
    ds_write_b64 v6, v[190:191] offset:21120
    v_pk_mul_f32 v[42:43], v[248:249], v[86:87] op_sel:[0,0] op_sel_hi:[0,1]
    v_pk_mul_f32 v[132:133], v[252:253], v[176:177] op_sel:[0,0] op_sel_hi:[0,1]
    v_pk_mul_f32 v[96:97], v[248:249], v[88:89] op_sel:[0,0] op_sel_hi:[0,1]
    v_pk_mul_f32 v[186:187], v[252:253], v[178:179] op_sel:[0,0] op_sel_hi:[0,1]
    v_cvt_pk_f16_f32 v192, v52, v53
    v_cvt_pk_f16_f32 v193, v142, v143
    ds_write_b64 v6, v[192:193] offset:21648
    v_pk_fma_f32 v[12:13], v[248:249], v[76:77], v[12:13] op_sel:[1,1,0] op_sel_hi:[1,0,1] neg_lo:[0,1,0]
    v_pk_fma_f32 v[102:103], v[252:253], v[166:167], v[102:103] op_sel:[1,1,0] op_sel_hi:[1,0,1] neg_lo:[0,1,0]
    v_pk_fma_f32 v[14:15], v[248:249], v[78:79], v[14:15] op_sel:[1,1,0] op_sel_hi:[1,0,1] neg_lo:[0,1,0]
    v_pk_fma_f32 v[104:105], v[252:253], v[168:169], v[104:105] op_sel:[1,1,0] op_sel_hi:[1,0,1] neg_lo:[0,1,0]
    v_cvt_pk_f16_f32 v194, v54, v55
    v_cvt_pk_f16_f32 v195, v144, v145
    ds_write_b64 v6, v[194:195] offset:22176
    v_pk_fma_f32 v[18:19], v[248:249], v[80:81], v[18:19] op_sel:[1,1,0] op_sel_hi:[1,0,1] neg_lo:[0,1,0]
    v_pk_fma_f32 v[108:109], v[252:253], v[170:171], v[108:109] op_sel:[1,1,0] op_sel_hi:[1,0,1] neg_lo:[0,1,0]
    v_pk_fma_f32 v[26:27], v[248:249], v[82:83], v[26:27] op_sel:[1,1,0] op_sel_hi:[1,0,1] neg_lo:[0,1,0]
    v_pk_fma_f32 v[116:117], v[252:253], v[172:173], v[116:117] op_sel:[1,1,0] op_sel_hi:[1,0,1] neg_lo:[0,1,0]
    v_cvt_pk_f16_f32 v196, v56, v57
    v_cvt_pk_f16_f32 v197, v146, v147
    ds_write_b64 v6, v[196:197] offset:22704
    v_pk_fma_f32 v[34:35], v[248:249], v[84:85], v[34:35] op_sel:[1,1,0] op_sel_hi:[1,0,1] neg_lo:[0,1,0]
    v_pk_fma_f32 v[124:125], v[252:253], v[174:175], v[124:125] op_sel:[1,1,0] op_sel_hi:[1,0,1] neg_lo:[0,1,0]
    v_pk_fma_f32 v[42:43], v[248:249], v[86:87], v[42:43] op_sel:[1,1,0] op_sel_hi:[1,0,1] neg_lo:[0,1,0]
    v_pk_fma_f32 v[132:133], v[252:253], v[176:177], v[132:133] op_sel:[1,1,0] op_sel_hi:[1,0,1] neg_lo:[0,1,0]
    v_cvt_pk_f16_f32 v198, v58, v59
    v_cvt_pk_f16_f32 v199, v148, v149
    ds_write_b64 v6, v[198:199] offset:23232
    v_pk_fma_f32 v[96:97], v[248:249], v[88:89], v[96:97] op_sel:[1,1,0] op_sel_hi:[1,0,1] neg_lo:[0,1,0]
    v_pk_fma_f32 v[186:187], v[252:253], v[178:179], v[186:187] op_sel:[1,1,0] op_sel_hi:[1,0,1] neg_lo:[0,1,0]
    v_pk_mul_f32 v[16:17], v[12:13], v[78:79] op_sel:[0,0] op_sel_hi:[0,1]
    v_pk_mul_f32 v[106:107], v[102:103], v[168:169] op_sel:[0,0] op_sel_hi:[0,1]
    v_cvt_pk_f16_f32 v188, v60, v61
    v_cvt_pk_f16_f32 v189, v150, v151
    ds_write_b64 v6, v[188:189] offset:23760
    v_pk_mul_f32 v[20:21], v[12:13], v[80:81] op_sel:[0,0] op_sel_hi:[0,1]
    v_pk_mul_f32 v[110:111], v[102:103], v[170:171] op_sel:[0,0] op_sel_hi:[0,1]
    v_pk_mul_f32 v[22:23], v[14:15], v[80:81] op_sel:[0,0] op_sel_hi:[0,1]
    v_pk_mul_f32 v[112:113], v[104:105], v[170:171] op_sel:[0,0] op_sel_hi:[0,1]
    v_cvt_pk_f16_f32 v190, v62, v63
    v_cvt_pk_f16_f32 v191, v152, v153
    ds_write_b64 v6, v[190:191] offset:24288
    v_pk_mul_f32 v[28:29], v[14:15], v[82:83] op_sel:[0,0] op_sel_hi:[0,1]
    v_pk_mul_f32 v[118:119], v[104:105], v[172:173] op_sel:[0,0] op_sel_hi:[0,1]
    v_pk_mul_f32 v[30:31], v[18:19], v[82:83] op_sel:[0,0] op_sel_hi:[0,1]
    v_pk_mul_f32 v[120:121], v[108:109], v[172:173] op_sel:[0,0] op_sel_hi:[0,1]
    v_pk_mul_f32 v[36:37], v[18:19], v[84:85] op_sel:[0,0] op_sel_hi:[0,1]
    v_cvt_pk_f16_f32 v192, v64, v65
    v_cvt_pk_f16_f32 v193, v154, v155
    ds_write_b64 v6, v[192:193] offset:24816
    v_pk_mul_f32 v[126:127], v[108:109], v[174:175] op_sel:[0,0] op_sel_hi:[0,1]
    v_pk_mul_f32 v[38:39], v[26:27], v[84:85] op_sel:[0,0] op_sel_hi:[0,1]
    v_pk_mul_f32 v[128:129], v[116:117], v[174:175] op_sel:[0,0] op_sel_hi:[0,1]
    v_pk_mul_f32 v[90:91], v[26:27], v[86:87] op_sel:[0,0] op_sel_hi:[0,1]
    v_cvt_pk_f16_f32 v194, v66, v67
    v_cvt_pk_f16_f32 v195, v156, v157
    ds_write_b64 v6, v[194:195] offset:25344
    v_pk_mul_f32 v[180:181], v[116:117], v[176:177] op_sel:[0,0] op_sel_hi:[0,1]
    v_pk_mul_f32 v[92:93], v[34:35], v[86:87] op_sel:[0,0] op_sel_hi:[0,1]
    v_pk_mul_f32 v[182:183], v[124:125], v[176:177] op_sel:[0,0] op_sel_hi:[0,1]
    v_pk_fma_f32 v[16:17], v[12:13], v[78:79], v[16:17] op_sel:[1,1,0] op_sel_hi:[1,0,1] neg_lo:[0,1,0]
    v_pk_fma_f32 v[106:107], v[102:103], v[168:169], v[106:107] op_sel:[1,1,0] op_sel_hi:[1,0,1] neg_lo:[0,1,0]
    v_cvt_pk_f16_f32 v196, v68, v69
    v_cvt_pk_f16_f32 v197, v158, v159
    ds_write_b64 v6, v[196:197] offset:25872
    v_pk_fma_f32 v[20:21], v[12:13], v[80:81], v[20:21] op_sel:[1,1,0] op_sel_hi:[1,0,1] neg_lo:[0,1,0]
    v_pk_fma_f32 v[110:111], v[102:103], v[170:171], v[110:111] op_sel:[1,1,0] op_sel_hi:[1,0,1] neg_lo:[0,1,0]
    v_pk_fma_f32 v[22:23], v[14:15], v[80:81], v[22:23] op_sel:[1,1,0] op_sel_hi:[1,0,1] neg_lo:[0,1,0]
    v_pk_fma_f32 v[112:113], v[104:105], v[170:171], v[112:113] op_sel:[1,1,0] op_sel_hi:[1,0,1] neg_lo:[0,1,0]
    v_cvt_pk_f16_f32 v198, v70, v71
    v_cvt_pk_f16_f32 v199, v160, v161
    ds_write_b64 v6, v[198:199] offset:26400
    v_pk_fma_f32 v[28:29], v[14:15], v[82:83], v[28:29] op_sel:[1,1,0] op_sel_hi:[1,0,1] neg_lo:[0,1,0]
    v_pk_fma_f32 v[118:119], v[104:105], v[172:173], v[118:119] op_sel:[1,1,0] op_sel_hi:[1,0,1] neg_lo:[0,1,0]
    v_pk_fma_f32 v[30:31], v[18:19], v[82:83], v[30:31] op_sel:[1,1,0] op_sel_hi:[1,0,1] neg_lo:[0,1,0]
    v_pk_fma_f32 v[120:121], v[108:109], v[172:173], v[120:121] op_sel:[1,1,0] op_sel_hi:[1,0,1] neg_lo:[0,1,0]
    v_pk_fma_f32 v[36:37], v[18:19], v[84:85], v[36:37] op_sel:[1,1,0] op_sel_hi:[1,0,1] neg_lo:[0,1,0]
    v_cvt_pk_f16_f32 v188, v72, v73
    v_cvt_pk_f16_f32 v189, v162, v163
    ds_write_b64 v6, v[188:189] offset:26928
    v_pk_fma_f32 v[126:127], v[108:109], v[174:175], v[126:127] op_sel:[1,1,0] op_sel_hi:[1,0,1] neg_lo:[0,1,0]
    v_pk_fma_f32 v[38:39], v[26:27], v[84:85], v[38:39] op_sel:[1,1,0] op_sel_hi:[1,0,1] neg_lo:[0,1,0]
    v_pk_fma_f32 v[128:129], v[116:117], v[174:175], v[128:129] op_sel:[1,1,0] op_sel_hi:[1,0,1] neg_lo:[0,1,0]
    v_pk_fma_f32 v[90:91], v[26:27], v[86:87], v[90:91] op_sel:[1,1,0] op_sel_hi:[1,0,1] neg_lo:[0,1,0]
    v_cvt_pk_f16_f32 v190, v74, v75
    v_cvt_pk_f16_f32 v191, v164, v165
    ds_write_b64 v6, v[190:191] offset:27456
    v_pk_fma_f32 v[180:181], v[116:117], v[176:177], v[180:181] op_sel:[1,1,0] op_sel_hi:[1,0,1] neg_lo:[0,1,0]
    v_pk_fma_f32 v[92:93], v[34:35], v[86:87], v[92:93] op_sel:[1,1,0] op_sel_hi:[1,0,1] neg_lo:[0,1,0]
    v_pk_fma_f32 v[182:183], v[124:125], v[176:177], v[182:183] op_sel:[1,1,0] op_sel_hi:[1,0,1] neg_lo:[0,1,0]
    v_pk_mul_f32 v[24:25], v[16:17], v[80:81] op_sel:[0,0] op_sel_hi:[0,1]
    v_cvt_pk_f16_f32 v192, v12, -v13
    v_cvt_pk_f16_f32 v193, v102, -v103
    ds_write_b64 v6, v[192:193] offset:528
    v_pk_mul_f32 v[114:115], v[106:107], v[170:171] op_sel:[0,0] op_sel_hi:[0,1]
    v_pk_mul_f32 v[32:33], v[22:23], v[82:83] op_sel:[0,0] op_sel_hi:[0,1]
    v_cvt_pk_f16_f32 v194, v14, -v15
    v_cvt_pk_f16_f32 v195, v104, -v105
    ds_write_b64 v6, v[194:195] offset:1056
    v_pk_mul_f32 v[122:123], v[112:113], v[172:173] op_sel:[0,0] op_sel_hi:[0,1]
    v_pk_mul_f32 v[40:41], v[30:31], v[84:85] op_sel:[0,0] op_sel_hi:[0,1]
    v_cvt_pk_f16_f32 v196, v18, -v19
    v_cvt_pk_f16_f32 v197, v108, -v109
    ds_write_b64 v6, v[196:197] offset:2112
    v_pk_mul_f32 v[130:131], v[120:121], v[174:175] op_sel:[0,0] op_sel_hi:[0,1]
    v_pk_mul_f32 v[94:95], v[38:39], v[86:87] op_sel:[0,0] op_sel_hi:[0,1]
    v_pk_mul_f32 v[184:185], v[128:129], v[176:177] op_sel:[0,0] op_sel_hi:[0,1]
    v_cvt_pk_f16_f32 v198, v26, -v27
    v_cvt_pk_f16_f32 v199, v116, -v117
    ds_write_b64 v6, v[198:199] offset:4224
    v_pk_fma_f32 v[24:25], v[16:17], v[80:81], v[24:25] op_sel:[1,1,0] op_sel_hi:[1,0,1] neg_lo:[0,1,0]
    v_pk_fma_f32 v[114:115], v[106:107], v[170:171], v[114:115] op_sel:[1,1,0] op_sel_hi:[1,0,1] neg_lo:[0,1,0]
    v_cvt_pk_f16_f32 v188, v34, -v35
    v_cvt_pk_f16_f32 v189, v124, -v125
    ds_write_b64 v6, v[188:189] offset:6336
    v_pk_fma_f32 v[32:33], v[22:23], v[82:83], v[32:33] op_sel:[1,1,0] op_sel_hi:[1,0,1] neg_lo:[0,1,0]
    v_pk_fma_f32 v[122:123], v[112:113], v[172:173], v[122:123] op_sel:[1,1,0] op_sel_hi:[1,0,1] neg_lo:[0,1,0]
    v_cvt_pk_f16_f32 v190, v42, -v43
    v_cvt_pk_f16_f32 v191, v132, -v133
    ds_write_b64 v6, v[190:191] offset:8448
    v_pk_fma_f32 v[40:41], v[30:31], v[84:85], v[40:41] op_sel:[1,1,0] op_sel_hi:[1,0,1] neg_lo:[0,1,0]
    v_pk_fma_f32 v[130:131], v[120:121], v[174:175], v[130:131] op_sel:[1,1,0] op_sel_hi:[1,0,1] neg_lo:[0,1,0]
    v_cvt_pk_f16_f32 v192, v96, -v97
    v_cvt_pk_f16_f32 v193, v186, -v187
    ds_write_b64 v6, v[192:193] offset:10560
    v_pk_fma_f32 v[94:95], v[38:39], v[86:87], v[94:95] op_sel:[1,1,0] op_sel_hi:[1,0,1] neg_lo:[0,1,0]
    v_pk_fma_f32 v[184:185], v[128:129], v[176:177], v[184:185] op_sel:[1,1,0] op_sel_hi:[1,0,1] neg_lo:[0,1,0]
    v_cvt_pk_f16_f32 v194, v16, -v17
    v_cvt_pk_f16_f32 v195, v106, -v107
    ds_write_b64 v6, v[194:195] offset:1584
    v_cvt_pk_f16_f32 v196, v20, -v21
    v_cvt_pk_f16_f32 v197, v110, -v111
    ds_write_b64 v6, v[196:197] offset:2640
    v_cvt_pk_f16_f32 v198, v22, -v23
    v_cvt_pk_f16_f32 v199, v112, -v113
    ds_write_b64 v6, v[198:199] offset:3168
    v_cvt_pk_f16_f32 v188, v28, -v29
    v_cvt_pk_f16_f32 v189, v118, -v119
    ds_write_b64 v6, v[188:189] offset:4752
    v_cvt_pk_f16_f32 v190, v30, -v31
    v_cvt_pk_f16_f32 v191, v120, -v121
    ds_write_b64 v6, v[190:191] offset:5280
    v_cvt_pk_f16_f32 v192, v36, -v37
    v_cvt_pk_f16_f32 v193, v126, -v127
    ds_write_b64 v6, v[192:193] offset:6864
    v_cvt_pk_f16_f32 v194, v38, -v39
    v_cvt_pk_f16_f32 v195, v128, -v129
    ds_write_b64 v6, v[194:195] offset:7392
    v_cvt_pk_f16_f32 v196, v90, -v91
    v_cvt_pk_f16_f32 v197, v180, -v181
    ds_write_b64 v6, v[196:197] offset:8976
    v_cvt_pk_f16_f32 v198, v92, -v93
    v_cvt_pk_f16_f32 v199, v182, -v183
    ds_write_b64 v6, v[198:199] offset:9504
    v_cvt_pk_f16_f32 v188, v24, -v25
    v_cvt_pk_f16_f32 v189, v114, -v115
    ds_write_b64 v6, v[188:189] offset:3696
    v_cvt_pk_f16_f32 v190, v32, -v33
    v_cvt_pk_f16_f32 v191, v122, -v123
    ds_write_b64 v6, v[190:191] offset:5808
    v_cvt_pk_f16_f32 v192, v40, -v41
    v_cvt_pk_f16_f32 v193, v130, -v131
    ds_write_b64 v6, v[192:193] offset:7920
    v_cvt_pk_f16_f32 v194, v94, -v95
    v_cvt_pk_f16_f32 v195, v184, -v185
    ds_write_b64 v6, v[194:195] offset:10032
    v_and_b32 v2, 31, v1
    v_lshrrev_b32 v3, 5, v1
    v_mul_u32_u24 v4, 528, v2
    v_lshl_add_u32 v4, v3, 4, v4
    v_add_u32 v4, s60, v4
    ds_read_b128 v[32:35], v4 offset:0
    ds_read_b128 v[36:39], v4 offset:11088
    ds_read_b128 v[40:43], v4 offset:32
    ds_read_b128 v[44:47], v4 offset:11120
    ds_read_b128 v[48:51], v4 offset:64
    ds_read_b128 v[52:55], v4 offset:11152
    ds_read_b128 v[56:59], v4 offset:96
    ds_read_b128 v[60:63], v4 offset:11184
    ds_read_b128 v[64:67], v4 offset:128
    ds_read_b128 v[68:71], v4 offset:11216
    ds_read_b128 v[72:75], v4 offset:160
    ds_read_b128 v[76:79], v4 offset:11248
    ds_read_b128 v[80:83], v4 offset:192
    ds_read_b128 v[84:87], v4 offset:11280
    s_waitcnt lgkmcnt(12)
    v_mfma_f32_32x32x16_f16 v[8:23], v[32:35], v[36:39], 0
    ds_read_b128 v[88:91], v4 offset:224
    ds_read_b128 v[92:95], v4 offset:11312
    s_waitcnt lgkmcnt(12)
    v_mfma_f32_32x32x16_f16 v[8:23], v[40:43], v[44:47], v[8:23]
    ds_read_b128 v[96:99], v4 offset:256
    ds_read_b128 v[100:103], v4 offset:11344
    s_waitcnt lgkmcnt(12)
    v_mfma_f32_32x32x16_f16 v[8:23], v[48:51], v[52:55], v[8:23]
    ds_read_b128 v[104:107], v4 offset:288
    ds_read_b128 v[108:111], v4 offset:11376
    s_waitcnt lgkmcnt(12)
    v_mfma_f32_32x32x16_f16 v[8:23], v[56:59], v[60:63], v[8:23]
    ds_read_b128 v[112:115], v4 offset:320
    ds_read_b128 v[116:119], v4 offset:11408
    s_waitcnt lgkmcnt(12)
    v_mfma_f32_32x32x16_f16 v[8:23], v[64:67], v[68:71], v[8:23]
    ds_read_b128 v[120:123], v4 offset:352
    ds_read_b128 v[124:127], v4 offset:11440
    s_waitcnt lgkmcnt(12)
    v_mfma_f32_32x32x16_f16 v[8:23], v[72:75], v[76:79], v[8:23]
    ds_read_b128 v[128:131], v4 offset:384
    ds_read_b128 v[132:135], v4 offset:11472
    s_waitcnt lgkmcnt(12)
    v_mfma_f32_32x32x16_f16 v[8:23], v[80:83], v[84:87], v[8:23]
    ds_read_b128 v[136:139], v4 offset:416
    ds_read_b128 v[140:143], v4 offset:11504
    s_waitcnt lgkmcnt(12)
    v_mfma_f32_32x32x16_f16 v[8:23], v[88:91], v[92:95], v[8:23]
    ds_read_b128 v[144:147], v4 offset:448
    ds_read_b128 v[148:151], v4 offset:11536
    s_waitcnt lgkmcnt(12)
    v_mfma_f32_32x32x16_f16 v[8:23], v[96:99], v[100:103], v[8:23]
    ds_read_b128 v[152:155], v4 offset:480
    ds_read_b128 v[156:159], v4 offset:11568
    s_waitcnt lgkmcnt(12)
    v_mfma_f32_32x32x16_f16 v[8:23], v[104:107], v[108:111], v[8:23]
    s_mul_i32 s55, s3, 18560
    s_add_u32 s55, s55, 98144
    v_lshlrev_b32 v5, 4, v2
    v_sub_u32 v5, s55, v5
    v_lshlrev_b32 v6, 3, v3
    v_sub_u32 v6, v5, v6
    v_lshl_add_u32 v7, v1, 4, s55
    v_mov_b32 v164, 0
    v_mov_b32 v165, 0
    v_mov_b32 v166, 0
    v_mov_b32 v167, 0
    s_waitcnt lgkmcnt(10)
    v_mfma_f32_32x32x16_f16 v[8:23], v[112:115], v[116:119], v[8:23]
    s_waitcnt lgkmcnt(8)
    v_mfma_f32_32x32x16_f16 v[8:23], v[120:123], v[124:127], v[8:23]
    s_waitcnt lgkmcnt(6)
    v_mfma_f32_32x32x16_f16 v[8:23], v[128:131], v[132:135], v[8:23]
    s_waitcnt lgkmcnt(4)
    v_mfma_f32_32x32x16_f16 v[8:23], v[136:139], v[140:143], v[8:23]
    s_waitcnt lgkmcnt(2)
    v_mfma_f32_32x32x16_f16 v[8:23], v[144:147], v[148:151], v[8:23]
    s_waitcnt lgkmcnt(0)
    v_mfma_f32_32x32x16_f16 v[8:23], v[152:155], v[156:159], v[8:23]
    v_cmp_gt_u32 vcc, 34, v1
    s_nop 0
    s_and_saveexec_b64 s[62:63], vcc
    ds_write_b128 v7, v[164:167] offset:4096
    s_mov_b64 exec, -1
    v_min_u32 v168, 23, v1
    v_lshl_add_u32 v168, v168, 4, s55
    v_add_u32 v168, 4096, v168
    v_subrev_u32 v169, 13920, v7
    v_subrev_u32 v170, 13920, v168
    s_nop 1
    v_cvt_pk_f16_f32 v24, v16, v16
    v_cvt_pk_f16_f32 v25, v16, v16
    v_cvt_pk_f16_f32 v26, v17, v17
    v_cvt_pk_f16_f32 v27, v17, v17
    v_cvt_pk_f16_f32 v28, v18, v18
    v_cvt_pk_f16_f32 v29, v18, v18
    v_cvt_pk_f16_f32 v30, v19, v19
    v_cvt_pk_f16_f32 v31, v19, v19
    v_cvt_pk_f16_f32 v32, v13, v13
    v_cvt_pk_f16_f32 v34, v13, v12
    v_cvt_pk_f16_f32 v35, v12, v12
    v_cvt_pk_f16_f32 v36, v15, v15
    v_cvt_pk_f16_f32 v38, v15, v14
    v_cvt_pk_f16_f32 v39, v14, v14
    v_cvt_pk_f16_f32 v40, v14, v13
    v_cvt_pk_f16_f32 v41, v12, v12
    v_cvt_pk_f16_f32 v42, v11, v10
    v_cvt_pk_f16_f32 v43, v9, v8
    s_mov_b32 exec_hi, 0
    ds_write_b64 v5, v[24:25] offset:2040
    ds_write_b64 v5, v[24:25] offset:2048
    ds_write_b64 v5, v[26:27] offset:1528
    ds_write_b64 v5, v[26:27] offset:1536
    ds_write_b64 v5, v[28:29] offset:1016
    ds_write_b64 v5, v[28:29] offset:1024
    ds_write_b64 v5, v[30:31] offset:504
    ds_write_b64 v5, v[30:31] offset:512
    s_mov_b32 exec_lo, 0x55555555
    ds_write_b16 v5, v24 offset:2038
    ds_write_b16 v5, v26 offset:1526
    ds_write_b16 v5, v28 offset:1014
    ds_write_b16 v5, v30 offset:502
    s_mov_b32 exec_lo, 0
    s_mov_b32 exec_hi, 1
    ds_write_b64 v5, v[24:25]
    s_mov_b32 exec_hi, -1
    ds_write_b32 v5, v32 offset:3060
    ds_write_b64 v5, v[34:35] offset:3064
    ds_write_b32 v5, v35 offset:3072
    ds_write_b32 v5, v36 offset:2548
    ds_write_b64 v5, v[38:39] offset:2552
    ds_write_b32 v5, v39 offset:2560
    s_mov_b32 exec_lo, -1
    s_mov_b32 exec_hi, 0
    ds_write_b16 v5, v36 offset:3570
    ds_write_b32 v5, v39 offset:3572
    ds_write_b64 v5, v[40:41] offset:3576
    ds_write_b16 v5, v35 offset:3584
    s_mov_b64 exec, -1
    ds_write_b64 v6, v[42:43] offset:4088
    ds_read_b128 v[44:47], v7 offset:0
    ds_read_b64 v[48:49], v7 offset:16
    ds_read_b128 v[68:71], v7 offset:1024
    ds_read_b64 v[72:73], v7 offset:1040
    ds_read_b128 v[92:95], v7 offset:2048
    ds_read_b64 v[96:97], v7 offset:2064
    ds_read_b128 v[116:119], v7 offset:3072
    ds_read_b64 v[120:121], v7 offset:3088
    ds_read_b128 v[140:143], v168
    ds_read_b64 v[144:145], v168 offset:16
    s_waitcnt lgkmcnt(8)
    v_alignbit_b32 v52, v45, v44, 16
    v_alignbit_b32 v53, v46, v45, 16
    v_alignbit_b32 v54, v47, v46, 16
    v_alignbit_b32 v55, v48, v47, 16
    ds_write_b128 v169, v[52:55] offset:9280
    v_mov_b32 v56, v45
    v_mov_b32 v57, v46
    v_mov_b32 v58, v47
    v_mov_b32 v59, v48
    ds_write_b128 v169, v[56:59] offset:4640
    v_alignbit_b32 v60, v46, v45, 16
    v_alignbit_b32 v61, v47, v46, 16
    v_alignbit_b32 v62, v48, v47, 16
    v_alignbit_b32 v63, v49, v48, 16
    ds_write_b128 v169, v[60:63] offset:0
    s_waitcnt lgkmcnt(9)
    v_alignbit_b32 v76, v69, v68, 16
    v_alignbit_b32 v77, v70, v69, 16
    v_alignbit_b32 v78, v71, v70, 16
    v_alignbit_b32 v79, v72, v71, 16
    ds_write_b128 v169, v[76:79] offset:10304
    v_mov_b32 v80, v69
    v_mov_b32 v81, v70
    v_mov_b32 v82, v71
    v_mov_b32 v83, v72
    ds_write_b128 v169, v[80:83] offset:5664
    v_alignbit_b32 v84, v70, v69, 16
    v_alignbit_b32 v85, v71, v70, 16
    v_alignbit_b32 v86, v72, v71, 16
    v_alignbit_b32 v87, v73, v72, 16
    ds_write_b128 v169, v[84:87] offset:1024
    s_waitcnt lgkmcnt(10)
    v_alignbit_b32 v100, v93, v92, 16
    v_alignbit_b32 v101, v94, v93, 16
    v_alignbit_b32 v102, v95, v94, 16
    v_alignbit_b32 v103, v96, v95, 16
    ds_write_b128 v169, v[100:103] offset:11328
    v_mov_b32 v104, v93
    v_mov_b32 v105, v94
    v_mov_b32 v106, v95
    v_mov_b32 v107, v96
    ds_write_b128 v169, v[104:107] offset:6688
    v_alignbit_b32 v108, v94, v93, 16
    v_alignbit_b32 v109, v95, v94, 16
    v_alignbit_b32 v110, v96, v95, 16
    v_alignbit_b32 v111, v97, v96, 16
    ds_write_b128 v169, v[108:111] offset:2048
    s_waitcnt lgkmcnt(11)
    v_alignbit_b32 v124, v117, v116, 16
    v_alignbit_b32 v125, v118, v117, 16
    v_alignbit_b32 v126, v119, v118, 16
    v_alignbit_b32 v127, v120, v119, 16
    ds_write_b128 v169, v[124:127] offset:12352
    v_mov_b32 v128, v117
    v_mov_b32 v129, v118
    v_mov_b32 v130, v119
    v_mov_b32 v131, v120
    ds_write_b128 v169, v[128:131] offset:7712
    v_alignbit_b32 v132, v118, v117, 16
    v_alignbit_b32 v133, v119, v118, 16
    v_alignbit_b32 v134, v120, v119, 16
    v_alignbit_b32 v135, v121, v120, 16
    ds_write_b128 v169, v[132:135] offset:3072
    s_waitcnt lgkmcnt(12)
    v_alignbit_b32 v148, v141, v140, 16
    v_alignbit_b32 v149, v142, v141, 16
    v_alignbit_b32 v150, v143, v142, 16
    v_alignbit_b32 v151, v144, v143, 16
    ds_write_b128 v170, v[148:151] offset:9280
    v_mov_b32 v152, v141
    v_mov_b32 v153, v142
    v_mov_b32 v154, v143
    v_mov_b32 v155, v144
    ds_write_b128 v170, v[152:155] offset:4640
    v_alignbit_b32 v156, v142, v141, 16
    v_alignbit_b32 v157, v143, v142, 16
    v_alignbit_b32 v158, v144, v143, 16
    v_alignbit_b32 v159, v145, v144, 16
    ds_write_b128 v170, v[156:159] offset:0
    s_branch L_kdone_4
L_w3_3:
    s_lshl_b32 s54, s6, 7
    s_lshl_b32 s55, s3, 2
    s_add_u32 s54, s54, s55
    v_mov_b32 v2, s54
    v_mov_b32 v3, s10
    s_waitcnt vmcnt(0)
    s_mov_b64 exec, 1
    global_store_dword v2, v3, s[52:53] sc1
    s_mov_b64 exec, -1
    global_load_dword v254, v231, s[32:33]
    v_add_u32 v231, 884736, v231
    s_lshl_b32 s54, s7, 4
    v_add_u32 v7, 0, v1
    v_mul_u32_u24 v8, 21846, v7
    v_lshrrev_b32 v8, 16, v8
    v_mul_u32_u24 v9, 3, v8
    v_sub_u32 v9, v7, v9
    v_mul_u32_u24 v100, 10240, v8
    v_lshl_add_u32 v100, v9, 4, v100
    v_add_u32 v100, s54, v100
    v_mul_u32_u24 v9, 4224, v9
    v_lshl_add_u32 v112, v8, 4, v9
    v_add_u32 v112, 140032, v112
    v_add_u32 v7, 64, v1
    v_mul_u32_u24 v8, 21846, v7
    v_lshrrev_b32 v8, 16, v8
    v_mul_u32_u24 v9, 3, v8
    v_sub_u32 v9, v7, v9
    v_mul_u32_u24 v101, 10240, v8
    v_lshl_add_u32 v101, v9, 4, v101
    v_add_u32 v101, s54, v101
    v_mul_u32_u24 v9, 4224, v9
    v_lshl_add_u32 v113, v8, 4, v9
    v_add_u32 v113, 140032, v113
    v_add_u32 v7, 128, v1
    v_mul_u32_u24 v8, 21846, v7
    v_lshrrev_b32 v8, 16, v8
    v_mul_u32_u24 v9, 3, v8
    v_sub_u32 v9, v7, v9
    v_mul_u32_u24 v102, 10240, v8
    v_lshl_add_u32 v102, v9, 4, v102
    v_add_u32 v102, s54, v102
    v_mul_u32_u24 v9, 4224, v9
    v_lshl_add_u32 v114, v8, 4, v9
    v_add_u32 v114, 140032, v114
    v_add_u32 v7, 192, v1
    v_mul_u32_u24 v8, 21846, v7
    v_lshrrev_b32 v8, 16, v8
    v_mul_u32_u24 v9, 3, v8
    v_sub_u32 v9, v7, v9
    v_mul_u32_u24 v103, 10240, v8
    v_lshl_add_u32 v103, v9, 4, v103
    v_add_u32 v103, s54, v103
    v_mul_u32_u24 v9, 4224, v9
    v_lshl_add_u32 v115, v8, 4, v9
    v_add_u32 v115, 140032, v115
    v_add_u32 v7, 256, v1
    v_mul_u32_u24 v8, 21846, v7
    v_lshrrev_b32 v8, 16, v8
    v_mul_u32_u24 v9, 3, v8
    v_sub_u32 v9, v7, v9
    v_mul_u32_u24 v104, 10240, v8
    v_lshl_add_u32 v104, v9, 4, v104
    v_add_u32 v104, s54, v104
    v_mul_u32_u24 v9, 4224, v9
    v_lshl_add_u32 v116, v8, 4, v9
    v_add_u32 v116, 140032, v116
    v_add_u32 v7, 320, v1
    v_mul_u32_u24 v8, 21846, v7
    v_lshrrev_b32 v8, 16, v8
    v_mul_u32_u24 v9, 3, v8
    v_sub_u32 v9, v7, v9
    v_mul_u32_u24 v105, 10240, v8
    v_lshl_add_u32 v105, v9, 4, v105
    v_add_u32 v105, s54, v105
    v_mul_u32_u24 v9, 4224, v9
    v_lshl_add_u32 v117, v8, 4, v9
    v_add_u32 v117, 140032, v117
    v_add_u32 v7, 384, v1
    v_mul_u32_u24 v8, 21846, v7
    v_lshrrev_b32 v8, 16, v8
    v_mul_u32_u24 v9, 3, v8
    v_sub_u32 v9, v7, v9
    v_mul_u32_u24 v106, 10240, v8
    v_lshl_add_u32 v106, v9, 4, v106
    v_add_u32 v106, s54, v106
    v_mul_u32_u24 v9, 4224, v9
    v_lshl_add_u32 v118, v8, 4, v9
    v_add_u32 v118, 140032, v118
    v_add_u32 v7, 448, v1
    v_mul_u32_u24 v8, 21846, v7
    v_lshrrev_b32 v8, 16, v8
    v_mul_u32_u24 v9, 3, v8
    v_sub_u32 v9, v7, v9
    v_mul_u32_u24 v107, 10240, v8
    v_lshl_add_u32 v107, v9, 4, v107
    v_add_u32 v107, s54, v107
    v_mul_u32_u24 v9, 4224, v9
    v_lshl_add_u32 v119, v8, 4, v9
    v_add_u32 v119, 140032, v119
    v_add_u32 v7, 512, v1
    v_mul_u32_u24 v8, 21846, v7
    v_lshrrev_b32 v8, 16, v8
    v_mul_u32_u24 v9, 3, v8
    v_sub_u32 v9, v7, v9
    v_mul_u32_u24 v108, 10240, v8
    v_lshl_add_u32 v108, v9, 4, v108
    v_add_u32 v108, s54, v108
    v_mul_u32_u24 v9, 4224, v9
    v_lshl_add_u32 v120, v8, 4, v9
    v_add_u32 v120, 140032, v120
    v_add_u32 v7, 576, v1
    v_mul_u32_u24 v8, 21846, v7
    v_lshrrev_b32 v8, 16, v8
    v_mul_u32_u24 v9, 3, v8
    v_sub_u32 v9, v7, v9
    v_mul_u32_u24 v109, 10240, v8
    v_lshl_add_u32 v109, v9, 4, v109
    v_add_u32 v109, s54, v109
    v_mul_u32_u24 v9, 4224, v9
    v_lshl_add_u32 v121, v8, 4, v9
    v_add_u32 v121, 140032, v121
    v_add_u32 v7, 640, v1
    v_mul_u32_u24 v8, 21846, v7
    v_lshrrev_b32 v8, 16, v8
    v_mul_u32_u24 v9, 3, v8
    v_sub_u32 v9, v7, v9
    v_mul_u32_u24 v110, 10240, v8
    v_lshl_add_u32 v110, v9, 4, v110
    v_add_u32 v110, s54, v110
    v_mul_u32_u24 v9, 4224, v9
    v_lshl_add_u32 v122, v8, 4, v9
    v_add_u32 v122, 140032, v122
    v_add_u32 v7, 704, v1
    v_mul_u32_u24 v8, 21846, v7
    v_lshrrev_b32 v8, 16, v8
    v_mul_u32_u24 v9, 3, v8
    v_sub_u32 v9, v7, v9
    v_mul_u32_u24 v111, 10240, v8
    v_lshl_add_u32 v111, v9, 4, v111
    v_add_u32 v111, s54, v111
    v_mul_u32_u24 v9, 4224, v9
    v_lshl_add_u32 v123, v8, 4, v9
    v_add_u32 v123, 140032, v123
    v_lshlrev_b32 v10, 7, v1
    v_add_u32 v11, 8192, v10
    v_add_u32 v12, 16384, v10
    v_add_u32 v13, 24576, v10
    s_waitcnt vmcnt(0)
    s_sleep 8
    s_mov_b32 s69, 0
L_flpoll_5:
    global_load_dwordx4 v[16:19], v10, s[52:53] sc1
    global_load_dwordx4 v[20:23], v11, s[52:53] sc1
    global_load_dwordx4 v[24:27], v12, s[52:53] sc1
    global_load_dwordx4 v[28:31], v13, s[52:53] sc1
    s_waitcnt vmcnt(0)
    v_xor_b32 v6, s10, v16
    v_xor_b32 v7, s10, v17
    v_or_b32 v6, v6, v7
    v_xor_b32 v7, s10, v18
    v_or_b32 v6, v6, v7
    v_xor_b32 v7, s10, v19
    v_or_b32 v6, v6, v7
    v_xor_b32 v7, s10, v20
    v_or_b32 v6, v6, v7
    v_xor_b32 v7, s10, v21
    v_or_b32 v6, v6, v7
    v_xor_b32 v7, s10, v22
    v_or_b32 v6, v6, v7
    v_xor_b32 v7, s10, v23
    v_or_b32 v6, v6, v7
    v_xor_b32 v7, s10, v24
    v_or_b32 v6, v6, v7
    v_xor_b32 v7, s10, v25
    v_or_b32 v6, v6, v7
    v_xor_b32 v7, s10, v26
    v_or_b32 v6, v6, v7
    v_xor_b32 v7, s10, v27
    v_or_b32 v6, v6, v7
    v_xor_b32 v7, s10, v28
    v_or_b32 v6, v6, v7
    v_xor_b32 v7, s10, v29
    v_or_b32 v6, v6, v7
    v_xor_b32 v7, s10, v30
    v_or_b32 v6, v6, v7
    v_xor_b32 v7, s10, v31
    v_or_b32 v6, v6, v7
    v_cmp_ne_u32 vcc, 0, v6
    s_cbranch_vccz L_flok_6
    s_add_u32 s69, s69, 1
    s_cmp_gt_u32 s69, 200000
    s_cbranch_scc1 L_flok_6
    s_sleep 4
    s_branch L_flpoll_5
L_flok_6:
    global_load_dwordx4 v[32:35], v100, s[12:13] sc1
    global_load_dwordx4 v[36:39], v101, s[12:13] sc1
    global_load_dwordx4 v[40:43], v102, s[12:13] sc1
    global_load_dwordx4 v[44:47], v103, s[12:13] sc1
    global_load_dwordx4 v[48:51], v104, s[12:13] sc1
    global_load_dwordx4 v[52:55], v105, s[12:13] sc1
    global_load_dwordx4 v[56:59], v106, s[12:13] sc1
    global_load_dwordx4 v[60:63], v107, s[12:13] sc1
    global_load_dwordx4 v[64:67], v108, s[12:13] sc1
    global_load_dwordx4 v[68:71], v109, s[12:13] sc1
    global_load_dwordx4 v[72:75], v110, s[12:13] sc1
    global_load_dwordx4 v[76:79], v111, s[12:13] sc1
    v_mov_b32 v6, 0
    v_and_b32 v5, 31, v1
    v_lshlrev_b32 v5, 2, v5
    v_add_u32 v5, 139904, v5
    ds_write_b32 v5, v6 offset:0
    ds_write_b32 v5, v6 offset:4224
    ds_write_b32 v5, v6 offset:8448
    v_accvgpr_read_b32 v194, a240
    v_accvgpr_read_b32 v195, a241
    v_accvgpr_read_b32 v196, a242
    v_accvgpr_read_b32 v197, a243
    v_accvgpr_read_b32 v198, a244
    v_accvgpr_read_b32 v199, a245
    v_accvgpr_read_b32 v242, a246
    v_accvgpr_read_b32 v243, a247
    v_accvgpr_read_b32 v244, a248
    v_accvgpr_read_b32 v245, a249
    v_accvgpr_read_b32 v246, a250
    s_waitcnt vmcnt(11)
    ds_write_b128 v112, v[32:35]
    s_waitcnt vmcnt(10)
    ds_write_b128 v113, v[36:39]
    s_waitcnt vmcnt(9)
    ds_write_b128 v114, v[40:43]
    s_waitcnt vmcnt(8)
    ds_write_b128 v115, v[44:47]
    s_waitcnt vmcnt(7)
    ds_write_b128 v116, v[48:51]
    s_waitcnt vmcnt(6)
    ds_write_b128 v117, v[52:55]
    s_waitcnt vmcnt(5)
    ds_write_b128 v118, v[56:59]
    s_waitcnt vmcnt(4)
    ds_write_b128 v119, v[60:63]
    s_waitcnt vmcnt(3)
    ds_write_b128 v120, v[64:67]
    s_waitcnt vmcnt(2)
    ds_write_b128 v121, v[68:71]
    s_waitcnt vmcnt(1)
    ds_write_b128 v122, v[72:75]
    s_waitcnt vmcnt(0)
    ds_write_b128 v123, v[76:79]
    s_branch L_kd2_7
L_kdone_4:
    v_accvgpr_read_b32 v194, a240
    v_accvgpr_read_b32 v195, a241
    v_accvgpr_read_b32 v196, a242
    v_accvgpr_read_b32 v197, a243
    v_accvgpr_read_b32 v198, a244
    v_accvgpr_read_b32 v199, a245
    v_accvgpr_read_b32 v242, a246
    v_accvgpr_read_b32 v243, a247
    v_accvgpr_read_b32 v244, a248
    v_accvgpr_read_b32 v245, a249
    v_accvgpr_read_b32 v246, a250
L_kd2_7:
    s_waitcnt lgkmcnt(0)
    s_barrier
    ds_read_b128 v[64:67], v194 offset:3648
    ds_read_b64 v[96:97], v195 offset:64
    ds_read_b64 v[98:99], v195 offset:72
    ds_read_b128 v[68:71], v194 offset:3136
    ds_read_b64 v[100:101], v195 offset:576
    ds_read_b64 v[102:103], v195 offset:584
    ds_read_b128 v[72:75], v194 offset:2624
    ds_read_b64 v[104:105], v195 offset:1088
    ds_read_b64 v[106:107], v195 offset:1096
    ds_read_b128 v[76:79], v194 offset:2112
    ds_read_b64 v[108:109], v195 offset:1600
    ds_read_b64 v[110:111], v195 offset:1608
    ds_read_b128 v[80:83], v194 offset:1600
    ds_read_b64 v[112:113], v195 offset:2112
    ds_read_b64 v[114:115], v195 offset:2120
    ds_read_b128 v[84:87], v194 offset:1088
    ds_read_b64 v[116:117], v195 offset:2624
    ds_read_b64 v[118:119], v195 offset:2632
    ds_read_b128 v[88:91], v194 offset:576
    ds_read_b64 v[120:121], v195 offset:3136
    ds_read_b64 v[122:123], v195 offset:3144
    ds_read_b128 v[92:95], v194 offset:64
    ds_read_b64 v[124:125], v195 offset:3648
    ds_read_b64 v[126:127], v195 offset:3656
    ds_read_b32 v4, v244
    ds_read_b32 v6, v245
    ds_read_b32 v8, v246
    s_waitcnt lgkmcnt(0)
    v_mfma_f32_16x16x32_f16 v[44:47], v[64:67], v[124:127], 0
    ds_read_b128 v[128:131], v194 offset:3584
    v_mfma_f32_16x16x32_f16 v[40:43], v[64:67], v[120:123], 0
    s_mul_i32 s82, s3, 16384
    s_mov_b32 m0, s82
    s_add_u32 s82, s82, 4096
    global_load_lds_dwordx4 v234, s[80:81]
    global_load_lds_dwordx4 v235, s[80:81] offset:1024
    v_mfma_f32_16x16x32_f16 v[36:39], v[64:67], v[116:119], 0
    ds_read_b64 v[160:161], v195 offset:0
    v_mfma_f32_16x16x32_f16 v[32:35], v[64:67], v[112:115], 0
    v_mfma_f32_16x16x32_f16 v[28:31], v[64:67], v[108:111], 0
    ds_read_b64 v[162:163], v195 offset:8
    v_mfma_f32_16x16x32_f16 v[24:27], v[64:67], v[104:107], 0
    ds_read_b128 v[132:135], v194 offset:3072
    v_mfma_f32_16x16x32_f16 v[20:23], v[64:67], v[100:103], 0
    ds_read_b64 v[164:165], v195 offset:512
    v_mfma_f32_16x16x32_f16 v[16:19], v[64:67], v[96:99], 0
    ds_read_b64 v[166:167], v195 offset:520
    v_mfma_f32_16x16x32_f16 v[44:47], v[68:71], v[120:123], v[44:47]
    ds_read_b128 v[136:139], v194 offset:2560
    v_mfma_f32_16x16x32_f16 v[40:43], v[68:71], v[116:119], v[40:43]
    global_load_lds_dwordx4 v236, s[80:81] offset:2048
    global_load_lds_dwordx4 v237, s[80:81] offset:3072
    s_add_u32 s80, s80, 110592
    s_addc_u32 s81, s81, 0
    v_mfma_f32_16x16x32_f16 v[36:39], v[68:71], v[112:115], v[36:39]
    ds_read_b64 v[168:169], v195 offset:1024
    v_mfma_f32_16x16x32_f16 v[32:35], v[68:71], v[108:111], v[32:35]
    v_mfma_f32_16x16x32_f16 v[28:31], v[68:71], v[104:107], v[28:31]
    ds_read_b64 v[170:171], v195 offset:1032
    v_mfma_f32_16x16x32_f16 v[24:27], v[68:71], v[100:103], v[24:27]
    ds_read_b128 v[140:143], v194 offset:2048
    v_mfma_f32_16x16x32_f16 v[20:23], v[68:71], v[96:99], v[20:23]
    ds_read_b64 v[172:173], v195 offset:1536
    v_mfma_f32_16x16x32_f16 v[44:47], v[72:75], v[116:119], v[44:47]
    ds_read_b64 v[174:175], v195 offset:1544
    v_mfma_f32_16x16x32_f16 v[40:43], v[72:75], v[112:115], v[40:43]
    ds_read_b128 v[144:147], v194 offset:1536
    v_mfma_f32_16x16x32_f16 v[36:39], v[72:75], v[108:111], v[36:39]
    s_mov_b32 m0, s82
    s_add_u32 s82, s82, 4096
    global_load_lds_dwordx4 v234, s[80:81]
    global_load_lds_dwordx4 v235, s[80:81] offset:1024
    v_mfma_f32_16x16x32_f16 v[32:35], v[72:75], v[104:107], v[32:35]
    ds_read_b64 v[176:177], v195 offset:2048
    v_mfma_f32_16x16x32_f16 v[28:31], v[72:75], v[100:103], v[28:31]
    v_mfma_f32_16x16x32_f16 v[24:27], v[72:75], v[96:99], v[24:27]
    ds_read_b64 v[178:179], v195 offset:2056
    v_mfma_f32_16x16x32_f16 v[44:47], v[76:79], v[112:115], v[44:47]
    ds_read_b128 v[148:151], v194 offset:1024
    v_mfma_f32_16x16x32_f16 v[40:43], v[76:79], v[108:111], v[40:43]
    ds_read_b64 v[180:181], v195 offset:2560
    v_mfma_f32_16x16x32_f16 v[36:39], v[76:79], v[104:107], v[36:39]
    ds_read_b64 v[182:183], v195 offset:2568
    v_mfma_f32_16x16x32_f16 v[32:35], v[76:79], v[100:103], v[32:35]
    ds_read_b128 v[152:155], v194 offset:512
    v_mfma_f32_16x16x32_f16 v[28:31], v[76:79], v[96:99], v[28:31]
    global_load_lds_dwordx4 v236, s[80:81] offset:2048
    global_load_lds_dwordx4 v237, s[80:81] offset:3072
    s_add_u32 s80, s80, 110592
    s_addc_u32 s81, s81, 0
    v_mfma_f32_16x16x32_f16 v[44:47], v[80:83], v[108:111], v[44:47]
    v_mfma_f32_16x16x32_f16 v[40:43], v[80:83], v[104:107], v[40:43]
    ds_read_b64 v[184:185], v195 offset:3072
    v_mfma_f32_16x16x32_f16 v[36:39], v[80:83], v[100:103], v[36:39]
    ds_read_b64 v[186:187], v195 offset:3080
    v_mfma_f32_16x16x32_f16 v[32:35], v[80:83], v[96:99], v[32:35]
    ds_read_b128 v[156:159], v194 offset:0
    v_mfma_f32_16x16x32_f16 v[44:47], v[84:87], v[104:107], v[44:47]
    ds_read_b64 v[188:189], v195 offset:3584
    v_mfma_f32_16x16x32_f16 v[40:43], v[84:87], v[100:103], v[40:43]
    ds_read_b64 v[190:191], v195 offset:3592
    v_mfma_f32_16x16x32_f16 v[36:39], v[84:87], v[96:99], v[36:39]
    v_mfma_f32_16x16x32_f16 v[44:47], v[88:91], v[100:103], v[44:47]
    v_mfma_f32_16x16x32_f16 v[40:43], v[88:91], v[96:99], v[40:43]
    v_mfma_f32_16x16x32_f16 v[44:47], v[92:95], v[96:99], v[44:47]
    s_waitcnt lgkmcnt(0)
    v_mfma_f32_16x16x32_f16 v[44:47], v[128:131], v[188:191], v[44:47]
    ds_read_b128 v[64:67], v196 offset:3648
    v_mfma_f32_16x16x32_f16 v[40:43], v[128:131], v[184:187], v[40:43]
    s_mov_b32 m0, s82
    s_add_u32 s82, s82, 4096
    global_load_lds_dwordx4 v234, s[80:81]
    global_load_lds_dwordx4 v235, s[80:81] offset:1024
    v_mfma_f32_16x16x32_f16 v[36:39], v[128:131], v[180:183], v[36:39]
    ds_read_b64 v[96:97], v197 offset:64
    v_mfma_f32_16x16x32_f16 v[32:35], v[128:131], v[176:179], v[32:35]
    v_mfma_f32_16x16x32_f16 v[28:31], v[128:131], v[172:175], v[28:31]
    ds_read_b64 v[98:99], v197 offset:72
    v_mfma_f32_16x16x32_f16 v[24:27], v[128:131], v[168:171], v[24:27]
    ds_read_b128 v[68:71], v196 offset:3136
    v_mfma_f32_16x16x32_f16 v[20:23], v[128:131], v[164:167], v[20:23]
    ds_read_b64 v[100:101], v197 offset:576
    v_mfma_f32_16x16x32_f16 v[16:19], v[128:131], v[160:163], v[16:19]
    ds_read_b64 v[102:103], v197 offset:584
    v_mfma_f32_16x16x32_f16 v[44:47], v[132:135], v[184:187], v[44:47]
    ds_read_b128 v[72:75], v196 offset:2624
    v_mfma_f32_16x16x32_f16 v[40:43], v[132:135], v[180:183], v[40:43]
    global_load_lds_dwordx4 v236, s[80:81] offset:2048
    global_load_lds_dwordx4 v237, s[80:81] offset:3072
    s_add_u32 s80, s80, 110592
    s_addc_u32 s81, s81, 0
    v_mfma_f32_16x16x32_f16 v[36:39], v[132:135], v[176:179], v[36:39]
    ds_read_b64 v[104:105], v197 offset:1088
    v_mfma_f32_16x16x32_f16 v[32:35], v[132:135], v[172:175], v[32:35]
    v_mfma_f32_16x16x32_f16 v[28:31], v[132:135], v[168:171], v[28:31]
    ds_read_b64 v[106:107], v197 offset:1096
    v_mfma_f32_16x16x32_f16 v[24:27], v[132:135], v[164:167], v[24:27]
    ds_read_b128 v[76:79], v196 offset:2112
    v_mfma_f32_16x16x32_f16 v[20:23], v[132:135], v[160:163], v[20:23]
    ds_read_b64 v[108:109], v197 offset:1600
    v_mfma_f32_16x16x32_f16 v[44:47], v[136:139], v[180:183], v[44:47]
    ds_read_b64 v[110:111], v197 offset:1608
    v_mfma_f32_16x16x32_f16 v[40:43], v[136:139], v[176:179], v[40:43]
    ds_read_b128 v[80:83], v196 offset:1600
    v_mfma_f32_16x16x32_f16 v[36:39], v[136:139], v[172:175], v[36:39]
    s_mov_b32 m0, s82
    s_add_u32 s82, s82, 4096
    global_load_lds_dwordx4 v234, s[80:81]
    global_load_lds_dwordx4 v235, s[80:81] offset:1024
    v_mfma_f32_16x16x32_f16 v[32:35], v[136:139], v[168:171], v[32:35]
    ds_read_b64 v[112:113], v197 offset:2112
    v_mfma_f32_16x16x32_f16 v[28:31], v[136:139], v[164:167], v[28:31]
    v_mfma_f32_16x16x32_f16 v[24:27], v[136:139], v[160:163], v[24:27]
    ds_read_b64 v[114:115], v197 offset:2120
    v_mfma_f32_16x16x32_f16 v[44:47], v[140:143], v[176:179], v[44:47]
    ds_read_b128 v[84:87], v196 offset:1088
    v_mfma_f32_16x16x32_f16 v[40:43], v[140:143], v[172:175], v[40:43]
    ds_read_b64 v[116:117], v197 offset:2624
    v_mfma_f32_16x16x32_f16 v[36:39], v[140:143], v[168:171], v[36:39]
    ds_read_b64 v[118:119], v197 offset:2632
    v_mfma_f32_16x16x32_f16 v[32:35], v[140:143], v[164:167], v[32:35]
    ds_read_b128 v[88:91], v196 offset:576
    v_mfma_f32_16x16x32_f16 v[28:31], v[140:143], v[160:163], v[28:31]
    global_load_lds_dwordx4 v236, s[80:81] offset:2048
    global_load_lds_dwordx4 v237, s[80:81] offset:3072
    s_add_u32 s80, s80, 110592
    s_addc_u32 s81, s81, 0
    v_mfma_f32_16x16x32_f16 v[44:47], v[144:147], v[172:175], v[44:47]
    v_mfma_f32_16x16x32_f16 v[40:43], v[144:147], v[168:171], v[40:43]
    ds_read_b64 v[120:121], v197 offset:3136
    v_mfma_f32_16x16x32_f16 v[36:39], v[144:147], v[164:167], v[36:39]
    ds_read_b64 v[122:123], v197 offset:3144
    v_mfma_f32_16x16x32_f16 v[32:35], v[144:147], v[160:163], v[32:35]
    ds_read_b128 v[92:95], v196 offset:64
    v_mfma_f32_16x16x32_f16 v[44:47], v[148:151], v[168:171], v[44:47]
    ds_read_b64 v[124:125], v197 offset:3648
    v_mfma_f32_16x16x32_f16 v[40:43], v[148:151], v[164:167], v[40:43]
    ds_read_b64 v[126:127], v197 offset:3656
    v_mfma_f32_16x16x32_f16 v[36:39], v[148:151], v[160:163], v[36:39]
    v_mfma_f32_16x16x32_f16 v[44:47], v[152:155], v[164:167], v[44:47]
    v_mfma_f32_16x16x32_f16 v[40:43], v[152:155], v[160:163], v[40:43]
    v_mfma_f32_16x16x32_f16 v[44:47], v[156:159], v[160:163], v[44:47]
    s_cmp_lg_u32 s3, 1
    s_cbranch_scc1 L_flush_8
    s_nop 7
    v_accvgpr_write_b32 a128, v16
    v_accvgpr_write_b32 a129, v17
    v_accvgpr_write_b32 a130, v18
    v_accvgpr_write_b32 a131, v19
    v_accvgpr_write_b32 a132, v20
    v_accvgpr_write_b32 a133, v21
    v_accvgpr_write_b32 a134, v22
    v_accvgpr_write_b32 a135, v23
    v_accvgpr_write_b32 a136, v24
    v_accvgpr_write_b32 a137, v25
    v_accvgpr_write_b32 a138, v26
    v_accvgpr_write_b32 a139, v27
    v_accvgpr_write_b32 a140, v28
    v_accvgpr_write_b32 a141, v29
    v_accvgpr_write_b32 a142, v30
    v_accvgpr_write_b32 a143, v31
    v_accvgpr_write_b32 a144, v32
    v_accvgpr_write_b32 a145, v33
    v_accvgpr_write_b32 a146, v34
    v_accvgpr_write_b32 a147, v35
    v_accvgpr_write_b32 a148, v36
    v_accvgpr_write_b32 a149, v37
    v_accvgpr_write_b32 a150, v38
    v_accvgpr_write_b32 a151, v39
    v_accvgpr_write_b32 a152, v40
    v_accvgpr_write_b32 a153, v41
    v_accvgpr_write_b32 a154, v42
    v_accvgpr_write_b32 a155, v43
    v_accvgpr_write_b32 a156, v44
    v_accvgpr_write_b32 a157, v45
    v_accvgpr_write_b32 a158, v46
    v_accvgpr_write_b32 a159, v47
    v_pk_mov_b32 v[16:17], 0, 0
    v_pk_mov_b32 v[18:19], 0, 0
    v_pk_mov_b32 v[20:21], 0, 0
    v_pk_mov_b32 v[22:23], 0, 0
    v_pk_mov_b32 v[24:25], 0, 0
    v_pk_mov_b32 v[26:27], 0, 0
    v_pk_mov_b32 v[28:29], 0, 0
    v_pk_mov_b32 v[30:31], 0, 0
    v_pk_mov_b32 v[32:33], 0, 0
    v_pk_mov_b32 v[34:35], 0, 0
    v_pk_mov_b32 v[36:37], 0, 0
    v_pk_mov_b32 v[38:39], 0, 0
    v_pk_mov_b32 v[40:41], 0, 0
    v_pk_mov_b32 v[42:43], 0, 0
    v_pk_mov_b32 v[44:45], 0, 0
    v_pk_mov_b32 v[46:47], 0, 0
    s_nop 1
L_flush_8:
    s_waitcnt lgkmcnt(0)
    v_mfma_f32_16x16x32_f16 v[44:47], v[64:67], v[124:127], v[44:47]
    ds_read_b128 v[128:131], v196 offset:3584
    v_mfma_f32_16x16x32_f16 v[40:43], v[64:67], v[120:123], v[40:43]
    ds_read_b64 v[160:161], v197 offset:0
    v_mfma_f32_16x16x32_f16 v[36:39], v[64:67], v[116:119], v[36:39]
    ds_read_b64 v[162:163], v197 offset:8
    v_mfma_f32_16x16x32_f16 v[32:35], v[64:67], v[112:115], v[32:35]
    v_mfma_f32_16x16x32_f16 v[28:31], v[64:67], v[108:111], v[28:31]
    ds_read_b128 v[132:135], v196 offset:3072
    v_mfma_f32_16x16x32_f16 v[24:27], v[64:67], v[104:107], v[24:27]
    ds_read_b64 v[164:165], v197 offset:512
    v_mfma_f32_16x16x32_f16 v[20:23], v[64:67], v[100:103], v[20:23]
    ds_read_b64 v[166:167], v197 offset:520
    v_mfma_f32_16x16x32_f16 v[16:19], v[64:67], v[96:99], v[16:19]
    v_mfma_f32_16x16x32_f16 v[44:47], v[68:71], v[120:123], v[44:47]
    ds_read_b128 v[136:139], v196 offset:2560
    v_mfma_f32_16x16x32_f16 v[40:43], v[68:71], v[116:119], v[40:43]
    ds_read_b64 v[168:169], v197 offset:1024
    v_mfma_f32_16x16x32_f16 v[36:39], v[68:71], v[112:115], v[36:39]
    ds_read_b64 v[170:171], v197 offset:1032
    v_mfma_f32_16x16x32_f16 v[32:35], v[68:71], v[108:111], v[32:35]
    v_mfma_f32_16x16x32_f16 v[28:31], v[68:71], v[104:107], v[28:31]
    ds_read_b128 v[140:143], v196 offset:2048
    v_mfma_f32_16x16x32_f16 v[24:27], v[68:71], v[100:103], v[24:27]
    ds_read_b64 v[172:173], v197 offset:1536
    v_mfma_f32_16x16x32_f16 v[20:23], v[68:71], v[96:99], v[20:23]
    s_waitcnt vmcnt(0)
    ds_read_b64_tr_b16 a[0:1], v238 offset:0
    ds_read_b64_tr_b16 a[2:3], v238 offset:512
    v_mfma_f32_16x16x32_f16 v[44:47], v[72:75], v[116:119], v[44:47]
    ds_read_b64 v[174:175], v197 offset:1544
    ds_read_b64_tr_b16 a[4:5], v239 offset:0
    v_mfma_f32_16x16x32_f16 v[40:43], v[72:75], v[112:115], v[40:43]
    ds_read_b64_tr_b16 a[6:7], v239 offset:512
    ds_read_b128 v[144:147], v196 offset:1536
    ds_read_b64_tr_b16 a[8:9], v240 offset:0
    v_mfma_f32_16x16x32_f16 v[36:39], v[72:75], v[108:111], v[36:39]
    ds_read_b64_tr_b16 a[10:11], v240 offset:512
    ds_read_b64 v[176:177], v197 offset:2048
    v_mfma_f32_16x16x32_f16 v[32:35], v[72:75], v[104:107], v[32:35]
    ds_read_b64_tr_b16 a[12:13], v241 offset:0
    ds_read_b64_tr_b16 a[14:15], v241 offset:512
    ds_read_b64_tr_b16 a[16:17], v238 offset:4096
    v_mfma_f32_16x16x32_f16 v[28:31], v[72:75], v[100:103], v[28:31]
    ds_read_b64 v[178:179], v197 offset:2056
    ds_read_b64_tr_b16 a[18:19], v238 offset:4608
    v_mfma_f32_16x16x32_f16 v[24:27], v[72:75], v[96:99], v[24:27]
    ds_read_b64_tr_b16 a[20:21], v239 offset:4096
    ds_read_b128 v[148:151], v196 offset:1024
    ds_read_b64_tr_b16 a[22:23], v239 offset:4608
    v_mfma_f32_16x16x32_f16 v[44:47], v[76:79], v[112:115], v[44:47]
    ds_read_b64_tr_b16 a[24:25], v240 offset:4096
    ds_read_b64 v[180:181], v197 offset:2560
    v_mfma_f32_16x16x32_f16 v[40:43], v[76:79], v[108:111], v[40:43]
    ds_read_b64_tr_b16 a[26:27], v240 offset:4608
    ds_read_b64_tr_b16 a[28:29], v241 offset:4096
    ds_read_b64_tr_b16 a[30:31], v241 offset:4608
    v_mfma_f32_16x16x32_f16 v[36:39], v[76:79], v[104:107], v[36:39]
    ds_read_b64 v[182:183], v197 offset:2568
    ds_read_b64_tr_b16 a[32:33], v238 offset:8192
    v_mfma_f32_16x16x32_f16 v[32:35], v[76:79], v[100:103], v[32:35]
    ds_read_b64_tr_b16 a[34:35], v238 offset:8704
    ds_read_b128 v[152:155], v196 offset:512
    ds_read_b64_tr_b16 a[36:37], v239 offset:8192
    v_mfma_f32_16x16x32_f16 v[28:31], v[76:79], v[96:99], v[28:31]
    ds_read_b64_tr_b16 a[38:39], v239 offset:8704
    ds_read_b64_tr_b16 a[40:41], v240 offset:8192
    v_mfma_f32_16x16x32_f16 v[44:47], v[80:83], v[108:111], v[44:47]
    ds_read_b64 v[184:185], v197 offset:3072
    ds_read_b64_tr_b16 a[42:43], v240 offset:8704
    ds_read_b64_tr_b16 a[44:45], v241 offset:8192
    v_mfma_f32_16x16x32_f16 v[40:43], v[80:83], v[104:107], v[40:43]
    ds_read_b64 v[186:187], v197 offset:3080
    ds_read_b64_tr_b16 a[46:47], v241 offset:8704
    v_mfma_f32_16x16x32_f16 v[36:39], v[80:83], v[100:103], v[36:39]
    ds_read_b64_tr_b16 a[48:49], v238 offset:12288
    ds_read_b128 v[156:159], v196 offset:0
    ds_read_b64_tr_b16 a[50:51], v238 offset:12800
    v_mfma_f32_16x16x32_f16 v[32:35], v[80:83], v[96:99], v[32:35]
    ds_read_b64_tr_b16 a[52:53], v239 offset:12288
    ds_read_b64_tr_b16 a[54:55], v239 offset:12800
    v_mfma_f32_16x16x32_f16 v[44:47], v[84:87], v[104:107], v[44:47]
    ds_read_b64 v[188:189], v197 offset:3584
    ds_read_b64_tr_b16 a[56:57], v240 offset:12288
    ds_read_b64_tr_b16 a[58:59], v240 offset:12800
    v_mfma_f32_16x16x32_f16 v[40:43], v[84:87], v[100:103], v[40:43]
    ds_read_b64 v[190:191], v197 offset:3592
    ds_read_b64_tr_b16 a[60:61], v241 offset:12288
    v_mfma_f32_16x16x32_f16 v[36:39], v[84:87], v[96:99], v[36:39]
    ds_read_b64_tr_b16 a[62:63], v241 offset:12800
    v_mfma_f32_16x16x32_f16 v[44:47], v[88:91], v[100:103], v[44:47]
    v_mfma_f32_16x16x32_f16 v[40:43], v[88:91], v[96:99], v[40:43]
    v_mfma_f32_16x16x32_f16 v[44:47], v[92:95], v[96:99], v[44:47]
    s_waitcnt lgkmcnt(0)
    v_mfma_f32_16x16x32_f16 v[44:47], v[128:131], v[188:191], v[44:47]
    ds_read_b128 v[64:67], v198 offset:3648
    v_mfma_f32_16x16x32_f16 v[40:43], v[128:131], v[184:187], v[40:43]
    s_mul_i32 s82, s3, 16384
    s_mov_b32 m0, s82
    s_add_u32 s82, s82, 4096
    global_load_lds_dwordx4 v234, s[80:81]
    global_load_lds_dwordx4 v235, s[80:81] offset:1024
    v_mfma_f32_16x16x32_f16 v[36:39], v[128:131], v[180:183], v[36:39]
    ds_read_b64 v[96:97], v199 offset:64
    v_mfma_f32_16x16x32_f16 v[32:35], v[128:131], v[176:179], v[32:35]
    ds_read_b64 v[98:99], v199 offset:72
    v_mfma_f32_16x16x32_f16 v[28:31], v[128:131], v[172:175], v[28:31]
    ds_read_b128 v[68:71], v198 offset:3136
    v_mfma_f32_16x16x32_f16 v[24:27], v[128:131], v[168:171], v[24:27]
    v_mfma_f32_16x16x32_f16 v[20:23], v[128:131], v[164:167], v[20:23]
    ds_read_b64 v[100:101], v199 offset:576
    v_mfma_f32_16x16x32_f16 v[16:19], v[128:131], v[160:163], v[16:19]
    global_load_lds_dwordx4 v236, s[80:81] offset:2048
    global_load_lds_dwordx4 v237, s[80:81] offset:3072
    s_add_u32 s80, s80, 110592
    s_addc_u32 s81, s81, 0
    v_mfma_f32_16x16x32_f16 v[44:47], v[132:135], v[184:187], v[44:47]
    ds_read_b64 v[102:103], v199 offset:584
    v_mfma_f32_16x16x32_f16 v[40:43], v[132:135], v[180:183], v[40:43]
    ds_read_b128 v[72:75], v198 offset:2624
    v_mfma_f32_16x16x32_f16 v[36:39], v[132:135], v[176:179], v[36:39]
    ds_read_b64 v[104:105], v199 offset:1088
    v_mfma_f32_16x16x32_f16 v[32:35], v[132:135], v[172:175], v[32:35]
    ds_read_b64 v[106:107], v199 offset:1096
    v_mfma_f32_16x16x32_f16 v[28:31], v[132:135], v[168:171], v[28:31]
    ds_read_b128 v[76:79], v198 offset:2112
    v_mfma_f32_16x16x32_f16 v[24:27], v[132:135], v[164:167], v[24:27]
    s_mov_b32 m0, s82
    s_add_u32 s82, s82, 4096
    global_load_lds_dwordx4 v234, s[80:81]
    global_load_lds_dwordx4 v235, s[80:81] offset:1024
    v_mfma_f32_16x16x32_f16 v[20:23], v[132:135], v[160:163], v[20:23]
    ds_read_b64 v[108:109], v199 offset:1600
    v_mfma_f32_16x16x32_f16 v[44:47], v[136:139], v[180:183], v[44:47]
    v_mfma_f32_16x16x32_f16 v[40:43], v[136:139], v[176:179], v[40:43]
    ds_read_b64 v[110:111], v199 offset:1608
    v_mfma_f32_16x16x32_f16 v[36:39], v[136:139], v[172:175], v[36:39]
    ds_read_b128 v[80:83], v198 offset:1600
    v_mfma_f32_16x16x32_f16 v[32:35], v[136:139], v[168:171], v[32:35]
    ds_read_b64 v[112:113], v199 offset:2112
    v_mfma_f32_16x16x32_f16 v[28:31], v[136:139], v[164:167], v[28:31]
    ds_read_b64 v[114:115], v199 offset:2120
    v_mfma_f32_16x16x32_f16 v[24:27], v[136:139], v[160:163], v[24:27]
    global_load_lds_dwordx4 v236, s[80:81] offset:2048
    global_load_lds_dwordx4 v237, s[80:81] offset:3072
    s_add_u32 s80, s80, 110592
    s_addc_u32 s81, s81, 0
    v_mfma_f32_16x16x32_f16 v[44:47], v[140:143], v[176:179], v[44:47]
    ds_read_b128 v[84:87], v198 offset:1088
    v_mfma_f32_16x16x32_f16 v[40:43], v[140:143], v[172:175], v[40:43]
    ds_read_b64 v[116:117], v199 offset:2624
    v_mfma_f32_16x16x32_f16 v[36:39], v[140:143], v[168:171], v[36:39]
    ds_read_b64 v[118:119], v199 offset:2632
    v_mfma_f32_16x16x32_f16 v[32:35], v[140:143], v[164:167], v[32:35]
    ds_read_b128 v[88:91], v198 offset:576
    v_mfma_f32_16x16x32_f16 v[28:31], v[140:143], v[160:163], v[28:31]
    v_mfma_f32_16x16x32_f16 v[44:47], v[144:147], v[172:175], v[44:47]
    ds_read_b64 v[120:121], v199 offset:3136
    v_mfma_f32_16x16x32_f16 v[40:43], v[144:147], v[168:171], v[40:43]
    s_mov_b32 m0, s82
    s_add_u32 s82, s82, 4096
    global_load_lds_dwordx4 v234, s[80:81]
    global_load_lds_dwordx4 v235, s[80:81] offset:1024
    v_mfma_f32_16x16x32_f16 v[36:39], v[144:147], v[164:167], v[36:39]
    ds_read_b64 v[122:123], v199 offset:3144
    v_mfma_f32_16x16x32_f16 v[32:35], v[144:147], v[160:163], v[32:35]
    ds_read_b128 v[92:95], v198 offset:64
    v_mfma_f32_16x16x32_f16 v[44:47], v[148:151], v[168:171], v[44:47]
    ds_read_b64 v[124:125], v199 offset:3648
    v_mfma_f32_16x16x32_f16 v[40:43], v[148:151], v[164:167], v[40:43]
    ds_read_b64 v[126:127], v199 offset:3656
    v_mfma_f32_16x16x32_f16 v[36:39], v[148:151], v[160:163], v[36:39]
    v_mfma_f32_16x16x32_f16 v[44:47], v[152:155], v[164:167], v[44:47]
    v_mfma_f32_16x16x32_f16 v[40:43], v[152:155], v[160:163], v[40:43]
    v_mfma_f32_16x16x32_f16 v[44:47], v[156:159], v[160:163], v[44:47]
    s_cmp_lg_u32 s3, 2
    s_cbranch_scc1 L_flush_9
    s_nop 7
    v_accvgpr_write_b32 a128, v16
    v_accvgpr_write_b32 a129, v17
    v_accvgpr_write_b32 a130, v18
    v_accvgpr_write_b32 a131, v19
    v_accvgpr_write_b32 a132, v20
    v_accvgpr_write_b32 a133, v21
    v_accvgpr_write_b32 a134, v22
    v_accvgpr_write_b32 a135, v23
    v_accvgpr_write_b32 a136, v24
    v_accvgpr_write_b32 a137, v25
    v_accvgpr_write_b32 a138, v26
    v_accvgpr_write_b32 a139, v27
    v_accvgpr_write_b32 a140, v28
    v_accvgpr_write_b32 a141, v29
    v_accvgpr_write_b32 a142, v30
    v_accvgpr_write_b32 a143, v31
    v_accvgpr_write_b32 a144, v32
    v_accvgpr_write_b32 a145, v33
    v_accvgpr_write_b32 a146, v34
    v_accvgpr_write_b32 a147, v35
    v_accvgpr_write_b32 a148, v36
    v_accvgpr_write_b32 a149, v37
    v_accvgpr_write_b32 a150, v38
    v_accvgpr_write_b32 a151, v39
    v_accvgpr_write_b32 a152, v40
    v_accvgpr_write_b32 a153, v41
    v_accvgpr_write_b32 a154, v42
    v_accvgpr_write_b32 a155, v43
    v_accvgpr_write_b32 a156, v44
    v_accvgpr_write_b32 a157, v45
    v_accvgpr_write_b32 a158, v46
    v_accvgpr_write_b32 a159, v47
    v_pk_mov_b32 v[16:17], 0, 0
    v_pk_mov_b32 v[18:19], 0, 0
    v_pk_mov_b32 v[20:21], 0, 0
    v_pk_mov_b32 v[22:23], 0, 0
    v_pk_mov_b32 v[24:25], 0, 0
    v_pk_mov_b32 v[26:27], 0, 0
    v_pk_mov_b32 v[28:29], 0, 0
    v_pk_mov_b32 v[30:31], 0, 0
    v_pk_mov_b32 v[32:33], 0, 0
    v_pk_mov_b32 v[34:35], 0, 0
    v_pk_mov_b32 v[36:37], 0, 0
    v_pk_mov_b32 v[38:39], 0, 0
    v_pk_mov_b32 v[40:41], 0, 0
    v_pk_mov_b32 v[42:43], 0, 0
    v_pk_mov_b32 v[44:45], 0, 0
    v_pk_mov_b32 v[46:47], 0, 0
    s_nop 1
L_flush_9:
    s_waitcnt lgkmcnt(0)
    v_mfma_f32_16x16x32_f16 v[44:47], v[64:67], v[124:127], v[44:47]
    ds_read_b128 v[128:131], v198 offset:3584
    v_mfma_f32_16x16x32_f16 v[40:43], v[64:67], v[120:123], v[40:43]
    global_load_lds_dwordx4 v236, s[80:81] offset:2048
    global_load_lds_dwordx4 v237, s[80:81] offset:3072
    s_add_u32 s80, s80, 110592
    s_addc_u32 s81, s81, 0
    v_mfma_f32_16x16x32_f16 v[36:39], v[64:67], v[116:119], v[36:39]
    ds_read_b64 v[160:161], v199 offset:0
    v_mfma_f32_16x16x32_f16 v[32:35], v[64:67], v[112:115], v[32:35]
    ds_read_b64 v[162:163], v199 offset:8
    v_mfma_f32_16x16x32_f16 v[28:31], v[64:67], v[108:111], v[28:31]
    ds_read_b128 v[132:135], v198 offset:3072
    v_mfma_f32_16x16x32_f16 v[24:27], v[64:67], v[104:107], v[24:27]
    ds_read_b64 v[164:165], v199 offset:512
    v_mfma_f32_16x16x32_f16 v[20:23], v[64:67], v[100:103], v[20:23]
    s_mov_b32 m0, s82
    s_add_u32 s82, s82, 4096
    global_load_lds_dwordx4 v234, s[80:81]
    global_load_lds_dwordx4 v235, s[80:81] offset:1024
    v_mfma_f32_16x16x32_f16 v[16:19], v[64:67], v[96:99], v[16:19]
    v_mfma_f32_16x16x32_f16 v[44:47], v[68:71], v[120:123], v[44:47]
    ds_read_b64 v[166:167], v199 offset:520
    v_mfma_f32_16x16x32_f16 v[40:43], v[68:71], v[116:119], v[40:43]
    ds_read_b128 v[136:139], v198 offset:2560
    v_mfma_f32_16x16x32_f16 v[36:39], v[68:71], v[112:115], v[36:39]
    ds_read_b64 v[168:169], v199 offset:1024
    v_mfma_f32_16x16x32_f16 v[32:35], v[68:71], v[108:111], v[32:35]
    ds_read_b64 v[170:171], v199 offset:1032
    v_mfma_f32_16x16x32_f16 v[28:31], v[68:71], v[104:107], v[28:31]
    global_load_lds_dwordx4 v236, s[80:81] offset:2048
    global_load_lds_dwordx4 v237, s[80:81] offset:3072
    s_add_u32 s80, s80, 110592
    s_addc_u32 s81, s81, 0
    v_mfma_f32_16x16x32_f16 v[24:27], v[68:71], v[100:103], v[24:27]
    ds_read_b128 v[140:143], v198 offset:2048
    v_mfma_f32_16x16x32_f16 v[20:23], v[68:71], v[96:99], v[20:23]
    ds_read_b64 v[172:173], v199 offset:1536
    v_mfma_f32_16x16x32_f16 v[44:47], v[72:75], v[116:119], v[44:47]
    ds_read_b64 v[174:175], v199 offset:1544
    v_mfma_f32_16x16x32_f16 v[40:43], v[72:75], v[112:115], v[40:43]
    ds_read_b128 v[144:147], v198 offset:1536
    v_mfma_f32_16x16x32_f16 v[36:39], v[72:75], v[108:111], v[36:39]
    global_load_dword v193, v233, s[52:53] sc1
    v_mfma_f32_16x16x32_f16 v[32:35], v[72:75], v[104:107], v[32:35]
    ds_read_b64 v[176:177], v199 offset:2048
    v_mfma_f32_16x16x32_f16 v[28:31], v[72:75], v[100:103], v[28:31]
    ds_read_b64 v[178:179], v199 offset:2056
    v_mfma_f32_16x16x32_f16 v[24:27], v[72:75], v[96:99], v[24:27]
    ds_read_b128 v[148:151], v198 offset:1024
    v_mfma_f32_16x16x32_f16 v[44:47], v[76:79], v[112:115], v[44:47]
    v_mfma_f32_16x16x32_f16 v[40:43], v[76:79], v[108:111], v[40:43]
    ds_read_b64 v[180:181], v199 offset:2560
    v_mfma_f32_16x16x32_f16 v[36:39], v[76:79], v[104:107], v[36:39]
    global_load_dword v192, v231, s[32:33]
    v_mfma_f32_16x16x32_f16 v[32:35], v[76:79], v[100:103], v[32:35]
    ds_read_b64 v[182:183], v199 offset:2568
    v_mfma_f32_16x16x32_f16 v[28:31], v[76:79], v[96:99], v[28:31]
    ds_read_b128 v[152:155], v198 offset:512
    v_mfma_f32_16x16x32_f16 v[44:47], v[80:83], v[108:111], v[44:47]
    ds_read_b64 v[184:185], v199 offset:3072
    v_mfma_f32_16x16x32_f16 v[40:43], v[80:83], v[104:107], v[40:43]
    ds_read_b64 v[186:187], v199 offset:3080
    v_mfma_f32_16x16x32_f16 v[36:39], v[80:83], v[100:103], v[36:39]
    global_load_dword v192, v232, s[36:37]
    v_mfma_f32_16x16x32_f16 v[32:35], v[80:83], v[96:99], v[32:35]
    ds_read_b128 v[156:159], v198 offset:0
    v_mfma_f32_16x16x32_f16 v[44:47], v[84:87], v[104:107], v[44:47]
    ds_read_b64 v[188:189], v199 offset:3584
    v_mfma_f32_16x16x32_f16 v[40:43], v[84:87], v[100:103], v[40:43]
    ds_read_b64 v[190:191], v199 offset:3592
    v_mfma_f32_16x16x32_f16 v[36:39], v[84:87], v[96:99], v[36:39]
    v_mfma_f32_16x16x32_f16 v[44:47], v[88:91], v[100:103], v[44:47]
    v_mfma_f32_16x16x32_f16 v[40:43], v[88:91], v[96:99], v[40:43]
    v_mfma_f32_16x16x32_f16 v[44:47], v[92:95], v[96:99], v[44:47]
    s_waitcnt lgkmcnt(0)
    v_mfma_f32_16x16x32_f16 v[44:47], v[128:131], v[188:191], v[44:47]
    v_mfma_f32_16x16x32_f16 v[40:43], v[128:131], v[184:187], v[40:43]
    v_mfma_f32_16x16x32_f16 v[36:39], v[128:131], v[180:183], v[36:39]
    v_mfma_f32_16x16x32_f16 v[32:35], v[128:131], v[176:179], v[32:35]
    v_mfma_f32_16x16x32_f16 v[28:31], v[128:131], v[172:175], v[28:31]
    v_mfma_f32_16x16x32_f16 v[24:27], v[128:131], v[168:171], v[24:27]
    v_mfma_f32_16x16x32_f16 v[20:23], v[128:131], v[164:167], v[20:23]
    v_mfma_f32_16x16x32_f16 v[16:19], v[128:131], v[160:163], v[16:19]
    v_mfma_f32_16x16x32_f16 v[44:47], v[132:135], v[184:187], v[44:47]
    v_mfma_f32_16x16x32_f16 v[40:43], v[132:135], v[180:183], v[40:43]
    v_mfma_f32_16x16x32_f16 v[36:39], v[132:135], v[176:179], v[36:39]
    v_mfma_f32_16x16x32_f16 v[32:35], v[132:135], v[172:175], v[32:35]
    v_mfma_f32_16x16x32_f16 v[28:31], v[132:135], v[168:171], v[28:31]
    v_mfma_f32_16x16x32_f16 v[24:27], v[132:135], v[164:167], v[24:27]
    v_mfma_f32_16x16x32_f16 v[20:23], v[132:135], v[160:163], v[20:23]
    v_mfma_f32_16x16x32_f16 v[44:47], v[136:139], v[180:183], v[44:47]
    v_mfma_f32_16x16x32_f16 v[40:43], v[136:139], v[176:179], v[40:43]
    v_mfma_f32_16x16x32_f16 v[36:39], v[136:139], v[172:175], v[36:39]
    v_mfma_f32_16x16x32_f16 v[32:35], v[136:139], v[168:171], v[32:35]
    v_mfma_f32_16x16x32_f16 v[28:31], v[136:139], v[164:167], v[28:31]
    v_mfma_f32_16x16x32_f16 v[24:27], v[136:139], v[160:163], v[24:27]
    v_mfma_f32_16x16x32_f16 v[44:47], v[140:143], v[176:179], v[44:47]
    v_mfma_f32_16x16x32_f16 v[40:43], v[140:143], v[172:175], v[40:43]
    v_mfma_f32_16x16x32_f16 v[36:39], v[140:143], v[168:171], v[36:39]
    v_mfma_f32_16x16x32_f16 v[32:35], v[140:143], v[164:167], v[32:35]
    v_mfma_f32_16x16x32_f16 v[28:31], v[140:143], v[160:163], v[28:31]
    v_mfma_f32_16x16x32_f16 v[44:47], v[144:147], v[172:175], v[44:47]
    v_mfma_f32_16x16x32_f16 v[40:43], v[144:147], v[168:171], v[40:43]
    v_mfma_f32_16x16x32_f16 v[36:39], v[144:147], v[164:167], v[36:39]
    v_mfma_f32_16x16x32_f16 v[32:35], v[144:147], v[160:163], v[32:35]
    v_mfma_f32_16x16x32_f16 v[44:47], v[148:151], v[168:171], v[44:47]
    v_mfma_f32_16x16x32_f16 v[40:43], v[148:151], v[164:167], v[40:43]
    v_mfma_f32_16x16x32_f16 v[36:39], v[148:151], v[160:163], v[36:39]
    v_mfma_f32_16x16x32_f16 v[44:47], v[152:155], v[164:167], v[44:47]
    v_mfma_f32_16x16x32_f16 v[40:43], v[152:155], v[160:163], v[40:43]
    v_mfma_f32_16x16x32_f16 v[44:47], v[156:159], v[160:163], v[44:47]
    s_mul_i32 s54, s6, 12288
    v_lshl_add_u32 v10, v0, 4, s54
    v_add_u32 v11, 4096, v10
    v_add_u32 v12, 8192, v10
    v_lshlrev_b32 v13, 4, v0
    v_add_u32 v13, 84224, v13
    s_barrier
    ds_write_b128 v242, v[16:19] offset:0
    ds_write_b128 v242, v[20:23] offset:1536
    ds_write_b128 v242, v[24:27] offset:3072
    ds_write_b128 v242, v[28:31] offset:4608
    ds_write_b128 v242, v[32:35] offset:6144
    ds_write_b128 v242, v[36:39] offset:7680
    ds_write_b128 v242, v[40:43] offset:9216
    ds_write_b128 v242, v[44:47] offset:10752
    s_add_u32 s54, s3, 1
    s_bitcmp0_b32 s54, 1
    s_cbranch_scc1 L_nofl_10
    ds_write_b128 v243, a[128:131] offset:0
    ds_write_b128 v243, a[132:135] offset:1536
    ds_write_b128 v243, a[136:139] offset:3072
    ds_write_b128 v243, a[140:143] offset:4608
    ds_write_b128 v243, a[144:147] offset:6144
    ds_write_b128 v243, a[148:151] offset:7680
    ds_write_b128 v243, a[152:155] offset:9216
    ds_write_b128 v243, a[156:159] offset:10752
L_nofl_10:
    s_mov_b32 s69, 0
    s_waitcnt vmcnt(2)
L_pdpoll_11:
    v_cmp_ne_u32 vcc, s10, v193
    s_cbranch_vccz L_pdok_12
    s_add_u32 s69, s69, 1
    s_cmp_gt_u32 s69, 200000
    s_cbranch_scc1 L_pdok_12
    s_sleep 4
    global_load_dword v193, v233, s[52:53] sc1
    s_waitcnt vmcnt(0)
    s_branch L_pdpoll_11
L_pdok_12:
    s_waitcnt lgkmcnt(0)
    s_barrier
    ds_read_b128 v[64:67], v13 offset:0
    ds_read_b128 v[68:71], v13 offset:12352
    ds_read_b128 v[72:75], v13 offset:24704
    ds_read_b128 v[76:79], v13 offset:37056
    ds_read_b128 v[80:83], v13 offset:4096
    ds_read_b128 v[84:87], v13 offset:16448
    ds_read_b128 v[88:91], v13 offset:28800
    ds_read_b128 v[92:95], v13 offset:41152
    ds_read_b128 v[96:99], v13 offset:8192
    ds_read_b128 v[100:103], v13 offset:20544
    ds_read_b128 v[104:107], v13 offset:32896
    ds_read_b128 v[108:111], v13 offset:45248
    s_waitcnt lgkmcnt(8)
    v_pk_add_f32 v[64:65], v[64:65], v[72:73]
    v_pk_add_f32 v[66:67], v[66:67], v[74:75]
    v_pk_add_f32 v[68:69], v[68:69], v[76:77]
    v_pk_add_f32 v[70:71], v[70:71], v[78:79]
    v_pk_mul_f32 v[64:65], v[64:65], v[4:5] op_sel_hi:[1,0]
    v_pk_mul_f32 v[66:67], v[66:67], v[4:5] op_sel_hi:[1,0]
    v_pk_mul_f32 v[68:69], v[68:69], v[4:5] op_sel_hi:[1,0]
    v_pk_mul_f32 v[70:71], v[70:71], v[4:5] op_sel_hi:[1,0]
    v_cvt_pk_bf16_f32 v72, v64, v65
    v_cvt_pk_bf16_f32 v73, v66, v67
    v_cvt_pk_bf16_f32 v74, v68, v69
    v_cvt_pk_bf16_f32 v75, v70, v71
    v_min_u32 v72, 0xfffffffe, v72
    v_min_u32 v73, 0xfffffffe, v73
    v_min_u32 v74, 0xfffffffe, v74
    v_min_u32 v75, 0xfffffffe, v75
    global_store_dwordx4 v10, v[72:75], s[46:47] sc1
    s_waitcnt lgkmcnt(4)
    v_pk_add_f32 v[80:81], v[80:81], v[88:89]
    v_pk_add_f32 v[82:83], v[82:83], v[90:91]
    v_pk_add_f32 v[84:85], v[84:85], v[92:93]
    v_pk_add_f32 v[86:87], v[86:87], v[94:95]
    v_pk_mul_f32 v[80:81], v[80:81], v[6:7] op_sel_hi:[1,0]
    v_pk_mul_f32 v[82:83], v[82:83], v[6:7] op_sel_hi:[1,0]
    v_pk_mul_f32 v[84:85], v[84:85], v[6:7] op_sel_hi:[1,0]
    v_pk_mul_f32 v[86:87], v[86:87], v[6:7] op_sel_hi:[1,0]
    v_cvt_pk_bf16_f32 v88, v80, v81
    v_cvt_pk_bf16_f32 v89, v82, v83
    v_cvt_pk_bf16_f32 v90, v84, v85
    v_cvt_pk_bf16_f32 v91, v86, v87
    v_min_u32 v88, 0xfffffffe, v88
    v_min_u32 v89, 0xfffffffe, v89
    v_min_u32 v90, 0xfffffffe, v90
    v_min_u32 v91, 0xfffffffe, v91
    global_store_dwordx4 v11, v[88:91], s[46:47] sc1
    s_waitcnt lgkmcnt(0)
    v_pk_add_f32 v[96:97], v[96:97], v[104:105]
    v_pk_add_f32 v[98:99], v[98:99], v[106:107]
    v_pk_add_f32 v[100:101], v[100:101], v[108:109]
    v_pk_add_f32 v[102:103], v[102:103], v[110:111]
    v_pk_mul_f32 v[96:97], v[96:97], v[8:9] op_sel_hi:[1,0]
    v_pk_mul_f32 v[98:99], v[98:99], v[8:9] op_sel_hi:[1,0]
    v_pk_mul_f32 v[100:101], v[100:101], v[8:9] op_sel_hi:[1,0]
    v_pk_mul_f32 v[102:103], v[102:103], v[8:9] op_sel_hi:[1,0]
    v_cvt_pk_bf16_f32 v104, v96, v97
    v_cvt_pk_bf16_f32 v105, v98, v99
    v_cvt_pk_bf16_f32 v106, v100, v101
    v_cvt_pk_bf16_f32 v107, v102, v103
    v_min_u32 v104, 0xfffffffe, v104
    v_min_u32 v105, 0xfffffffe, v105
    v_min_u32 v106, 0xfffffffe, v106
    v_min_u32 v107, 0xfffffffe, v107
    global_store_dwordx4 v12, v[104:107], s[46:47] sc1
L_win2:
    ds_read_b64_tr_b16 a[64:65], v238 offset:0
    ds_read_b64_tr_b16 a[66:67], v238 offset:512
    ds_read_b64_tr_b16 a[68:69], v239 offset:0
    ds_read_b64_tr_b16 a[70:71], v239 offset:512
    ds_read_b64_tr_b16 a[72:73], v240 offset:0
    ds_read_b64_tr_b16 a[74:75], v240 offset:512
    ds_read_b64_tr_b16 a[76:77], v241 offset:0
    ds_read_b64_tr_b16 a[78:79], v241 offset:512
    ds_read_b64_tr_b16 a[80:81], v238 offset:4096
    ds_read_b64_tr_b16 a[82:83], v238 offset:4608
    ds_read_b64_tr_b16 a[84:85], v239 offset:4096
    ds_read_b64_tr_b16 a[86:87], v239 offset:4608
    ds_read_b64_tr_b16 a[88:89], v240 offset:4096
    ds_read_b64_tr_b16 a[90:91], v240 offset:4608
    ds_read_b64_tr_b16 a[92:93], v241 offset:4096
    ds_read_b64_tr_b16 a[94:95], v241 offset:4608
    ds_read_b64_tr_b16 a[96:97], v238 offset:8192
    ds_read_b64_tr_b16 a[98:99], v238 offset:8704
    ds_read_b64_tr_b16 a[100:101], v239 offset:8192
    ds_read_b64_tr_b16 a[102:103], v239 offset:8704
    ds_read_b64_tr_b16 a[104:105], v240 offset:8192
    ds_read_b64_tr_b16 a[106:107], v240 offset:8704
    ds_read_b64_tr_b16 a[108:109], v241 offset:8192
    ds_read_b64_tr_b16 a[110:111], v241 offset:8704
    ds_read_b64_tr_b16 a[112:113], v238 offset:12288
    ds_read_b64_tr_b16 a[114:115], v238 offset:12800
    ds_read_b64_tr_b16 a[116:117], v239 offset:12288
    ds_read_b64_tr_b16 a[118:119], v239 offset:12800
    ds_read_b64_tr_b16 a[120:121], v240 offset:12288
    ds_read_b64_tr_b16 a[122:123], v240 offset:12800
    ds_read_b64_tr_b16 a[124:125], v241 offset:12288
    ds_read_b64_tr_b16 a[126:127], v241 offset:12800
    s_lshl_b32 s54, s3, 14
    s_waitcnt lgkmcnt(0)
    v_add_u32 v238, s54, v238
    v_add_u32 v239, s54, v239
    v_add_u32 v240, s54, v240
    v_add_u32 v241, s54, v241
    s_barrier
    v_add_u32 v233, 0x18000, v233
    global_load_dword v193, v233, s[52:53] sc1
    v_accvgpr_read_b32 v170, a224
    v_accvgpr_read_b32 v171, a225
    v_accvgpr_read_b32 v172, a226
    s_mul_i32 s82, s3, 32768
    s_mov_b32 m0, s82
    s_add_u32 s82, s82, 4096
    global_load_lds_dwordx4 v234, s[80:81]
    global_load_lds_dwordx4 v235, s[80:81] offset:1024
    v_accvgpr_read_b32 v173, a227
    v_accvgpr_read_b32 v174, a228
    v_accvgpr_read_b32 v175, a229
    v_accvgpr_read_b32 v176, a230
    v_accvgpr_read_b32 v177, a231
    v_accvgpr_read_b32 v178, a232
    v_accvgpr_read_b32 v179, a233
    global_load_lds_dwordx4 v236, s[80:81] offset:2048
    global_load_lds_dwordx4 v237, s[80:81] offset:3072
    s_add_u32 s80, s80, 110592
    s_addc_u32 s81, s81, 0
    v_accvgpr_read_b32 v180, a234
    v_lshlrev_b32 v100, 16, v200
    v_and_b32 v101, 0xffff0000, v200
    v_lshlrev_b32 v124, 16, v212
    v_and_b32 v125, 0xffff0000, v212
    v_lshlrev_b32 v102, 16, v201
    v_and_b32 v103, 0xffff0000, v201
    s_mov_b32 m0, s82
    s_add_u32 s82, s82, 4096
    global_load_lds_dwordx4 v234, s[80:81]
    global_load_lds_dwordx4 v235, s[80:81] offset:1024
    v_lshlrev_b32 v126, 16, v213
    v_and_b32 v127, 0xffff0000, v213
    v_lshlrev_b32 v104, 16, v202
    v_and_b32 v105, 0xffff0000, v202
    v_lshlrev_b32 v128, 16, v214
    v_and_b32 v129, 0xffff0000, v214
    v_lshlrev_b32 v106, 16, v203
    global_load_lds_dwordx4 v236, s[80:81] offset:2048
    global_load_lds_dwordx4 v237, s[80:81] offset:3072
    s_add_u32 s80, s80, 110592
    s_addc_u32 s81, s81, 0
    v_and_b32 v107, 0xffff0000, v203
    v_lshlrev_b32 v130, 16, v215
    v_and_b32 v131, 0xffff0000, v215
    v_lshlrev_b32 v108, 16, v204
    v_and_b32 v109, 0xffff0000, v204
    v_lshlrev_b32 v132, 16, v216
    v_and_b32 v133, 0xffff0000, v216
    s_mov_b32 m0, s82
    s_add_u32 s82, s82, 4096
    global_load_lds_dwordx4 v234, s[80:81]
    global_load_lds_dwordx4 v235, s[80:81] offset:1024
    v_lshlrev_b32 v110, 16, v205
    v_and_b32 v111, 0xffff0000, v205
    v_lshlrev_b32 v134, 16, v217
    v_and_b32 v135, 0xffff0000, v217
    v_lshlrev_b32 v112, 16, v206
    v_and_b32 v113, 0xffff0000, v206
    v_lshlrev_b32 v136, 16, v218
    global_load_lds_dwordx4 v236, s[80:81] offset:2048
    global_load_lds_dwordx4 v237, s[80:81] offset:3072
    s_add_u32 s80, s80, 110592
    s_addc_u32 s81, s81, 0
    v_and_b32 v137, 0xffff0000, v218
    v_lshlrev_b32 v114, 16, v207
    v_and_b32 v115, 0xffff0000, v207
    v_lshlrev_b32 v138, 16, v219
    v_and_b32 v139, 0xffff0000, v219
    v_lshlrev_b32 v116, 16, v208
    v_and_b32 v117, 0xffff0000, v208
    s_mov_b32 m0, s82
    s_add_u32 s82, s82, 4096
    global_load_lds_dwordx4 v234, s[80:81]
    global_load_lds_dwordx4 v235, s[80:81] offset:1024
    v_lshlrev_b32 v140, 16, v220
    v_and_b32 v141, 0xffff0000, v220
    v_lshlrev_b32 v118, 16, v209
    v_and_b32 v119, 0xffff0000, v209
    v_lshlrev_b32 v142, 16, v221
    v_and_b32 v143, 0xffff0000, v221
    global_load_lds_dwordx4 v236, s[80:81] offset:2048
    global_load_lds_dwordx4 v237, s[80:81] offset:3072
    s_add_u32 s80, s80, 110592
    s_addc_u32 s81, s81, 0
    v_lshlrev_b32 v120, 16, v210
    v_and_b32 v121, 0xffff0000, v210
    v_lshlrev_b32 v144, 16, v222
    v_and_b32 v145, 0xffff0000, v222
    v_lshlrev_b32 v122, 16, v211
    v_and_b32 v123, 0xffff0000, v211
    v_lshlrev_b32 v146, 16, v223
    s_mov_b32 m0, s82
    s_add_u32 s82, s82, 4096
    global_load_lds_dwordx4 v234, s[80:81]
    global_load_lds_dwordx4 v235, s[80:81] offset:1024
    v_and_b32 v147, 0xffff0000, v223
    s_add_u32 s54, s3, 1
    s_and_b32 s54, s54, 3
    s_lshl_b32 s54, s54, 15
    s_add_u32 s54, s54, 20480
    v_lshl_add_u32 v242, v1, 4, s54
    s_add_u32 s54, s3, 2
    global_load_lds_dwordx4 v236, s[80:81] offset:2048
    global_load_lds_dwordx4 v237, s[80:81] offset:3072
    s_add_u32 s80, s80, 110592
    s_addc_u32 s81, s81, 0
    s_and_b32 s54, s54, 3
    s_lshl_b32 s54, s54, 15
    s_add_u32 s54, s54, 23552
    v_lshl_add_u32 v243, v1, 4, s54
    s_add_u32 s54, s3, 3
    s_and_b32 s54, s54, 3
    s_lshl_b32 s54, s54, 15
    s_add_u32 s54, s54, 26624
    v_lshl_add_u32 v244, v1, 4, s54
    s_lshl_b32 s54, s3, 15
    s_add_u32 s54, s54, 20480
    v_lshl_add_u32 v245, v1, 4, s54
    s_cmp_eq_u32 s79, 0
    s_cbranch_scc1 L_nog1s_13
    s_mul_i32 s54, s76, 327680
    v_lshl_add_u32 v2, v1, 4, s54
    v_add_u32 v3, 65536, v2
    v_add_u32 v4, 131072, v2
    v_add_u32 v5, 196608, v2
    v_add_u32 v6, 262144, v2
    s_lshl_b32 s54, s3, 14
    s_add_u32 s54, s54, 4096
    s_add_u32 s84, s48, s54
    s_addc_u32 s85, s49, 0
    s_add_u32 s86, s84, 8192
    s_addc_u32 s87, s85, 0
    s_mul_i32 s54, s76, 270
    s_lshl_b32 s55, s77, 1
    s_add_u32 s54, s54, s55
    s_lshl_b32 s54, s54, 10
    s_lshl_b32 s55, s3, 9
    s_add_u32 s54, s54, s55
    v_and_b32 v7, 15, v1
    v_lshrrev_b32 v8, 5, v1
    v_lshl_add_u32 v7, v8, 4, v7
    v_lshl_add_u32 v7, v7, 4, s54
    v_add_u32 v247, 110592, v7
    v_bfe_u32 v8, v1, 4, 1
    v_mul_u32_u24 v8, 55296, v8
    v_add_u32 v246, v7, v8
    v_add_u32 v248, 165888, v246
    v_mov_b32 v10, -1
    v_mov_b32 v11, -1
    v_mov_b32 v12, -1
    v_mov_b32 v13, -1
    global_store_dwordx4 v246, v[10:13], s[50:51] sc1
    global_store_dwordx4 v247, v[10:13], s[50:51] sc1
    global_store_dwordx4 v248, v[10:13], s[50:51] sc1
    s_lshl_b32 s54, s77, 7
    s_lshl_b32 s55, s3, 5
    s_add_u32 s54, s54, s55
    v_lshrrev_b32 v7, 4, v1
    v_lshl_add_u32 v7, v7, 3, s54
    global_load_dwordx2 v[252:253], v7, s[34:35]
    s_mul_i32 s54, s76, 27
    s_add_u32 s54, s54, s77
    s_lshl_b32 s54, s54, 7
    s_add_u32 s54, s54, 0x18000
    v_mov_b32 v249, s54
    v_mov_b32 v9, s10
    s_mov_b32 s69, 0
    s_lshl_b32 s54, s6, 7
    s_lshl_b32 s55, s3, 2
    s_add_u32 s54, s54, s55
    s_add_u32 s54, s54, 0x10000
    v_mov_b32 v254, s54
L_nog1s_13:
    s_mov_b32 s69, 0
    global_load_dwordx4 v[16:19], v170, s[46:47] sc1
    global_load_dwordx4 v[20:23], v171, s[46:47] sc1
    global_load_dwordx4 v[24:27], v172, s[46:47] sc1
    s_waitcnt vmcnt(3)
    ds_read_b64_tr_b16 a[128:129], v238 offset:0
    ds_read_b64_tr_b16 a[130:131], v238 offset:512
    ds_read_b64_tr_b16 a[132:133], v239 offset:0
    ds_read_b64_tr_b16 a[134:135], v239 offset:512
    ds_read_b64_tr_b16 a[136:137], v240 offset:0
    ds_read_b64_tr_b16 a[138:139], v240 offset:512
    ds_read_b64_tr_b16 a[140:141], v241 offset:0
    ds_read_b64_tr_b16 a[142:143], v241 offset:512
    ds_read_b64_tr_b16 a[144:145], v238 offset:4096
    ds_read_b64_tr_b16 a[146:147], v238 offset:4608
    ds_read_b64_tr_b16 a[148:149], v239 offset:4096
    ds_read_b64_tr_b16 a[150:151], v239 offset:4608
    ds_read_b64_tr_b16 a[152:153], v240 offset:4096
    ds_read_b64_tr_b16 a[154:155], v240 offset:4608
    ds_read_b64_tr_b16 a[156:157], v241 offset:4096
    ds_read_b64_tr_b16 a[158:159], v241 offset:4608
    ds_read_b64_tr_b16 a[160:161], v238 offset:8192
    ds_read_b64_tr_b16 a[162:163], v238 offset:8704
    ds_read_b64_tr_b16 a[164:165], v239 offset:8192
    ds_read_b64_tr_b16 a[166:167], v239 offset:8704
    ds_read_b64_tr_b16 a[168:169], v240 offset:8192
    ds_read_b64_tr_b16 a[170:171], v240 offset:8704
    ds_read_b64_tr_b16 a[172:173], v241 offset:8192
    ds_read_b64_tr_b16 a[174:175], v241 offset:8704
    ds_read_b64_tr_b16 a[176:177], v238 offset:12288
    ds_read_b64_tr_b16 a[178:179], v238 offset:12800
    ds_read_b64_tr_b16 a[180:181], v239 offset:12288
    ds_read_b64_tr_b16 a[182:183], v239 offset:12800
    ds_read_b64_tr_b16 a[184:185], v240 offset:12288
    ds_read_b64_tr_b16 a[186:187], v240 offset:12800
    ds_read_b64_tr_b16 a[188:189], v241 offset:12288
    ds_read_b64_tr_b16 a[190:191], v241 offset:12800
    ds_read_b64_tr_b16 a[192:193], v238 offset:16384
    ds_read_b64_tr_b16 a[194:195], v238 offset:16896
    ds_read_b64_tr_b16 a[196:197], v239 offset:16384
    ds_read_b64_tr_b16 a[198:199], v239 offset:16896
    ds_read_b64_tr_b16 a[200:201], v240 offset:16384
    ds_read_b64_tr_b16 a[202:203], v240 offset:16896
    ds_read_b64_tr_b16 a[204:205], v241 offset:16384
    ds_read_b64_tr_b16 a[206:207], v241 offset:16896
    s_branch L_hfirst_16
L_hpoll_14:
    global_load_dwordx4 v[16:19], v170, s[46:47] sc1
    global_load_dwordx4 v[20:23], v171, s[46:47] sc1
    global_load_dwordx4 v[24:27], v172, s[46:47] sc1
L_hfirst_16:
    s_waitcnt vmcnt(0)
    v_max3_u32 v28, v16, v17, v18
    v_max3_u32 v29, v19, v20, v21
    v_max3_u32 v30, v22, v23, v24
    v_max3_u32 v31, v25, v26, v27
    v_max3_u32 v28, v28, v29, v30
    v_max_u32 v28, v28, v31
    v_cmp_eq_u32 vcc, -1, v28
    s_cbranch_vccz L_hok_15
    s_add_u32 s69, s69, 1
    s_cmp_gt_u32 s69, 200000
    s_cbranch_scc1 L_hok_15
    s_sleep 4
    s_branch L_hpoll_14
L_hok_15:
    v_lshlrev_b32 v32, 16, v16
    v_and_b32 v33, 0xffff0000, v16
    v_lshlrev_b32 v34, 16, v17
    v_and_b32 v35, 0xffff0000, v17
    v_lshlrev_b32 v36, 16, v18
    v_and_b32 v37, 0xffff0000, v18
    v_lshlrev_b32 v38, 16, v19
    v_and_b32 v39, 0xffff0000, v19
    s_mul_i32 s82, s3, 32768
    s_add_u32 s82, s82, 20480
    s_mov_b32 m0, s82
    s_add_u32 s82, s82, 4096
    global_load_lds_dwordx4 v234, s[80:81]
    global_load_lds_dwordx4 v235, s[80:81] offset:1024
    v_lshlrev_b32 v40, 16, v20
    v_and_b32 v41, 0xffff0000, v20
    v_lshlrev_b32 v42, 16, v21
    v_and_b32 v43, 0xffff0000, v21
    v_lshlrev_b32 v44, 16, v22
    v_and_b32 v45, 0xffff0000, v22
    v_lshlrev_b32 v46, 16, v23
    v_and_b32 v47, 0xffff0000, v23
    v_lshlrev_b32 v48, 16, v24
    v_and_b32 v49, 0xffff0000, v24
    v_lshlrev_b32 v50, 16, v25
    v_and_b32 v51, 0xffff0000, v25
    v_lshlrev_b32 v52, 16, v26
    v_and_b32 v53, 0xffff0000, v26
    v_lshlrev_b32 v54, 16, v27
    v_and_b32 v55, 0xffff0000, v27
    global_load_lds_dwordx4 v236, s[80:81] offset:2048
    global_load_lds_dwordx4 v237, s[80:81] offset:3072
    s_add_u32 s80, s80, 110592
    s_addc_u32 s81, s81, 0
    v_pk_add_f32 v[32:33], v[32:33], v[124:125]
    v_pk_add_f32 v[34:35], v[34:35], v[126:127]
    v_pk_add_f32 v[36:37], v[36:37], v[128:129]
    v_pk_add_f32 v[38:39], v[38:39], v[130:131]
    v_pk_add_f32 v[40:41], v[40:41], v[132:133]
    v_pk_add_f32 v[42:43], v[42:43], v[134:135]
    v_pk_add_f32 v[44:45], v[44:45], v[136:137]
    v_pk_add_f32 v[46:47], v[46:47], v[138:139]
    v_pk_add_f32 v[48:49], v[48:49], v[140:141]
    v_pk_add_f32 v[50:51], v[50:51], v[142:143]
    v_pk_add_f32 v[52:53], v[52:53], v[144:145]
    v_pk_add_f32 v[54:55], v[54:55], v[146:147]
    v_cvt_pk_bf16_f32 v16, v32, v33
    v_cvt_pk_bf16_f32 v17, v34, v35
    v_cvt_pk_bf16_f32 v18, v36, v37
    v_cvt_pk_bf16_f32 v19, v38, v39
    s_mov_b32 m0, s82
    s_add_u32 s82, s82, 4096
    global_load_lds_dwordx4 v234, s[80:81]
    global_load_lds_dwordx4 v235, s[80:81] offset:1024
    v_cvt_pk_bf16_f32 v20, v40, v41
    v_cvt_pk_bf16_f32 v21, v42, v43
    v_cvt_pk_bf16_f32 v22, v44, v45
    v_cvt_pk_bf16_f32 v23, v46, v47
    v_cvt_pk_bf16_f32 v24, v48, v49
    v_cvt_pk_bf16_f32 v25, v50, v51
    v_cvt_pk_bf16_f32 v26, v52, v53
    v_cvt_pk_bf16_f32 v27, v54, v55
    v_lshlrev_b32 v32, 16, v16
    v_and_b32 v33, 0xffff0000, v16
    v_lshlrev_b32 v34, 16, v17
    v_and_b32 v35, 0xffff0000, v17
    v_lshlrev_b32 v36, 16, v18
    v_and_b32 v37, 0xffff0000, v18
    v_lshlrev_b32 v38, 16, v19
    v_and_b32 v39, 0xffff0000, v19
    global_load_lds_dwordx4 v236, s[80:81] offset:2048
    global_load_lds_dwordx4 v237, s[80:81] offset:3072
    s_add_u32 s80, s80, 110592
    s_addc_u32 s81, s81, 0
    v_lshlrev_b32 v40, 16, v20
    v_and_b32 v41, 0xffff0000, v20
    v_lshlrev_b32 v42, 16, v21
    v_and_b32 v43, 0xffff0000, v21
    v_lshlrev_b32 v44, 16, v22
    v_and_b32 v45, 0xffff0000, v22
    v_lshlrev_b32 v46, 16, v23
    v_and_b32 v47, 0xffff0000, v23
    v_lshlrev_b32 v48, 16, v24
    v_and_b32 v49, 0xffff0000, v24
    v_lshlrev_b32 v50, 16, v25
    v_and_b32 v51, 0xffff0000, v25
    v_lshlrev_b32 v52, 16, v26
    v_and_b32 v53, 0xffff0000, v26
    v_lshlrev_b32 v54, 16, v27
    v_and_b32 v55, 0xffff0000, v27
    s_mov_b32 m0, s82
    s_add_u32 s82, s82, 4096
    global_load_lds_dwordx4 v234, s[80:81]
    global_load_lds_dwordx4 v235, s[80:81] offset:1024
    v_pk_add_f32 v[32:33], v[32:33], v[100:101]
    v_pk_add_f32 v[34:35], v[34:35], v[102:103]
    v_pk_add_f32 v[36:37], v[36:37], v[104:105]
    v_pk_add_f32 v[38:39], v[38:39], v[106:107]
    v_pk_add_f32 v[40:41], v[40:41], v[108:109]
    v_pk_add_f32 v[42:43], v[42:43], v[110:111]
    v_pk_add_f32 v[44:45], v[44:45], v[112:113]
    v_pk_add_f32 v[46:47], v[46:47], v[114:115]
    v_pk_add_f32 v[48:49], v[48:49], v[116:117]
    v_pk_add_f32 v[50:51], v[50:51], v[118:119]
    v_pk_add_f32 v[52:53], v[52:53], v[120:121]
    v_pk_add_f32 v[54:55], v[54:55], v[122:123]
    v_cvt_pk_bf16_f32 v150, v32, v33
    v_cvt_pk_bf16_f32 v151, v34, v35
    v_cvt_pk_bf16_f32 v152, v36, v37
    v_cvt_pk_bf16_f32 v153, v38, v39
    global_load_lds_dwordx4 v236, s[80:81] offset:2048
    global_load_lds_dwordx4 v237, s[80:81] offset:3072
    s_add_u32 s80, s80, 110592
    s_addc_u32 s81, s81, 0
    v_cvt_pk_bf16_f32 v154, v40, v41
    v_cvt_pk_bf16_f32 v155, v42, v43
    v_cvt_pk_bf16_f32 v156, v44, v45
    v_cvt_pk_bf16_f32 v157, v46, v47
    v_cvt_pk_bf16_f32 v158, v48, v49
    v_cvt_pk_bf16_f32 v159, v50, v51
    v_cvt_pk_bf16_f32 v160, v52, v53
    v_cvt_pk_bf16_f32 v161, v54, v55
    s_cmp_lt_u32 s3, 2
    s_cbranch_scc1 L_hz_17
    v_mov_b32 v158, 0
    v_mov_b32 v159, 0
    v_mov_b32 v160, 0
    v_mov_b32 v161, 0
L_hz_17:
    v_lshlrev_b32 v32, 16, v150
    v_and_b32 v33, 0xffff0000, v150
    v_lshlrev_b32 v34, 16, v151
    v_and_b32 v35, 0xffff0000, v151
    v_lshlrev_b32 v36, 16, v152
    v_and_b32 v37, 0xffff0000, v152
    v_lshlrev_b32 v38, 16, v153
    v_and_b32 v39, 0xffff0000, v153
    v_lshlrev_b32 v40, 16, v154
    v_and_b32 v41, 0xffff0000, v154
    v_lshlrev_b32 v42, 16, v155
    v_and_b32 v43, 0xffff0000, v155
    v_lshlrev_b32 v44, 16, v156
    v_and_b32 v45, 0xffff0000, v156
    v_lshlrev_b32 v46, 16, v157
    v_and_b32 v47, 0xffff0000, v157
    v_lshlrev_b32 v48, 16, v158
    v_and_b32 v49, 0xffff0000, v158
    v_lshlrev_b32 v50, 16, v159
    v_and_b32 v51, 0xffff0000, v159
    v_lshlrev_b32 v52, 16, v160
    v_and_b32 v53, 0xffff0000, v160
    v_lshlrev_b32 v54, 16, v161
    v_and_b32 v55, 0xffff0000, v161
    v_pk_add_f32 v[64:65], v[32:33], v[40:41]
    v_pk_mul_f32 v[72:73], v[32:33], v[32:33]
    v_pk_add_f32 v[66:67], v[34:35], v[42:43]
    v_pk_mul_f32 v[74:75], v[34:35], v[34:35]
    v_pk_add_f32 v[68:69], v[36:37], v[44:45]
    v_pk_mul_f32 v[76:77], v[36:37], v[36:37]
    v_pk_add_f32 v[70:71], v[38:39], v[46:47]
    v_pk_mul_f32 v[78:79], v[38:39], v[38:39]
    v_pk_add_f32 v[64:65], v[64:65], v[48:49]
    v_pk_fma_f32 v[72:73], v[40:41], v[40:41], v[72:73]
    v_pk_add_f32 v[66:67], v[66:67], v[50:51]
    v_pk_fma_f32 v[74:75], v[42:43], v[42:43], v[74:75]
    v_pk_add_f32 v[68:69], v[68:69], v[52:53]
    v_pk_fma_f32 v[76:77], v[44:45], v[44:45], v[76:77]
    v_pk_add_f32 v[70:71], v[70:71], v[54:55]
    v_pk_fma_f32 v[78:79], v[46:47], v[46:47], v[78:79]
    v_pk_fma_f32 v[72:73], v[48:49], v[48:49], v[72:73]
    v_pk_fma_f32 v[74:75], v[50:51], v[50:51], v[74:75]
    v_pk_fma_f32 v[76:77], v[52:53], v[52:53], v[76:77]
    v_pk_fma_f32 v[78:79], v[54:55], v[54:55], v[78:79]
    v_permlane32_swap_b32 v64, v72
    v_permlane32_swap_b32 v65, v73
    v_permlane32_swap_b32 v66, v74
    v_permlane32_swap_b32 v67, v75
    v_permlane32_swap_b32 v68, v76
    v_permlane32_swap_b32 v69, v77
    v_permlane32_swap_b32 v70, v78
    v_permlane32_swap_b32 v71, v79
    v_pk_add_f32 v[64:65], v[64:65], v[72:73]
    v_pk_add_f32 v[66:67], v[66:67], v[74:75]
    v_pk_add_f32 v[68:69], v[68:69], v[76:77]
    v_pk_add_f32 v[70:71], v[70:71], v[78:79]
    s_nop 0
    v_permlane16_swap_b32 v64, v68
    v_permlane16_swap_b32 v65, v69
    v_permlane16_swap_b32 v66, v70
    v_permlane16_swap_b32 v67, v71
    v_pk_add_f32 v[64:65], v[64:65], v[68:69]
    v_pk_add_f32 v[66:67], v[66:67], v[70:71]
    s_nop 0
    v_add_f32_dpp v72, v64, v64 row_ror:8 row_mask:0xf bank_mask:0x3
    v_add_f32_dpp v73, v65, v65 row_ror:8 row_mask:0xf bank_mask:0x3
    s_nop 0
    v_add_f32_dpp v72, v66, v66 row_ror:8 row_mask:0xf bank_mask:0xc
    v_add_f32_dpp v73, v67, v67 row_ror:8 row_mask:0xf bank_mask:0xc
    s_nop 0
    v_add_f32_dpp v64, v72, v72 row_half_mirror row_mask:0xf bank_mask:0x5
    s_nop 1
    v_add_f32_dpp v64, v73, v73 row_half_mirror row_mask:0xf bank_mask:0xa
    s_nop 1
    v_add_f32_dpp v64, v64, v64 quad_perm:[1,0,3,2] row_mask:0xf bank_mask:0xf
    s_nop 1
    v_add_f32_dpp v64, v64, v64 quad_perm:[2,3,0,1] row_mask:0xf bank_mask:0xf
    ds_write_b32 v179, v64
    s_mov_b32 s69, 0
    s_waitcnt vmcnt(63)
L_pdpoll_18:
    v_cmp_ne_u32 vcc, s10, v193
    s_cbranch_vccz L_pdok_19
    s_add_u32 s69, s69, 1
    s_cmp_gt_u32 s69, 200000
    s_cbranch_scc1 L_pdok_19
    s_sleep 4
    global_load_dword v193, v233, s[52:53] sc1
    s_waitcnt vmcnt(0)
    s_branch L_pdpoll_18
L_pdok_19:
    v_min_u32 v150, 0xfffffffe, v150
    v_min_u32 v151, 0xfffffffe, v151
    v_min_u32 v152, 0xfffffffe, v152
    v_min_u32 v153, 0xfffffffe, v153
    v_min_u32 v154, 0xfffffffe, v154
    v_min_u32 v155, 0xfffffffe, v155
    v_min_u32 v156, 0xfffffffe, v156
    v_min_u32 v157, 0xfffffffe, v157
    v_min_u32 v158, 0xfffffffe, v158
    v_min_u32 v159, 0xfffffffe, v159
    v_min_u32 v160, 0xfffffffe, v160
    v_min_u32 v161, 0xfffffffe, v161
    s_waitcnt lgkmcnt(0)
    s_barrier
    ds_read_b32 v64, v180 offset:0
    ds_read_b32 v65, v180 offset:256
    ds_read_b32 v66, v180 offset:512
    ds_read_b32 v67, v180 offset:768
    s_waitcnt lgkmcnt(0)
    v_pk_add_f32 v[64:65], v[64:65], v[66:67]
    v_add_f32 v64, v64, v65
    v_mul_f32 v64, 0x3acccccd, v64
    v_mov_b32 v65, v64
    s_nop 1
    v_permlane32_swap_b32 v64, v65
    v_fma_f32 v65, -v64, v64, v65
    v_max_f32 v65, 0, v65
    v_cvt_pk_bf16_f32 v67, v65, v65
    v_and_b32 v67, 0xffff0000, v67
    v_cvt_pk_bf16_f32 v66, v64, v64
    v_and_b32 v66, 0xffff0000, v66
    v_add_f32 v67, 0x3727c5ac, v67
    v_cvt_pk_bf16_f32 v67, v67, v67
    v_and_b32 v67, 0xffff0000, v67
    v_sqrt_f32 v67, v67
    v_sub_f32 v68, v64, v66
    v_cvt_pk_bf16_f32 v67, v67, v67
    v_and_b32 v67, 0xffff0000, v67
    v_rcp_f32 v67, v67
    s_nop 0
    v_mul_f32 v69, v65, v67
    v_mul_f32 v68, v68, v67
    v_mul_f32 v69, v69, v67
    v_cvt_pk_bf16_f32 v69, v69, v69
    v_and_b32 v69, 0xffff0000, v69
    v_cvt_pk_bf16_f32 v68, v68, v68
    v_and_b32 v68, 0xffff0000, v68
    v_add_f32 v69, 0x3727c5ac, v69
    v_cvt_pk_bf16_f32 v69, v69, v69
    v_and_b32 v69, 0xffff0000, v69
    v_sqrt_f32 v69, v69
    v_fma_f32 v70, v66, v67, v68
    v_cvt_pk_bf16_f32 v69, v69, v69
    v_and_b32 v69, 0xffff0000, v69
    v_rcp_f32 v69, v69
    s_nop 0
    v_mul_f32 v70, -v70, v69
    v_mul_f32 v71, v67, v69
    v_readlane_b32 s54, v70, 0
    v_readlane_b32 s55, v70, 4
    v_readlane_b32 s56, v70, 8
    v_readlane_b32 s57, v70, 12
    v_readlane_b32 s58, v70, 16
    v_readlane_b32 s59, v70, 20
    v_readlane_b32 s60, v70, 24
    v_readlane_b32 s61, v70, 28
    v_readlane_b32 s62, v71, 0
    v_readlane_b32 s63, v71, 4
    v_readlane_b32 s64, v71, 8
    v_readlane_b32 s65, v71, 12
    v_readlane_b32 s66, v71, 16
    v_readlane_b32 s67, v71, 20
    v_readlane_b32 s70, v71, 24
    v_readlane_b32 s71, v71, 28
    v_mov_b32 v72, s54
    v_mov_b32 v73, s55
    v_mov_b32 v74, s56
    v_mov_b32 v75, s57
    v_mov_b32 v76, s58
    v_mov_b32 v77, s59
    v_mov_b32 v78, s60
    v_mov_b32 v79, s61
    v_pk_fma_f32 v[32:33], v[32:33], s[62:63], v[72:73]
    v_pk_fma_f32 v[34:35], v[34:35], s[64:65], v[74:75]
    v_pk_fma_f32 v[36:37], v[36:37], s[66:67], v[76:77]
    v_pk_fma_f32 v[38:39], v[38:39], s[70:71], v[78:79]
    v_cvt_pk_bf16_f32 v16, v32, v33
    v_cvt_pk_bf16_f32 v17, v34, v35
    v_cvt_pk_bf16_f32 v18, v36, v37
    v_cvt_pk_bf16_f32 v19, v38, v39
    v_min_u32 v16, 0xfffffffe, v16
    v_min_u32 v17, 0xfffffffe, v17
    v_min_u32 v18, 0xfffffffe, v18
    v_min_u32 v19, 0xfffffffe, v19
    global_store_dwordx4 v173, v[16:19], s[48:49] sc1
    v_pk_fma_f32 v[40:41], v[40:41], s[62:63], v[72:73]
    v_pk_fma_f32 v[42:43], v[42:43], s[64:65], v[74:75]
    v_pk_fma_f32 v[44:45], v[44:45], s[66:67], v[76:77]
    v_pk_fma_f32 v[46:47], v[46:47], s[70:71], v[78:79]
    v_cvt_pk_bf16_f32 v20, v40, v41
    v_cvt_pk_bf16_f32 v21, v42, v43
    v_cvt_pk_bf16_f32 v22, v44, v45
    v_cvt_pk_bf16_f32 v23, v46, v47
    v_min_u32 v20, 0xfffffffe, v20
    v_min_u32 v21, 0xfffffffe, v21
    v_min_u32 v22, 0xfffffffe, v22
    v_min_u32 v23, 0xfffffffe, v23
    global_store_dwordx4 v174, v[20:23], s[48:49] sc1
    s_cmp_ge_u32 s3, 2
    s_cbranch_scc1 L_h3_20
    v_pk_fma_f32 v[48:49], v[48:49], s[62:63], v[72:73]
    v_pk_fma_f32 v[50:51], v[50:51], s[64:65], v[74:75]
    v_pk_fma_f32 v[52:53], v[52:53], s[66:67], v[76:77]
    v_pk_fma_f32 v[54:55], v[54:55], s[70:71], v[78:79]
    v_cvt_pk_bf16_f32 v24, v48, v49
    v_cvt_pk_bf16_f32 v25, v50, v51
    v_cvt_pk_bf16_f32 v26, v52, v53
    v_cvt_pk_bf16_f32 v27, v54, v55
    v_min_u32 v24, 0xfffffffe, v24
    v_min_u32 v25, 0xfffffffe, v25
    v_min_u32 v26, 0xfffffffe, v26
    v_min_u32 v27, 0xfffffffe, v27
    global_store_dwordx4 v175, v[24:27], s[48:49] sc1
    global_store_dwordx4 v178, v[158:161], s[14:15] sc1
L_h3_20:
    global_store_dwordx4 v176, v[150:153], s[14:15] sc1
    global_store_dwordx4 v177, v[154:157], s[14:15] sc1
    s_lshl_b32 s90, s92, 5
    s_lshl_b32 s91, s78, 7
    v_lshrrev_b32 v28, 3, v1
    v_and_b32 v29, 7, v1
    v_and_b32 v30, 2, v28
    v_xor_b32 v29, v29, v30
    v_mul_u32_u24 v28, 4096, v28
    v_lshl_add_u32 v234, v29, 4, v28
    v_xor_b32 v29, 4, v29
    v_lshl_add_u32 v235, v29, 4, v28
    v_add_u32 v235, 31744, v235
    v_add_u32 v236, 63488, v234
    v_add_u32 v237, 63488, v235
    s_mul_i32 s54, s90, 4096
    s_add_u32 s54, s54, s91
    s_add_u32 s80, s36, s54
    s_addc_u32 s81, s37, 0
    s_waitcnt lgkmcnt(0)
    s_cmp_eq_u32 s79, 0
    s_cbranch_scc1 L_nog1_21
    s_mov_b32 s69, 0
    s_mul_i32 s82, s3, 32768
    s_mov_b32 m0, s82
    s_add_u32 s82, s82, 4096
    global_load_lds_dwordx4 v234, s[80:81]
    global_load_lds_dwordx4 v235, s[80:81] offset:1024
    global_load_lds_dwordx4 v236, s[80:81] offset:2048
    global_load_lds_dwordx4 v237, s[80:81] offset:3072
    s_add_u32 s80, s80, 131072
    s_addc_u32 s81, s81, 0
    s_mov_b32 m0, s82
    s_add_u32 s82, s82, 4096
    global_load_lds_dwordx4 v234, s[80:81]
    global_load_lds_dwordx4 v235, s[80:81] offset:1024
    global_load_lds_dwordx4 v236, s[80:81] offset:2048
    global_load_lds_dwordx4 v237, s[80:81] offset:3072
    s_add_u32 s80, s80, 131072
    s_addc_u32 s81, s81, 0
    s_mov_b32 m0, s82
    s_add_u32 s82, s82, 4096
    global_load_lds_dwordx4 v234, s[80:81]
    global_load_lds_dwordx4 v235, s[80:81] offset:1024
    global_load_lds_dwordx4 v236, s[80:81] offset:2048
    global_load_lds_dwordx4 v237, s[80:81] offset:3072
    s_add_u32 s80, s80, 131072
    s_addc_u32 s81, s81, 0
    s_mov_b32 m0, s82
    s_add_u32 s82, s82, 4096
    global_load_lds_dwordx4 v234, s[80:81]
    global_load_lds_dwordx4 v235, s[80:81] offset:1024
    global_load_lds_dwordx4 v236, s[80:81] offset:2048
    global_load_lds_dwordx4 v237, s[80:81] offset:3072
    s_add_u32 s80, s80, 131072
    s_addc_u32 s81, s81, 0
    s_mov_b32 m0, s82
    s_add_u32 s82, s82, 4096
    global_load_lds_dwordx4 v234, s[80:81]
    global_load_lds_dwordx4 v235, s[80:81] offset:1024
    global_load_lds_dwordx4 v236, s[80:81] offset:2048
    global_load_lds_dwordx4 v237, s[80:81] offset:3072
    s_add_u32 s80, s80, 131072
    s_addc_u32 s81, s81, 0
    global_load_dwordx4 v[94:97], v2, s[84:85] offset:-4096 sc1
    global_load_dwordx4 v[98:101], v3, s[84:85] offset:-4096 sc1
    global_load_dwordx4 v[102:105], v4, s[84:85] offset:-4096 sc1
    s_waitcnt vmcnt(0)
    global_load_dwordx4 v[106:109], v2, s[84:85] offset:-3072 sc1
    global_load_dwordx4 v[110:113], v3, s[84:85] offset:-3072 sc1
    global_load_dwordx4 v[114:117], v4, s[84:85] offset:-3072 sc1
    global_load_dwordx4 v[118:121], v2, s[84:85] offset:-2048 sc1
    global_load_dwordx4 v[122:125], v3, s[84:85] offset:-2048 sc1
    global_load_dwordx4 v[126:129], v4, s[84:85] offset:-2048 sc1
    global_load_dwordx4 v[130:133], v2, s[84:85] offset:-1024 sc1
    v_max3_u32 v7, v94, v95, v96
    v_max3_u32 v8, v97, v98, v99
    v_max3_u32 v7, v7, v100, v101
    v_max3_u32 v8, v8, v102, v103
    v_max3_u32 v7, v7, v104, v105
    v_max_u32 v7, v7, v8
    v_cmp_eq_u32 vcc, -1, v7
    s_cbranch_vccnz L_gslow_23
L_gback_24:
    v_mfma_f32_16x16x32_bf16 v[14:17], a[0:3], v[94:97], 0
    ds_read_b64_tr_b16 a[208:209], v238 offset:20480
    v_mfma_f32_16x16x32_bf16 v[18:21], a[4:7], v[94:97], 0
    ds_read_b64_tr_b16 a[210:211], v238 offset:20992
    global_load_dwordx4 v[134:137], v3, s[84:85] offset:-1024 sc1
    v_mfma_f32_16x16x32_bf16 v[22:25], a[8:11], v[94:97], 0
    ds_read_b64_tr_b16 a[212:213], v239 offset:20480
    ds_read_b64_tr_b16 a[214:215], v239 offset:20992
    v_mfma_f32_16x16x32_bf16 v[26:29], a[12:15], v[94:97], 0
    ds_read_b64_tr_b16 a[216:217], v240 offset:20480
    v_mfma_f32_16x16x32_bf16 v[30:33], a[0:3], v[98:101], 0
    ds_read_b64_tr_b16 a[218:219], v240 offset:20992
    v_mfma_f32_16x16x32_bf16 v[34:37], a[4:7], v[98:101], 0
    global_load_dwordx4 v[138:141], v4, s[84:85] offset:-1024 sc1
    ds_read_b64_tr_b16 a[220:221], v241 offset:20480
    ds_read_b64_tr_b16 a[222:223], v241 offset:20992
    v_mfma_f32_16x16x32_bf16 v[38:41], a[8:11], v[98:101], 0
    s_waitcnt vmcnt(6)
    global_load_dwordx4 v[142:145], v2, s[84:85] offset:0 sc1
    global_load_dwordx4 v[146:149], v3, s[84:85] offset:0 sc1
    global_load_dwordx4 v[150:153], v4, s[84:85] offset:0 sc1
    global_load_dwordx4 v[154:157], v2, s[84:85] offset:1024 sc1
    global_load_dwordx4 v[158:161], v3, s[84:85] offset:1024 sc1
    global_load_dwordx4 v[162:165], v4, s[84:85] offset:1024 sc1
    global_load_dwordx4 v[166:169], v2, s[84:85] offset:2048 sc1
    v_mfma_f32_16x16x32_bf16 v[42:45], a[12:15], v[98:101], 0
    v_max3_u32 v7, v106, v107, v108
    v_mfma_f32_16x16x32_bf16 v[46:49], a[0:3], v[102:105], 0
    v_max3_u32 v8, v109, v110, v111
    v_max3_u32 v7, v7, v112, v113
    v_mfma_f32_16x16x32_bf16 v[50:53], a[4:7], v[102:105], 0
    v_max3_u32 v8, v8, v114, v115
    v_mfma_f32_16x16x32_bf16 v[54:57], a[8:11], v[102:105], 0
    v_max3_u32 v7, v7, v116, v117
    v_mfma_f32_16x16x32_bf16 v[58:61], a[12:15], v[102:105], 0
    global_load_dwordx4 v[170:173], v3, s[84:85] offset:2048 sc1
    v_max_u32 v7, v7, v8
    v_cmp_eq_u32 vcc, -1, v7
    s_cbranch_vccnz L_gslow_25
L_gback_26:
    v_mfma_f32_16x16x32_bf16 v[14:17], a[16:19], v[106:109], v[14:17]
    ds_read_b64_tr_b16 a[224:225], v238 offset:24576
    v_mfma_f32_16x16x32_bf16 v[18:21], a[20:23], v[106:109], v[18:21]
    ds_read_b64_tr_b16 a[226:227], v238 offset:25088
    v_mfma_f32_16x16x32_bf16 v[22:25], a[24:27], v[106:109], v[22:25]
    ds_read_b64_tr_b16 a[228:229], v239 offset:24576
    global_load_dwordx4 v[174:177], v4, s[84:85] offset:2048 sc1
    ds_read_b64_tr_b16 a[230:231], v239 offset:25088
    v_mfma_f32_16x16x32_bf16 v[26:29], a[28:31], v[106:109], v[26:29]
    ds_read_b64_tr_b16 a[232:233], v240 offset:24576
    v_mfma_f32_16x16x32_bf16 v[30:33], a[16:19], v[110:113], v[30:33]
    ds_read_b64_tr_b16 a[234:235], v240 offset:25088
    v_mfma_f32_16x16x32_bf16 v[34:37], a[20:23], v[110:113], v[34:37]
    ds_read_b64_tr_b16 a[236:237], v241 offset:24576
    ds_read_b64_tr_b16 a[238:239], v241 offset:25088
    global_load_dwordx4 v[178:181], v2, s[84:85] offset:3072 sc1
    v_mfma_f32_16x16x32_bf16 v[38:41], a[24:27], v[110:113], v[38:41]
    s_waitcnt vmcnt(13)
    v_mfma_f32_16x16x32_bf16 v[42:45], a[28:31], v[110:113], v[42:45]
    v_max3_u32 v7, v118, v119, v120
    v_mfma_f32_16x16x32_bf16 v[46:49], a[16:19], v[114:117], v[46:49]
    v_max3_u32 v8, v121, v122, v123
    v_max3_u32 v7, v7, v124, v125
    v_mfma_f32_16x16x32_bf16 v[50:53], a[20:23], v[114:117], v[50:53]
    v_max3_u32 v8, v8, v126, v127
    global_load_dwordx4 v[182:185], v3, s[84:85] offset:3072 sc1
    v_mfma_f32_16x16x32_bf16 v[54:57], a[24:27], v[114:117], v[54:57]
    v_max3_u32 v7, v7, v128, v129
    v_mfma_f32_16x16x32_bf16 v[58:61], a[28:31], v[114:117], v[58:61]
    v_max_u32 v7, v7, v8
    v_cmp_eq_u32 vcc, -1, v7
    s_cbranch_vccnz L_gslow_27
L_gback_28:
    v_mfma_f32_16x16x32_bf16 v[14:17], a[32:35], v[118:121], v[14:17]
    ds_read_b64_tr_b16 a[240:241], v238 offset:28672
    v_mfma_f32_16x16x32_bf16 v[18:21], a[36:39], v[118:121], v[18:21]
    ds_read_b64_tr_b16 a[242:243], v238 offset:29184
    global_load_dwordx4 v[186:189], v4, s[84:85] offset:3072 sc1
    v_mfma_f32_16x16x32_bf16 v[22:25], a[40:43], v[118:121], v[22:25]
    ds_read_b64_tr_b16 a[244:245], v239 offset:28672
    ds_read_b64_tr_b16 a[246:247], v239 offset:29184
    v_mfma_f32_16x16x32_bf16 v[26:29], a[44:47], v[118:121], v[26:29]
    ds_read_b64_tr_b16 a[248:249], v240 offset:28672
    v_mfma_f32_16x16x32_bf16 v[30:33], a[32:35], v[122:125], v[30:33]
    ds_read_b64_tr_b16 a[250:251], v240 offset:29184
    v_mfma_f32_16x16x32_bf16 v[34:37], a[36:39], v[122:125], v[34:37]
    global_load_dwordx4 v[190:193], v2, s[86:87] offset:-4096 sc1
    ds_read_b64_tr_b16 a[252:253], v241 offset:28672
    ds_read_b64_tr_b16 a[254:255], v241 offset:29184
    v_mfma_f32_16x16x32_bf16 v[38:41], a[40:43], v[122:125], v[38:41]
    s_waitcnt vmcnt(13)
    v_mfma_f32_16x16x32_bf16 v[42:45], a[44:47], v[122:125], v[42:45]
    v_max3_u32 v7, v130, v131, v132
    v_mfma_f32_16x16x32_bf16 v[46:49], a[32:35], v[126:129], v[46:49]
    v_max3_u32 v8, v133, v134, v135
    v_max3_u32 v7, v7, v136, v137
    global_load_dwordx4 v[194:197], v3, s[86:87] offset:-4096 sc1
    v_mfma_f32_16x16x32_bf16 v[50:53], a[36:39], v[126:129], v[50:53]
    v_max3_u32 v8, v8, v138, v139
    v_mfma_f32_16x16x32_bf16 v[54:57], a[40:43], v[126:129], v[54:57]
    v_max3_u32 v7, v7, v140, v141
    v_mfma_f32_16x16x32_bf16 v[58:61], a[44:47], v[126:129], v[58:61]
    v_max_u32 v7, v7, v8
    v_cmp_eq_u32 vcc, -1, v7
    s_cbranch_vccnz L_gslow_29
L_gback_30:
    v_mfma_f32_16x16x32_bf16 v[14:17], a[48:51], v[130:133], v[14:17]
    v_mfma_f32_16x16x32_bf16 v[18:21], a[52:55], v[130:133], v[18:21]
    global_load_dwordx4 v[198:201], v4, s[86:87] offset:-4096 sc1
    s_waitcnt vmcnt(12)
    global_load_dwordx4 v[202:205], v2, s[86:87] offset:-3072 sc1
    global_load_dwordx4 v[206:209], v3, s[86:87] offset:-3072 sc1
    global_load_dwordx4 v[210:213], v4, s[86:87] offset:-3072 sc1
    global_load_dwordx4 v[214:217], v2, s[86:87] offset:-2048 sc1
    global_load_dwordx4 v[218:221], v3, s[86:87] offset:-2048 sc1
    v_mfma_f32_16x16x32_bf16 v[22:25], a[56:59], v[130:133], v[22:25]
    v_max3_u32 v7, v142, v143, v144
    v_mfma_f32_16x16x32_bf16 v[26:29], a[60:63], v[130:133], v[26:29]
    v_mfma_f32_16x16x32_bf16 v[30:33], a[48:51], v[134:137], v[30:33]
    v_max3_u32 v8, v145, v146, v147
    v_mfma_f32_16x16x32_bf16 v[34:37], a[52:55], v[134:137], v[34:37]
    v_max3_u32 v7, v7, v148, v149
    v_mfma_f32_16x16x32_bf16 v[38:41], a[56:59], v[134:137], v[38:41]
    global_load_dwordx4 v[222:225], v4, s[86:87] offset:-2048 sc1
    v_mfma_f32_16x16x32_bf16 v[42:45], a[60:63], v[134:137], v[42:45]
    v_max3_u32 v8, v8, v150, v151
    v_mfma_f32_16x16x32_bf16 v[46:49], a[48:51], v[138:141], v[46:49]
    v_max3_u32 v7, v7, v152, v153
    v_mfma_f32_16x16x32_bf16 v[50:53], a[52:55], v[138:141], v[50:53]
    v_mfma_f32_16x16x32_bf16 v[54:57], a[56:59], v[138:141], v[54:57]
    global_load_dwordx4 v[226:229], v2, s[86:87] offset:-1024 sc1
    v_max_u32 v7, v7, v8
    v_mfma_f32_16x16x32_bf16 v[58:61], a[60:63], v[138:141], v[58:61]
    v_cmp_eq_u32 vcc, -1, v7
    s_cbranch_vccnz L_gslow_31
L_gback_32:
    v_mfma_f32_16x16x32_bf16 v[14:17], a[64:67], v[142:145], v[14:17]
    v_mfma_f32_16x16x32_bf16 v[18:21], a[68:71], v[142:145], v[18:21]
    s_mov_b64 exec, 1
    global_store_dword v254, v9, s[52:53] sc1
    s_mov_b64 exec, -1
    v_mfma_f32_16x16x32_bf16 v[22:25], a[72:75], v[142:145], v[22:25]
    global_load_dwordx4 v[230:233], v3, s[86:87] offset:-1024 sc1
    s_waitcnt vmcnt(18)
    v_mfma_f32_16x16x32_bf16 v[26:29], a[76:79], v[142:145], v[26:29]
    v_max3_u32 v7, v154, v155, v156
    v_mfma_f32_16x16x32_bf16 v[30:33], a[64:67], v[146:149], v[30:33]
    v_mfma_f32_16x16x32_bf16 v[34:37], a[68:71], v[146:149], v[34:37]
    v_max3_u32 v8, v157, v158, v159
    v_mfma_f32_16x16x32_bf16 v[38:41], a[72:75], v[146:149], v[38:41]
    v_max3_u32 v7, v7, v160, v161
    global_load_dwordx4 v[94:97], v4, s[86:87] offset:-1024 sc1
    v_mfma_f32_16x16x32_bf16 v[42:45], a[76:79], v[146:149], v[42:45]
    v_max3_u32 v8, v8, v162, v163
    v_mfma_f32_16x16x32_bf16 v[46:49], a[64:67], v[150:153], v[46:49]
    v_mfma_f32_16x16x32_bf16 v[50:53], a[68:71], v[150:153], v[50:53]
    v_max3_u32 v7, v7, v164, v165
    v_mfma_f32_16x16x32_bf16 v[54:57], a[72:75], v[150:153], v[54:57]
    v_max_u32 v7, v7, v8
    v_mfma_f32_16x16x32_bf16 v[58:61], a[76:79], v[150:153], v[58:61]
    global_load_dwordx4 v[98:101], v2, s[86:87] offset:0 sc1
    v_cmp_eq_u32 vcc, -1, v7
    s_cbranch_vccnz L_gslow_33
L_gback_34:
    v_mfma_f32_16x16x32_bf16 v[14:17], a[80:83], v[154:157], v[14:17]
    v_mfma_f32_16x16x32_bf16 v[18:21], a[84:87], v[154:157], v[18:21]
    s_waitcnt vmcnt(17)
    v_mfma_f32_16x16x32_bf16 v[22:25], a[88:91], v[154:157], v[22:25]
    v_max3_u32 v7, v166, v167, v168
    v_mfma_f32_16x16x32_bf16 v[26:29], a[92:95], v[154:157], v[26:29]
    global_load_dwordx4 v[102:105], v3, s[86:87] offset:0 sc1
    v_mfma_f32_16x16x32_bf16 v[30:33], a[80:83], v[158:161], v[30:33]
    v_max3_u32 v8, v169, v170, v171
    v_mfma_f32_16x16x32_bf16 v[34:37], a[84:87], v[158:161], v[34:37]
    v_max3_u32 v7, v7, v172, v173
    v_mfma_f32_16x16x32_bf16 v[38:41], a[88:91], v[158:161], v[38:41]
    v_mfma_f32_16x16x32_bf16 v[42:45], a[92:95], v[158:161], v[42:45]
    global_load_dwordx4 v[106:109], v4, s[86:87] offset:0 sc1
    v_max3_u32 v8, v8, v174, v175
    v_mfma_f32_16x16x32_bf16 v[46:49], a[80:83], v[162:165], v[46:49]
    v_max3_u32 v7, v7, v176, v177
    v_mfma_f32_16x16x32_bf16 v[50:53], a[84:87], v[162:165], v[50:53]
    v_mfma_f32_16x16x32_bf16 v[54:57], a[88:91], v[162:165], v[54:57]
    v_max_u32 v7, v7, v8
    v_mfma_f32_16x16x32_bf16 v[58:61], a[92:95], v[162:165], v[58:61]
    v_cmp_eq_u32 vcc, -1, v7
    global_load_dwordx4 v[110:113], v2, s[86:87] offset:1024 sc1
    s_cbranch_vccnz L_gslow_35
L_gback_36:
    v_mfma_f32_16x16x32_bf16 v[14:17], a[96:99], v[166:169], v[14:17]
    v_mfma_f32_16x16x32_bf16 v[18:21], a[100:103], v[166:169], v[18:21]
    s_waitcnt vmcnt(17)
    v_mfma_f32_16x16x32_bf16 v[22:25], a[104:107], v[166:169], v[22:25]
    v_max3_u32 v7, v178, v179, v180
    v_mfma_f32_16x16x32_bf16 v[26:29], a[108:111], v[166:169], v[26:29]
    global_load_dwordx4 v[114:117], v3, s[86:87] offset:1024 sc1
    v_mfma_f32_16x16x32_bf16 v[30:33], a[96:99], v[170:173], v[30:33]
    v_max3_u32 v8, v181, v182, v183
    v_mfma_f32_16x16x32_bf16 v[34:37], a[100:103], v[170:173], v[34:37]
    v_max3_u32 v7, v7, v184, v185
    v_mfma_f32_16x16x32_bf16 v[38:41], a[104:107], v[170:173], v[38:41]
    v_mfma_f32_16x16x32_bf16 v[42:45], a[108:111], v[170:173], v[42:45]
    global_load_dwordx4 v[118:121], v4, s[86:87] offset:1024 sc1
    v_max3_u32 v8, v8, v186, v187
    v_mfma_f32_16x16x32_bf16 v[46:49], a[96:99], v[174:177], v[46:49]
    v_max3_u32 v7, v7, v188, v189
    v_mfma_f32_16x16x32_bf16 v[50:53], a[100:103], v[174:177], v[50:53]
    v_mfma_f32_16x16x32_bf16 v[54:57], a[104:107], v[174:177], v[54:57]
    v_max_u32 v7, v7, v8
    v_mfma_f32_16x16x32_bf16 v[58:61], a[108:111], v[174:177], v[58:61]
    v_cmp_eq_u32 vcc, -1, v7
    global_load_dwordx4 v[122:125], v2, s[86:87] offset:2048 sc1
    s_cbranch_vccnz L_gslow_37
L_gback_38:
    v_mfma_f32_16x16x32_bf16 v[14:17], a[112:115], v[178:181], v[14:17]
    v_mfma_f32_16x16x32_bf16 v[18:21], a[116:119], v[178:181], v[18:21]
    v_lshlrev_b32 v250, 16, v252
    v_and_b32 v251, 0xffff0000, v252
    v_mfma_f32_16x16x32_bf16 v[22:25], a[120:123], v[178:181], v[22:25]
    v_lshlrev_b32 v252, 16, v253
    v_and_b32 v253, 0xffff0000, v253
    v_mfma_f32_16x16x32_bf16 v[26:29], a[124:127], v[178:181], v[26:29]
    v_mov_b32 v10, 0xc0135761
    global_load_dwordx4 v[126:129], v3, s[86:87] offset:2048 sc1
    v_mov_b32 v12, 0xbdd2d3e8
    v_mfma_f32_16x16x32_bf16 v[30:33], a[112:115], v[182:185], v[30:33]
    s_waitcnt vmcnt(18)
    v_mfma_f32_16x16x32_bf16 v[34:37], a[116:119], v[182:185], v[34:37]
    v_max3_u32 v7, v190, v191, v192
    v_mfma_f32_16x16x32_bf16 v[38:41], a[120:123], v[182:185], v[38:41]
    v_max3_u32 v8, v193, v194, v195
    v_mfma_f32_16x16x32_bf16 v[42:45], a[124:127], v[182:185], v[42:45]
    v_max3_u32 v7, v7, v196, v197
    global_load_dwordx4 v[130:133], v4, s[86:87] offset:2048 sc1
    v_mfma_f32_16x16x32_bf16 v[46:49], a[112:115], v[186:189], v[46:49]
    v_max3_u32 v8, v8, v198, v199
    v_mfma_f32_16x16x32_bf16 v[50:53], a[116:119], v[186:189], v[50:53]
    v_max3_u32 v7, v7, v200, v201
    v_mfma_f32_16x16x32_bf16 v[54:57], a[120:123], v[186:189], v[54:57]
    v_max_u32 v7, v7, v8
    v_mfma_f32_16x16x32_bf16 v[58:61], a[124:127], v[186:189], v[58:61]
    v_cmp_eq_u32 vcc, -1, v7
    s_cbranch_vccnz L_gslow_39
L_gback_40:
    global_load_dwordx4 v[134:137], v2, s[86:87] offset:3072 sc1
    v_mfma_f32_16x16x32_bf16 v[14:17], a[128:131], v[190:193], v[14:17]
    v_mfma_f32_16x16x32_bf16 v[18:21], a[132:135], v[190:193], v[18:21]
    s_waitcnt vmcnt(17)
    v_mfma_f32_16x16x32_bf16 v[22:25], a[136:139], v[190:193], v[22:25]
    v_max3_u32 v7, v202, v203, v204
    v_mfma_f32_16x16x32_bf16 v[26:29], a[140:143], v[190:193], v[26:29]
    global_load_dwordx4 v[138:141], v3, s[86:87] offset:3072 sc1
    v_mfma_f32_16x16x32_bf16 v[30:33], a[128:131], v[194:197], v[30:33]
    v_max3_u32 v8, v205, v206, v207
    v_mfma_f32_16x16x32_bf16 v[34:37], a[132:135], v[194:197], v[34:37]
    v_max3_u32 v7, v7, v208, v209
    v_mfma_f32_16x16x32_bf16 v[38:41], a[136:139], v[194:197], v[38:41]
    v_mfma_f32_16x16x32_bf16 v[42:45], a[140:143], v[194:197], v[42:45]
    global_load_dwordx4 v[142:145], v4, s[86:87] offset:3072 sc1
    v_max3_u32 v8, v8, v210, v211
    v_mfma_f32_16x16x32_bf16 v[46:49], a[128:131], v[198:201], v[46:49]
    v_max3_u32 v7, v7, v212, v213
    v_mfma_f32_16x16x32_bf16 v[50:53], a[132:135], v[198:201], v[50:53]
    v_mfma_f32_16x16x32_bf16 v[54:57], a[136:139], v[198:201], v[54:57]
    v_max_u32 v7, v7, v8
    v_mfma_f32_16x16x32_bf16 v[58:61], a[140:143], v[198:201], v[58:61]
    v_cmp_eq_u32 vcc, -1, v7
    global_load_dwordx4 v[146:149], v5, s[84:85] offset:-4096 sc1
    s_cbranch_vccnz L_gslow_41
L_gback_42:
    v_mfma_f32_16x16x32_bf16 v[14:17], a[144:147], v[202:205], v[14:17]
    v_mfma_f32_16x16x32_bf16 v[18:21], a[148:151], v[202:205], v[18:21]
    s_waitcnt vmcnt(17)
    v_mfma_f32_16x16x32_bf16 v[22:25], a[152:155], v[202:205], v[22:25]
    v_max3_u32 v7, v214, v215, v216
    v_mfma_f32_16x16x32_bf16 v[26:29], a[156:159], v[202:205], v[26:29]
    global_load_dwordx4 v[150:153], v6, s[84:85] offset:-4096 sc1
    v_mfma_f32_16x16x32_bf16 v[30:33], a[144:147], v[206:209], v[30:33]
    v_max3_u32 v8, v217, v218, v219
    v_mfma_f32_16x16x32_bf16 v[34:37], a[148:151], v[206:209], v[34:37]
    v_max3_u32 v7, v7, v220, v221
    v_mfma_f32_16x16x32_bf16 v[38:41], a[152:155], v[206:209], v[38:41]
    v_mfma_f32_16x16x32_bf16 v[42:45], a[156:159], v[206:209], v[42:45]
    global_load_dwordx4 v[154:157], v5, s[84:85] offset:-3072 sc1
    v_max3_u32 v8, v8, v222, v223
    v_mfma_f32_16x16x32_bf16 v[46:49], a[144:147], v[210:213], v[46:49]
    v_max3_u32 v7, v7, v224, v225
    v_mfma_f32_16x16x32_bf16 v[50:53], a[148:151], v[210:213], v[50:53]
    v_mfma_f32_16x16x32_bf16 v[54:57], a[152:155], v[210:213], v[54:57]
    v_max_u32 v7, v7, v8
    v_mfma_f32_16x16x32_bf16 v[58:61], a[156:159], v[210:213], v[58:61]
    v_cmp_eq_u32 vcc, -1, v7
    global_load_dwordx4 v[158:161], v6, s[84:85] offset:-3072 sc1
    s_cbranch_vccnz L_gslow_43
L_gback_44:
    v_mfma_f32_16x16x32_bf16 v[14:17], a[160:163], v[214:217], v[14:17]
    v_mfma_f32_16x16x32_bf16 v[18:21], a[164:167], v[214:217], v[18:21]
    s_waitcnt vmcnt(16)
    v_mfma_f32_16x16x32_bf16 v[22:25], a[168:171], v[214:217], v[22:25]
    v_max3_u32 v7, v226, v227, v228
    v_mfma_f32_16x16x32_bf16 v[26:29], a[172:175], v[214:217], v[26:29]
    global_load_dwordx4 v[162:165], v5, s[84:85] offset:-2048 sc1
    v_mfma_f32_16x16x32_bf16 v[30:33], a[160:163], v[218:221], v[30:33]
    v_max3_u32 v8, v229, v230, v231
    v_mfma_f32_16x16x32_bf16 v[34:37], a[164:167], v[218:221], v[34:37]
    v_max3_u32 v7, v7, v232, v233
    v_mfma_f32_16x16x32_bf16 v[38:41], a[168:171], v[218:221], v[38:41]
    v_mfma_f32_16x16x32_bf16 v[42:45], a[172:175], v[218:221], v[42:45]
    global_load_dwordx4 v[166:169], v6, s[84:85] offset:-2048 sc1
    v_max3_u32 v8, v8, v94, v95
    v_mfma_f32_16x16x32_bf16 v[46:49], a[160:163], v[222:225], v[46:49]
    v_max3_u32 v7, v7, v96, v97
    v_mfma_f32_16x16x32_bf16 v[50:53], a[164:167], v[222:225], v[50:53]
    v_mfma_f32_16x16x32_bf16 v[54:57], a[168:171], v[222:225], v[54:57]
    v_max_u32 v7, v7, v8
    v_mfma_f32_16x16x32_bf16 v[58:61], a[172:175], v[222:225], v[58:61]
    v_cmp_eq_u32 vcc, -1, v7
    global_load_dwordx4 v[170:173], v5, s[84:85] offset:-1024 sc1
    s_cbranch_vccnz L_gslow_45
L_gback_46:
    v_mfma_f32_16x16x32_bf16 v[14:17], a[176:179], v[226:229], v[14:17]
    v_mfma_f32_16x16x32_bf16 v[18:21], a[180:183], v[226:229], v[18:21]
    s_waitcnt vmcnt(16)
    v_mfma_f32_16x16x32_bf16 v[22:25], a[184:187], v[226:229], v[22:25]
    v_max3_u32 v7, v98, v99, v100
    v_mfma_f32_16x16x32_bf16 v[26:29], a[188:191], v[226:229], v[26:29]
    global_load_dwordx4 v[174:177], v6, s[84:85] offset:-1024 sc1
    v_mfma_f32_16x16x32_bf16 v[30:33], a[176:179], v[230:233], v[30:33]
    v_max3_u32 v8, v101, v102, v103
    v_mfma_f32_16x16x32_bf16 v[34:37], a[180:183], v[230:233], v[34:37]
    v_max3_u32 v7, v7, v104, v105
    v_mfma_f32_16x16x32_bf16 v[38:41], a[184:187], v[230:233], v[38:41]
    v_mfma_f32_16x16x32_bf16 v[42:45], a[188:191], v[230:233], v[42:45]
    global_load_dwordx4 v[178:181], v5, s[84:85] offset:0 sc1
    v_max3_u32 v8, v8, v106, v107
    v_mfma_f32_16x16x32_bf16 v[46:49], a[176:179], v[94:97], v[46:49]
    v_max3_u32 v7, v7, v108, v109
    v_mfma_f32_16x16x32_bf16 v[50:53], a[180:183], v[94:97], v[50:53]
    v_mfma_f32_16x16x32_bf16 v[54:57], a[184:187], v[94:97], v[54:57]
    v_max_u32 v7, v7, v8
    v_mfma_f32_16x16x32_bf16 v[58:61], a[188:191], v[94:97], v[58:61]
    v_cmp_eq_u32 vcc, -1, v7
    global_load_dwordx4 v[182:185], v6, s[84:85] offset:0 sc1
    s_cbranch_vccnz L_gslow_47
L_gback_48:
    v_mfma_f32_16x16x32_bf16 v[14:17], a[192:195], v[98:101], v[14:17]
    v_mfma_f32_16x16x32_bf16 v[18:21], a[196:199], v[98:101], v[18:21]
    s_waitcnt lgkmcnt(0)
    v_mfma_f32_16x16x32_bf16 v[22:25], a[200:203], v[98:101], v[22:25]
    s_waitcnt vmcnt(16)
    v_mfma_f32_16x16x32_bf16 v[26:29], a[204:207], v[98:101], v[26:29]
    v_max3_u32 v7, v110, v111, v112
    global_load_dwordx4 v[186:189], v5, s[84:85] offset:1024 sc1
    v_mfma_f32_16x16x32_bf16 v[30:33], a[192:195], v[102:105], v[30:33]
    v_mfma_f32_16x16x32_bf16 v[34:37], a[196:199], v[102:105], v[34:37]
    v_max3_u32 v8, v113, v114, v115
    v_mfma_f32_16x16x32_bf16 v[38:41], a[200:203], v[102:105], v[38:41]
    v_max3_u32 v7, v7, v116, v117
    v_mfma_f32_16x16x32_bf16 v[42:45], a[204:207], v[102:105], v[42:45]
    v_max3_u32 v8, v8, v118, v119
    v_mfma_f32_16x16x32_bf16 v[46:49], a[192:195], v[106:109], v[46:49]
    global_load_dwordx4 v[190:193], v6, s[84:85] offset:1024 sc1
    v_mfma_f32_16x16x32_bf16 v[50:53], a[196:199], v[106:109], v[50:53]
    v_max3_u32 v7, v7, v120, v121
    v_mfma_f32_16x16x32_bf16 v[54:57], a[200:203], v[106:109], v[54:57]
    v_max_u32 v7, v7, v8
    v_mfma_f32_16x16x32_bf16 v[58:61], a[204:207], v[106:109], v[58:61]
    v_cmp_eq_u32 vcc, -1, v7
    s_cbranch_vccnz L_gslow_49
L_gback_50:
    v_mfma_f32_16x16x32_bf16 v[14:17], a[208:211], v[110:113], v[14:17]
    global_load_dwordx4 v[194:197], v5, s[84:85] offset:2048 sc1
    v_mfma_f32_16x16x32_bf16 v[18:21], a[212:215], v[110:113], v[18:21]
    s_waitcnt vmcnt(16)
    v_mfma_f32_16x16x32_bf16 v[22:25], a[216:219], v[110:113], v[22:25]
    v_max3_u32 v7, v122, v123, v124
    v_mfma_f32_16x16x32_bf16 v[26:29], a[220:223], v[110:113], v[26:29]
    global_load_dwordx4 v[198:201], v6, s[84:85] offset:2048 sc1
    v_mfma_f32_16x16x32_bf16 v[30:33], a[208:211], v[114:117], v[30:33]
    v_max3_u32 v8, v125, v126, v127
    v_mfma_f32_16x16x32_bf16 v[34:37], a[212:215], v[114:117], v[34:37]
    v_max3_u32 v7, v7, v128, v129
    v_mfma_f32_16x16x32_bf16 v[38:41], a[216:219], v[114:117], v[38:41]
    v_mfma_f32_16x16x32_bf16 v[42:45], a[220:223], v[114:117], v[42:45]
    global_load_dwordx4 v[202:205], v5, s[84:85] offset:3072 sc1
    v_max3_u32 v8, v8, v130, v131
    v_mfma_f32_16x16x32_bf16 v[46:49], a[208:211], v[118:121], v[46:49]
    v_max3_u32 v7, v7, v132, v133
    v_mfma_f32_16x16x32_bf16 v[50:53], a[212:215], v[118:121], v[50:53]
    v_mfma_f32_16x16x32_bf16 v[54:57], a[216:219], v[118:121], v[54:57]
    v_max_u32 v7, v7, v8
    v_mfma_f32_16x16x32_bf16 v[58:61], a[220:223], v[118:121], v[58:61]
    v_cmp_eq_u32 vcc, -1, v7
    global_load_dwordx4 v[206:209], v6, s[84:85] offset:3072 sc1
    s_cbranch_vccnz L_gslow_51
L_gback_52:
    v_mfma_f32_16x16x32_bf16 v[14:17], a[224:227], v[122:125], v[14:17]
    v_mfma_f32_16x16x32_bf16 v[18:21], a[228:231], v[122:125], v[18:21]
    s_waitcnt vmcnt(16)
    v_mfma_f32_16x16x32_bf16 v[22:25], a[232:235], v[122:125], v[22:25]
    v_max3_u32 v7, v134, v135, v136
    v_mfma_f32_16x16x32_bf16 v[26:29], a[236:239], v[122:125], v[26:29]
    global_load_dwordx4 v[210:213], v5, s[86:87] offset:-4096 sc1
    v_mfma_f32_16x16x32_bf16 v[30:33], a[224:227], v[126:129], v[30:33]
    v_max3_u32 v8, v137, v138, v139
    v_mfma_f32_16x16x32_bf16 v[34:37], a[228:231], v[126:129], v[34:37]
    v_max3_u32 v7, v7, v140, v141
    v_mfma_f32_16x16x32_bf16 v[38:41], a[232:235], v[126:129], v[38:41]
    v_mfma_f32_16x16x32_bf16 v[42:45], a[236:239], v[126:129], v[42:45]
    global_load_dwordx4 v[214:217], v6, s[86:87] offset:-4096 sc1
    v_max3_u32 v8, v8, v142, v143
    v_mfma_f32_16x16x32_bf16 v[46:49], a[224:227], v[130:133], v[46:49]
    v_max3_u32 v7, v7, v144, v145
    v_mfma_f32_16x16x32_bf16 v[50:53], a[228:231], v[130:133], v[50:53]
    v_mfma_f32_16x16x32_bf16 v[54:57], a[232:235], v[130:133], v[54:57]
    v_max_u32 v7, v7, v8
    v_mfma_f32_16x16x32_bf16 v[58:61], a[236:239], v[130:133], v[58:61]
    v_cmp_eq_u32 vcc, -1, v7
    global_load_dwordx4 v[218:221], v5, s[86:87] offset:-3072 sc1
    s_cbranch_vccnz L_gslow_53
L_gback_54:
    v_mfma_f32_16x16x32_bf16 v[14:17], a[240:243], v[134:137], v[14:17]
    v_mfma_f32_16x16x32_bf16 v[18:21], a[244:247], v[134:137], v[18:21]
    v_mfma_f32_16x16x32_bf16 v[22:25], a[248:251], v[134:137], v[22:25]
    v_mfma_f32_16x16x32_bf16 v[26:29], a[252:255], v[134:137], v[26:29]
    v_mfma_f32_16x16x32_bf16 v[30:33], a[240:243], v[138:141], v[30:33]
    global_load_dwordx4 v[222:225], v6, s[86:87] offset:-3072 sc1
    v_mfma_f32_16x16x32_bf16 v[34:37], a[244:247], v[138:141], v[34:37]
    v_mfma_f32_16x16x32_bf16 v[38:41], a[248:251], v[138:141], v[38:41]
    v_mfma_f32_16x16x32_bf16 v[42:45], a[252:255], v[138:141], v[42:45]
    v_mfma_f32_16x16x32_bf16 v[46:49], a[240:243], v[142:145], v[46:49]
    global_load_dwordx4 v[226:229], v5, s[86:87] offset:-2048 sc1
    v_mfma_f32_16x16x32_bf16 v[50:53], a[244:247], v[142:145], v[50:53]
    v_mfma_f32_16x16x32_bf16 v[54:57], a[248:251], v[142:145], v[54:57]
    v_mfma_f32_16x16x32_bf16 v[58:61], a[252:255], v[142:145], v[58:61]
L_gdone_22:
    s_waitcnt lgkmcnt(0)
    s_barrier
    global_load_dwordx4 v[230:233], v6, s[86:87] offset:-2048 sc1
    s_cmp_lg_u32 s3, 0
    s_cbranch_scc1 L_pd2_55
    s_mov_b64 exec, 1
    global_store_dword v249, v9, s[52:53] sc1
    s_mov_b64 exec, -1
L_pd2_55:
    global_load_dwordx4 v[94:97], v5, s[86:87] offset:-1024 sc1
    ds_write_b128 v242, v[18:21] offset:0
    ds_write_b128 v242, v[34:37] offset:1024
    global_load_dwordx4 v[98:101], v6, s[86:87] offset:-1024 sc1
    ds_write_b128 v242, v[50:53] offset:2048
    ds_write_b128 v243, v[22:25] offset:0
    ds_write_b128 v243, v[38:41] offset:1024
    global_load_dwordx4 v[102:105], v5, s[86:87] offset:0 sc1
    ds_write_b128 v243, v[54:57] offset:2048
    ds_write_b128 v244, v[26:29] offset:0
    global_load_dwordx4 v[106:109], v6, s[86:87] offset:0 sc1
    ds_write_b128 v244, v[42:45] offset:1024
    ds_write_b128 v244, v[58:61] offset:2048
    global_load_dwordx4 v[110:113], v5, s[86:87] offset:1024 sc1
    s_waitcnt lgkmcnt(0)
    s_barrier
    global_load_dwordx4 v[114:117], v6, s[86:87] offset:1024 sc1
    ds_read_b128 v[18:21], v245 offset:0
    ds_read_b128 v[22:25], v245 offset:3072
    ds_read_b128 v[26:29], v245 offset:6144
    ds_read_b128 v[34:37], v245 offset:1024
    ds_read_b128 v[38:41], v245 offset:4096
    ds_read_b128 v[42:45], v245 offset:7168
    ds_read_b128 v[50:53], v245 offset:2048
    global_load_dwordx4 v[118:121], v5, s[86:87] offset:2048 sc1
    ds_read_b128 v[54:57], v245 offset:5120
    ds_read_b128 v[58:61], v245 offset:8192
    s_waitcnt lgkmcnt(6)
    v_pk_add_f32 v[14:15], v[14:15], v[18:19]
    v_pk_add_f32 v[22:23], v[22:23], v[26:27]
    v_pk_add_f32 v[16:17], v[16:17], v[20:21]
    v_pk_add_f32 v[24:25], v[24:25], v[28:29]
    s_waitcnt lgkmcnt(3)
    v_pk_add_f32 v[30:31], v[30:31], v[34:35]
    v_pk_add_f32 v[38:39], v[38:39], v[42:43]
    v_pk_add_f32 v[32:33], v[32:33], v[36:37]
    v_pk_add_f32 v[40:41], v[40:41], v[44:45]
    s_waitcnt lgkmcnt(0)
    global_load_dwordx4 v[122:125], v6, s[86:87] offset:2048 sc1
    v_pk_add_f32 v[46:47], v[46:47], v[50:51]
    v_pk_add_f32 v[54:55], v[54:55], v[58:59]
    v_pk_add_f32 v[48:49], v[48:49], v[52:53]
    v_pk_add_f32 v[56:57], v[56:57], v[60:61]
    v_pk_add_f32 v[14:15], v[14:15], v[22:23]
    v_pk_add_f32 v[16:17], v[16:17], v[24:25]
    v_pk_add_f32 v[30:31], v[30:31], v[38:39]
    v_pk_add_f32 v[32:33], v[32:33], v[40:41]
    v_pk_add_f32 v[46:47], v[46:47], v[54:55]
    v_pk_add_f32 v[48:49], v[48:49], v[56:57]
    v_cvt_pk_bf16_f32 v15, v14, v15
    v_cvt_pk_bf16_f32 v17, v16, v17
    v_cvt_pk_bf16_f32 v31, v30, v31
    v_cvt_pk_bf16_f32 v33, v32, v33
    global_load_dwordx4 v[126:129], v5, s[86:87] offset:3072 sc1
    v_cvt_pk_bf16_f32 v47, v46, v47
    v_cvt_pk_bf16_f32 v49, v48, v49
    v_lshlrev_b32 v14, 16, v15
    v_and_b32 v15, 0xffff0000, v15
    v_lshlrev_b32 v16, 16, v17
    v_and_b32 v17, 0xffff0000, v17
    v_lshlrev_b32 v30, 16, v31
    v_and_b32 v31, 0xffff0000, v31
    v_lshlrev_b32 v32, 16, v33
    v_and_b32 v33, 0xffff0000, v33
    v_lshlrev_b32 v46, 16, v47
    v_and_b32 v47, 0xffff0000, v47
    v_lshlrev_b32 v48, 16, v49
    v_and_b32 v49, 0xffff0000, v49
    v_pk_add_f32 v[14:15], v[14:15], v[250:251]
    global_load_dwordx4 v[130:133], v6, s[86:87] offset:3072 sc1
    v_pk_add_f32 v[16:17], v[16:17], v[252:253]
    v_pk_add_f32 v[30:31], v[30:31], v[250:251]
    v_pk_add_f32 v[32:33], v[32:33], v[252:253]
    v_pk_add_f32 v[46:47], v[46:47], v[250:251]
    v_pk_add_f32 v[48:49], v[48:49], v[252:253]
    v_cvt_pk_bf16_f32 v15, v14, v15
    v_cvt_pk_bf16_f32 v17, v16, v17
    v_cvt_pk_bf16_f32 v31, v30, v31
    v_cvt_pk_bf16_f32 v33, v32, v33
    v_cvt_pk_bf16_f32 v47, v46, v47
    v_cvt_pk_bf16_f32 v49, v48, v49
    v_lshlrev_b32 v14, 16, v15
    v_and_b32 v15, 0xffff0000, v15
    v_lshlrev_b32 v16, 16, v17
    v_and_b32 v17, 0xffff0000, v17
    v_lshlrev_b32 v30, 16, v31
    v_and_b32 v31, 0xffff0000, v31
    v_lshlrev_b32 v32, 16, v33
    v_and_b32 v33, 0xffff0000, v33
    v_lshlrev_b32 v46, 16, v47
    v_and_b32 v47, 0xffff0000, v47
    v_lshlrev_b32 v48, 16, v49
    v_and_b32 v49, 0xffff0000, v49
    v_pk_mul_f32 v[18:19], v[14:15], v[14:15]
    v_pk_mul_f32 v[20:21], v[16:17], v[16:17]
    v_pk_mul_f32 v[34:35], v[30:31], v[30:31]
    v_pk_mul_f32 v[36:37], v[32:33], v[32:33]
    v_pk_mul_f32 v[50:51], v[46:47], v[46:47]
    v_pk_mul_f32 v[52:53], v[48:49], v[48:49]
    v_pk_fma_f32 v[18:19], v[18:19], v[12:13], v[10:11] op_sel_hi:[1,0,0]
    v_pk_fma_f32 v[20:21], v[20:21], v[12:13], v[10:11] op_sel_hi:[1,0,0]
    v_pk_fma_f32 v[34:35], v[34:35], v[12:13], v[10:11] op_sel_hi:[1,0,0]
    v_pk_fma_f32 v[36:37], v[36:37], v[12:13], v[10:11] op_sel_hi:[1,0,0]
    v_pk_fma_f32 v[50:51], v[50:51], v[12:13], v[10:11] op_sel_hi:[1,0,0]
    v_pk_fma_f32 v[52:53], v[52:53], v[12:13], v[10:11] op_sel_hi:[1,0,0]
    v_pk_mul_f32 v[18:19], v[18:19], v[14:15]
    v_pk_mul_f32 v[20:21], v[20:21], v[16:17]
    v_pk_mul_f32 v[34:35], v[34:35], v[30:31]
    v_pk_mul_f32 v[36:37], v[36:37], v[32:33]
    v_pk_mul_f32 v[50:51], v[50:51], v[46:47]
    v_pk_mul_f32 v[52:53], v[52:53], v[48:49]
    v_exp_f32 v18, v18
    v_exp_f32 v19, v19
    v_exp_f32 v20, v20
    v_exp_f32 v21, v21
    v_exp_f32 v34, v34
    v_exp_f32 v35, v35
    v_exp_f32 v36, v36
    v_exp_f32 v37, v37
    v_exp_f32 v50, v50
    v_exp_f32 v51, v51
    v_exp_f32 v52, v52
    v_exp_f32 v53, v53
    v_pk_add_f32 v[18:19], v[18:19], 1.0 op_sel_hi:[1,0]
    v_pk_add_f32 v[20:21], v[20:21], 1.0 op_sel_hi:[1,0]
    v_pk_add_f32 v[34:35], v[34:35], 1.0 op_sel_hi:[1,0]
    v_pk_add_f32 v[36:37], v[36:37], 1.0 op_sel_hi:[1,0]
    v_pk_add_f32 v[50:51], v[50:51], 1.0 op_sel_hi:[1,0]
    v_pk_add_f32 v[52:53], v[52:53], 1.0 op_sel_hi:[1,0]
    v_rcp_f32 v18, v18
    v_rcp_f32 v19, v19
    v_rcp_f32 v20, v20
    v_rcp_f32 v21, v21
    v_rcp_f32 v34, v34
    v_rcp_f32 v35, v35
    v_rcp_f32 v36, v36
    v_rcp_f32 v37, v37
    v_rcp_f32 v50, v50
    v_rcp_f32 v51, v51
    v_rcp_f32 v52, v52
    v_rcp_f32 v53, v53
    v_pk_mul_f32 v[14:15], v[14:15], v[18:19]
    v_pk_mul_f32 v[16:17], v[16:17], v[20:21]
    v_pk_mul_f32 v[30:31], v[30:31], v[34:35]
    v_pk_mul_f32 v[32:33], v[32:33], v[36:37]
    v_pk_mul_f32 v[46:47], v[46:47], v[50:51]
    v_pk_mul_f32 v[48:49], v[48:49], v[52:53]
    v_cvt_pk_bf16_f32 v22, v14, v15
    v_cvt_pk_bf16_f32 v24, v30, v31
    v_cvt_pk_bf16_f32 v23, v16, v17
    v_cvt_pk_bf16_f32 v25, v32, v33
    v_cvt_pk_bf16_f32 v54, v46, v47
    v_cvt_pk_bf16_f32 v56, v46, v47
    v_cvt_pk_bf16_f32 v55, v48, v49
    v_cvt_pk_bf16_f32 v57, v48, v49
    v_min_u32 v22, 0xfffffffe, v22
    v_min_u32 v23, 0xfffffffe, v23
    v_min_u32 v24, 0xfffffffe, v24
    v_min_u32 v25, 0xfffffffe, v25
    v_min_u32 v54, 0xfffffffe, v54
    v_min_u32 v55, 0xfffffffe, v55
    v_min_u32 v56, 0xfffffffe, v56
    v_min_u32 v57, 0xfffffffe, v57
    v_permlane16_swap_b32 v22, v24
    v_permlane16_swap_b32 v23, v25
    v_permlane16_swap_b32 v54, v56
    v_permlane16_swap_b32 v55, v57
    global_store_dwordx4 v246, v[22:25], s[50:51] sc1
    global_store_dwordx4 v247, v[54:57], s[50:51] sc1
    s_waitcnt vmcnt(32)
    v_max3_u32 v7, v146, v147, v148
    v_max3_u32 v8, v149, v150, v151
    v_max3_u32 v7, v7, v152, v153
    v_max_u32 v7, v7, v8
    v_cmp_eq_u32 vcc, -1, v7
    s_cbranch_vccnz L_gslow_57
L_gback_58:
    v_mfma_f32_16x16x32_bf16 v[62:65], a[0:3], v[146:149], 0
    v_bfe_u32 v9, v1, 2, 3
    s_lshl_b32 s54, s78, 3
    v_add_u32 v9, s54, v9
    v_lshlrev_b32 v9, 7, v9
    v_mfma_f32_16x16x32_bf16 v[66:69], a[4:7], v[146:149], 0
    v_and_b32 v13, 3, v1
    v_lshl_add_u32 v9, v13, 2, v9
    v_add_u32 v9, 0x10000, v9
    s_mul_i32 s54, s75, 3456
    s_add_u32 s54, s54, 0x18000
    v_and_b32 v11, 31, v1
    v_min_u32 v11, 26, v11
    v_lshl_add_u32 v11, v11, 7, s54
    v_mfma_f32_16x16x32_bf16 v[70:73], a[8:11], v[146:149], 0
    v_cmp_lt_u32 s[62:63], 31, v1
    s_nop 1
    v_cndmask_b32 v9, v9, v11, s[62:63]
    v_mfma_f32_16x16x32_bf16 v[74:77], a[12:15], v[146:149], 0
    s_mul_i32 s54, s75, 276480
    v_lshl_add_u32 v11, v1, 4, s54
    v_add_u32 v2, 0, v11
    v_add_u32 v3, 55296, v11
    v_add_u32 v4, 110592, v11
    v_mfma_f32_16x16x32_bf16 v[78:81], a[0:3], v[150:153], 0
    s_lshl_b32 s54, s92, 10
    s_add_u32 s54, s54, 4096
    s_add_u32 s64, s50, s54
    s_addc_u32 s65, s51, 0
    s_add_u32 s66, s64, 8192
    s_addc_u32 s67, s65, 0
    s_waitcnt vmcnt(30)
    v_mfma_f32_16x16x32_bf16 v[82:85], a[4:7], v[150:153], 0
    v_max3_u32 v7, v154, v155, v156
    v_mfma_f32_16x16x32_bf16 v[86:89], a[8:11], v[150:153], 0
    v_max3_u32 v8, v157, v158, v159
    v_max3_u32 v7, v7, v160, v161
    v_mfma_f32_16x16x32_bf16 v[90:93], a[12:15], v[150:153], 0
    v_max_u32 v7, v7, v8
    v_cmp_eq_u32 vcc, -1, v7
    s_cbranch_vccnz L_gslow_59
L_gback_60:
    v_mfma_f32_16x16x32_bf16 v[62:65], a[16:19], v[154:157], v[62:65]
    s_waitcnt vmcnt(63)
    v_mfma_f32_16x16x32_bf16 v[66:69], a[20:23], v[154:157], v[66:69]
    ds_read_b64_tr_b16 a[0:1], v238 offset:0
    ds_read_b64_tr_b16 a[2:3], v238 offset:512
    v_mfma_f32_16x16x32_bf16 v[70:73], a[24:27], v[154:157], v[70:73]
    ds_read_b64_tr_b16 a[4:5], v239 offset:0
    ds_read_b64_tr_b16 a[6:7], v239 offset:512
    v_mfma_f32_16x16x32_bf16 v[74:77], a[28:31], v[154:157], v[74:77]
    ds_read_b64_tr_b16 a[8:9], v240 offset:0
    ds_read_b64_tr_b16 a[10:11], v240 offset:512
    v_mfma_f32_16x16x32_bf16 v[78:81], a[16:19], v[158:161], v[78:81]
    ds_read_b64_tr_b16 a[12:13], v241 offset:0
    ds_read_b64_tr_b16 a[14:15], v241 offset:512
    v_mfma_f32_16x16x32_bf16 v[82:85], a[20:23], v[158:161], v[82:85]
    s_waitcnt vmcnt(28)
    v_max3_u32 v7, v162, v163, v164
    v_mfma_f32_16x16x32_bf16 v[86:89], a[24:27], v[158:161], v[86:89]
    v_max3_u32 v8, v165, v166, v167
    v_max3_u32 v7, v7, v168, v169
    v_mfma_f32_16x16x32_bf16 v[90:93], a[28:31], v[158:161], v[90:93]
    v_max_u32 v7, v7, v8
    v_cmp_eq_u32 vcc, -1, v7
    s_cbranch_vccnz L_gslow_61
L_gback_62:
    v_mfma_f32_16x16x32_bf16 v[62:65], a[32:35], v[162:165], v[62:65]
    s_waitcnt vmcnt(63)
    v_mfma_f32_16x16x32_bf16 v[66:69], a[36:39], v[162:165], v[66:69]
    ds_read_b64_tr_b16 a[16:17], v238 offset:4096
    ds_read_b64_tr_b16 a[18:19], v238 offset:4608
    v_mfma_f32_16x16x32_bf16 v[70:73], a[40:43], v[162:165], v[70:73]
    ds_read_b64_tr_b16 a[20:21], v239 offset:4096
    ds_read_b64_tr_b16 a[22:23], v239 offset:4608
    v_mfma_f32_16x16x32_bf16 v[74:77], a[44:47], v[162:165], v[74:77]
    ds_read_b64_tr_b16 a[24:25], v240 offset:4096
    ds_read_b64_tr_b16 a[26:27], v240 offset:4608
    v_mfma_f32_16x16x32_bf16 v[78:81], a[32:35], v[166:169], v[78:81]
    ds_read_b64_tr_b16 a[28:29], v241 offset:4096
    ds_read_b64_tr_b16 a[30:31], v241 offset:4608
    v_mfma_f32_16x16x32_bf16 v[82:85], a[36:39], v[166:169], v[82:85]
    s_waitcnt vmcnt(26)
    v_max3_u32 v7, v170, v171, v172
    v_mfma_f32_16x16x32_bf16 v[86:89], a[40:43], v[166:169], v[86:89]
    v_max3_u32 v8, v173, v174, v175
    v_max3_u32 v7, v7, v176, v177
    v_mfma_f32_16x16x32_bf16 v[90:93], a[44:47], v[166:169], v[90:93]
    v_max_u32 v7, v7, v8
    v_cmp_eq_u32 vcc, -1, v7
    s_cbranch_vccnz L_gslow_63
L_gback_64:
    v_mfma_f32_16x16x32_bf16 v[62:65], a[48:51], v[170:173], v[62:65]
    s_waitcnt lgkmcnt(8)
    s_mul_i32 s82, s3, 32768
    s_mov_b32 m0, s82
    s_add_u32 s82, s82, 4096
    global_load_lds_dwordx4 v234, s[80:81]
    global_load_lds_dwordx4 v235, s[80:81] offset:1024
    global_load_lds_dwordx4 v236, s[80:81] offset:2048
    global_load_lds_dwordx4 v237, s[80:81] offset:3072
    s_add_u32 s80, s80, 131072
    s_addc_u32 s81, s81, 0
    s_waitcnt vmcnt(63)
    v_mfma_f32_16x16x32_bf16 v[66:69], a[52:55], v[170:173], v[66:69]
    ds_read_b64_tr_b16 a[32:33], v238 offset:8192
    ds_read_b64_tr_b16 a[34:35], v238 offset:8704
    v_mfma_f32_16x16x32_bf16 v[70:73], a[56:59], v[170:173], v[70:73]
    ds_read_b64_tr_b16 a[36:37], v239 offset:8192
    ds_read_b64_tr_b16 a[38:39], v239 offset:8704
    v_mfma_f32_16x16x32_bf16 v[74:77], a[60:63], v[170:173], v[74:77]
    ds_read_b64_tr_b16 a[40:41], v240 offset:8192
    ds_read_b64_tr_b16 a[42:43], v240 offset:8704
    v_mfma_f32_16x16x32_bf16 v[78:81], a[48:51], v[174:177], v[78:81]
    ds_read_b64_tr_b16 a[44:45], v241 offset:8192
    ds_read_b64_tr_b16 a[46:47], v241 offset:8704
    v_mfma_f32_16x16x32_bf16 v[82:85], a[52:55], v[174:177], v[82:85]
    s_waitcnt vmcnt(28)
    v_max3_u32 v7, v178, v179, v180
    v_mfma_f32_16x16x32_bf16 v[86:89], a[56:59], v[174:177], v[86:89]
    v_max3_u32 v8, v181, v182, v183
    v_max3_u32 v7, v7, v184, v185
    v_mfma_f32_16x16x32_bf16 v[90:93], a[60:63], v[174:177], v[90:93]
    v_max_u32 v7, v7, v8
    v_cmp_eq_u32 vcc, -1, v7
    s_cbranch_vccnz L_gslow_65
L_gback_66:
    v_mfma_f32_16x16x32_bf16 v[62:65], a[64:67], v[178:181], v[62:65]
    s_waitcnt lgkmcnt(8)
    s_mov_b32 m0, s82
    s_add_u32 s82, s82, 4096
    global_load_lds_dwordx4 v234, s[80:81]
    global_load_lds_dwordx4 v235, s[80:81] offset:1024
    global_load_lds_dwordx4 v236, s[80:81] offset:2048
    global_load_lds_dwordx4 v237, s[80:81] offset:3072
    s_add_u32 s80, s80, 131072
    s_addc_u32 s81, s81, 0
    s_waitcnt vmcnt(63)
    v_mfma_f32_16x16x32_bf16 v[66:69], a[68:71], v[178:181], v[66:69]
    ds_read_b64_tr_b16 a[48:49], v238 offset:12288
    ds_read_b64_tr_b16 a[50:51], v238 offset:12800
    v_mfma_f32_16x16x32_bf16 v[70:73], a[72:75], v[178:181], v[70:73]
    ds_read_b64_tr_b16 a[52:53], v239 offset:12288
    ds_read_b64_tr_b16 a[54:55], v239 offset:12800
    v_mfma_f32_16x16x32_bf16 v[74:77], a[76:79], v[178:181], v[74:77]
    ds_read_b64_tr_b16 a[56:57], v240 offset:12288
    ds_read_b64_tr_b16 a[58:59], v240 offset:12800
    v_mfma_f32_16x16x32_bf16 v[78:81], a[64:67], v[182:185], v[78:81]
    ds_read_b64_tr_b16 a[60:61], v241 offset:12288
    ds_read_b64_tr_b16 a[62:63], v241 offset:12800
    v_mfma_f32_16x16x32_bf16 v[82:85], a[68:71], v[182:185], v[82:85]
    s_waitcnt vmcnt(30)
    v_max3_u32 v7, v186, v187, v188
    v_mfma_f32_16x16x32_bf16 v[86:89], a[72:75], v[182:185], v[86:89]
    v_max3_u32 v8, v189, v190, v191
    v_max3_u32 v7, v7, v192, v193
    v_mfma_f32_16x16x32_bf16 v[90:93], a[76:79], v[182:185], v[90:93]
    v_max_u32 v7, v7, v8
    v_cmp_eq_u32 vcc, -1, v7
    s_cbranch_vccnz L_gslow_67
L_gback_68:
    v_mfma_f32_16x16x32_bf16 v[62:65], a[80:83], v[186:189], v[62:65]
    s_waitcnt lgkmcnt(8)
    s_mov_b32 m0, s82
    s_add_u32 s82, s82, 4096
    global_load_lds_dwordx4 v234, s[80:81]
    global_load_lds_dwordx4 v235, s[80:81] offset:1024
    global_load_lds_dwordx4 v236, s[80:81] offset:2048
    global_load_lds_dwordx4 v237, s[80:81] offset:3072
    s_add_u32 s80, s80, 131072
    s_addc_u32 s81, s81, 0
    s_waitcnt vmcnt(63)
    v_mfma_f32_16x16x32_bf16 v[66:69], a[84:87], v[186:189], v[66:69]
    ds_read_b64_tr_b16 a[64:65], v238 offset:16384
    ds_read_b64_tr_b16 a[66:67], v238 offset:16896
    v_mfma_f32_16x16x32_bf16 v[70:73], a[88:91], v[186:189], v[70:73]
    ds_read_b64_tr_b16 a[68:69], v239 offset:16384
    ds_read_b64_tr_b16 a[70:71], v239 offset:16896
    v_mfma_f32_16x16x32_bf16 v[74:77], a[92:95], v[186:189], v[74:77]
    ds_read_b64_tr_b16 a[72:73], v240 offset:16384
    ds_read_b64_tr_b16 a[74:75], v240 offset:16896
    v_mfma_f32_16x16x32_bf16 v[78:81], a[80:83], v[190:193], v[78:81]
    ds_read_b64_tr_b16 a[76:77], v241 offset:16384
    ds_read_b64_tr_b16 a[78:79], v241 offset:16896
    v_mfma_f32_16x16x32_bf16 v[82:85], a[84:87], v[190:193], v[82:85]
    global_load_dword v249, v9, s[52:53] sc1
    s_waitcnt vmcnt(33)
    v_mfma_f32_16x16x32_bf16 v[86:89], a[88:91], v[190:193], v[86:89]
    v_max3_u32 v7, v194, v195, v196
    v_max3_u32 v8, v197, v198, v199
    v_mfma_f32_16x16x32_bf16 v[90:93], a[92:95], v[190:193], v[90:93]
    v_max3_u32 v7, v7, v200, v201
    v_max_u32 v7, v7, v8
    v_cmp_eq_u32 vcc, -1, v7
    s_cbranch_vccnz L_gslow_69
L_gback_70:
    v_mfma_f32_16x16x32_bf16 v[62:65], a[96:99], v[194:197], v[62:65]
    v_mfma_f32_16x16x32_bf16 v[66:69], a[100:103], v[194:197], v[66:69]
    s_waitcnt lgkmcnt(0)
    s_mov_b32 m0, s82
    s_add_u32 s82, s82, 4096
    global_load_lds_dwordx4 v234, s[80:81]
    global_load_lds_dwordx4 v235, s[80:81] offset:1024
    global_load_lds_dwordx4 v236, s[80:81] offset:2048
    global_load_lds_dwordx4 v237, s[80:81] offset:3072
    s_add_u32 s80, s80, 131072
    s_addc_u32 s81, s81, 0
    v_mfma_f32_16x16x32_bf16 v[70:73], a[104:107], v[194:197], v[70:73]
    s_waitcnt vmcnt(35)
    v_mfma_f32_16x16x32_bf16 v[74:77], a[108:111], v[194:197], v[74:77]
    v_max3_u32 v7, v202, v203, v204
    v_mfma_f32_16x16x32_bf16 v[78:81], a[96:99], v[198:201], v[78:81]
    v_max3_u32 v8, v205, v206, v207
    v_mfma_f32_16x16x32_bf16 v[82:85], a[100:103], v[198:201], v[82:85]
    v_max3_u32 v7, v7, v208, v209
    v_mfma_f32_16x16x32_bf16 v[86:89], a[104:107], v[198:201], v[86:89]
    v_max_u32 v7, v7, v8
    v_mfma_f32_16x16x32_bf16 v[90:93], a[108:111], v[198:201], v[90:93]
    v_cmp_eq_u32 vcc, -1, v7
    s_cbranch_vccnz L_gslow_71
L_gback_72:
    v_mfma_f32_16x16x32_bf16 v[62:65], a[112:115], v[202:205], v[62:65]
    v_mfma_f32_16x16x32_bf16 v[66:69], a[116:119], v[202:205], v[66:69]
    s_waitcnt lgkmcnt(0)
    s_mov_b32 m0, s82
    s_add_u32 s82, s82, 4096
    global_load_lds_dwordx4 v234, s[80:81]
    global_load_lds_dwordx4 v235, s[80:81] offset:1024
    v_mfma_f32_16x16x32_bf16 v[70:73], a[120:123], v[202:205], v[70:73]
    s_waitcnt vmcnt(35)
    v_mfma_f32_16x16x32_bf16 v[74:77], a[124:127], v[202:205], v[74:77]
    v_max3_u32 v7, v210, v211, v212
    v_mfma_f32_16x16x32_bf16 v[78:81], a[112:115], v[206:209], v[78:81]
    v_max3_u32 v8, v213, v214, v215
    v_mfma_f32_16x16x32_bf16 v[82:85], a[116:119], v[206:209], v[82:85]
    v_max3_u32 v7, v7, v216, v217
    v_mfma_f32_16x16x32_bf16 v[86:89], a[120:123], v[206:209], v[86:89]
    global_load_lds_dwordx4 v236, s[80:81] offset:2048
    global_load_lds_dwordx4 v237, s[80:81] offset:3072
    s_add_u32 s80, s80, 131072
    s_addc_u32 s81, s81, 0
    v_max_u32 v7, v7, v8
    v_mfma_f32_16x16x32_bf16 v[90:93], a[124:127], v[206:209], v[90:93]
    v_cmp_eq_u32 vcc, -1, v7
    s_cbranch_vccnz L_gslow_73
L_gback_74:
    s_waitcnt vmcnt(8)
L_h2poll_75:
    v_cmp_ne_u32 vcc, s10, v249
    s_cbranch_vccz L_h2ok_76
    s_add_u32 s69, s69, 1
    s_cmp_gt_u32 s69, 200000
    s_cbranch_scc1 L_h2ok_76
    s_sleep 8
    global_load_dword v249, v9, s[52:53] sc1
    s_waitcnt vmcnt(0)
    s_branch L_h2poll_75
L_h2ok_76:
    v_mfma_f32_16x16x32_bf16 v[62:65], a[128:131], v[210:213], v[62:65]
    v_mfma_f32_16x16x32_bf16 v[66:69], a[132:135], v[210:213], v[66:69]
    s_waitcnt vmcnt(35)
    v_mfma_f32_16x16x32_bf16 v[70:73], a[136:139], v[210:213], v[70:73]
    v_max3_u32 v7, v218, v219, v220
    v_mfma_f32_16x16x32_bf16 v[74:77], a[140:143], v[210:213], v[74:77]
    global_load_dwordx4 v[134:137], v2, s[64:65] offset:-4096 sc1
    v_max3_u32 v8, v221, v222, v223
    v_mfma_f32_16x16x32_bf16 v[78:81], a[128:131], v[214:217], v[78:81]
    v_mfma_f32_16x16x32_bf16 v[82:85], a[132:135], v[214:217], v[82:85]
    v_max3_u32 v7, v7, v224, v225
    v_mfma_f32_16x16x32_bf16 v[86:89], a[136:139], v[214:217], v[86:89]
    v_max_u32 v7, v7, v8
    v_mfma_f32_16x16x32_bf16 v[90:93], a[140:143], v[214:217], v[90:93]
    global_load_dwordx4 v[138:141], v3, s[64:65] offset:-4096 sc1
    v_cmp_eq_u32 vcc, -1, v7
    s_cbranch_vccnz L_gslow_77
L_gback_78:
    v_mfma_f32_16x16x32_bf16 v[62:65], a[144:147], v[218:221], v[62:65]
    v_mfma_f32_16x16x32_bf16 v[66:69], a[148:151], v[218:221], v[66:69]
    s_waitcnt vmcnt(35)
    v_mfma_f32_16x16x32_bf16 v[70:73], a[152:155], v[218:221], v[70:73]
    v_max3_u32 v7, v226, v227, v228
    v_mfma_f32_16x16x32_bf16 v[74:77], a[156:159], v[218:221], v[74:77]
    global_load_dwordx4 v[142:145], v4, s[64:65] offset:-4096 sc1
    v_max3_u32 v8, v229, v230, v231
    v_mfma_f32_16x16x32_bf16 v[78:81], a[144:147], v[222:225], v[78:81]
    v_mfma_f32_16x16x32_bf16 v[82:85], a[148:151], v[222:225], v[82:85]
    v_max3_u32 v7, v7, v232, v233
    v_mfma_f32_16x16x32_bf16 v[86:89], a[152:155], v[222:225], v[86:89]
    v_max_u32 v7, v7, v8
    v_mfma_f32_16x16x32_bf16 v[90:93], a[156:159], v[222:225], v[90:93]
    v_cmp_eq_u32 vcc, -1, v7
    global_load_dwordx4 v[146:149], v2, s[64:65] offset:-3072 sc1
    s_cbranch_vccnz L_gslow_79
L_gback_80:
    v_mfma_f32_16x16x32_bf16 v[62:65], a[160:163], v[226:229], v[62:65]
    v_mfma_f32_16x16x32_bf16 v[66:69], a[164:167], v[226:229], v[66:69]
    s_waitcnt vmcnt(35)
    v_mfma_f32_16x16x32_bf16 v[70:73], a[168:171], v[226:229], v[70:73]
    v_max3_u32 v7, v94, v95, v96
    v_mfma_f32_16x16x32_bf16 v[74:77], a[172:175], v[226:229], v[74:77]
    v_max3_u32 v8, v97, v98, v99
    global_load_dwordx4 v[150:153], v3, s[64:65] offset:-3072 sc1
    v_mfma_f32_16x16x32_bf16 v[78:81], a[160:163], v[230:233], v[78:81]
    v_mfma_f32_16x16x32_bf16 v[82:85], a[164:167], v[230:233], v[82:85]
    v_max3_u32 v7, v7, v100, v101
    v_mfma_f32_16x16x32_bf16 v[86:89], a[168:171], v[230:233], v[86:89]
    v_max_u32 v7, v7, v8
    v_mfma_f32_16x16x32_bf16 v[90:93], a[172:175], v[230:233], v[90:93]
    v_cmp_eq_u32 vcc, -1, v7
    s_cbranch_vccnz L_gslow_81
L_gback_82:
    global_load_dwordx4 v[154:157], v4, s[64:65] offset:-3072 sc1
    v_mfma_f32_16x16x32_bf16 v[62:65], a[176:179], v[94:97], v[62:65]
    s_waitcnt vmcnt(23)
    v_mfma_f32_16x16x32_bf16 v[66:69], a[180:183], v[94:97], v[66:69]
    ds_read_b64_tr_b16 a[80:81], v238 offset:0
    ds_read_b64_tr_b16 a[82:83], v238 offset:512
    v_mfma_f32_16x16x32_bf16 v[70:73], a[184:187], v[94:97], v[70:73]
    ds_read_b64_tr_b16 a[84:85], v239 offset:0
    ds_read_b64_tr_b16 a[86:87], v239 offset:512
    v_mfma_f32_16x16x32_bf16 v[74:77], a[188:191], v[94:97], v[74:77]
    global_load_dwordx4 v[158:161], v2, s[64:65] offset:-2048 sc1
    ds_read_b64_tr_b16 a[88:89], v240 offset:0
    ds_read_b64_tr_b16 a[90:91], v240 offset:512
    v_mfma_f32_16x16x32_bf16 v[78:81], a[176:179], v[98:101], v[78:81]
    ds_read_b64_tr_b16 a[92:93], v241 offset:0
    ds_read_b64_tr_b16 a[94:95], v241 offset:512
    v_mfma_f32_16x16x32_bf16 v[82:85], a[180:183], v[98:101], v[82:85]
    s_waitcnt vmcnt(36)
    v_max3_u32 v7, v102, v103, v104
    v_mfma_f32_16x16x32_bf16 v[86:89], a[184:187], v[98:101], v[86:89]
    global_load_dwordx4 v[162:165], v3, s[64:65] offset:-2048 sc1
    v_max3_u32 v8, v105, v106, v107
    v_max3_u32 v7, v7, v108, v109
    v_mfma_f32_16x16x32_bf16 v[90:93], a[188:191], v[98:101], v[90:93]
    v_max_u32 v7, v7, v8
    v_cmp_eq_u32 vcc, -1, v7
    s_cbranch_vccnz L_gslow_83
L_gback_84:
    v_mfma_f32_16x16x32_bf16 v[62:65], a[192:195], v[102:105], v[62:65]
    s_waitcnt vmcnt(21)
    v_mfma_f32_16x16x32_bf16 v[66:69], a[196:199], v[102:105], v[66:69]
    ds_read_b64_tr_b16 a[96:97], v238 offset:4096
    global_load_dwordx4 v[166:169], v4, s[64:65] offset:-2048 sc1
    ds_read_b64_tr_b16 a[98:99], v238 offset:4608
    v_mfma_f32_16x16x32_bf16 v[70:73], a[200:203], v[102:105], v[70:73]
    ds_read_b64_tr_b16 a[100:101], v239 offset:4096
    ds_read_b64_tr_b16 a[102:103], v239 offset:4608
    v_mfma_f32_16x16x32_bf16 v[74:77], a[204:207], v[102:105], v[74:77]
    ds_read_b64_tr_b16 a[104:105], v240 offset:4096
    ds_read_b64_tr_b16 a[106:107], v240 offset:4608
    v_mfma_f32_16x16x32_bf16 v[78:81], a[192:195], v[106:109], v[78:81]
    global_load_dwordx4 v[170:173], v2, s[64:65] offset:-1024 sc1
    ds_read_b64_tr_b16 a[108:109], v241 offset:4096
    ds_read_b64_tr_b16 a[110:111], v241 offset:4608
    v_mfma_f32_16x16x32_bf16 v[82:85], a[196:199], v[106:109], v[82:85]
    s_waitcnt vmcnt(37)
    v_max3_u32 v7, v110, v111, v112
    v_mfma_f32_16x16x32_bf16 v[86:89], a[200:203], v[106:109], v[86:89]
    v_max3_u32 v8, v113, v114, v115
    v_max3_u32 v7, v7, v116, v117
    v_mfma_f32_16x16x32_bf16 v[90:93], a[204:207], v[106:109], v[90:93]
    v_max_u32 v7, v7, v8
    v_cmp_eq_u32 vcc, -1, v7
    global_load_dwordx4 v[174:177], v3, s[64:65] offset:-1024 sc1
    s_cbranch_vccnz L_gslow_85
L_gback_86:
    v_mfma_f32_16x16x32_bf16 v[62:65], a[208:211], v[110:113], v[62:65]
    s_waitcnt vmcnt(20)
    v_mfma_f32_16x16x32_bf16 v[66:69], a[212:215], v[110:113], v[66:69]
    ds_read_b64_tr_b16 a[112:113], v238 offset:8192
    ds_read_b64_tr_b16 a[114:115], v238 offset:8704
    v_mfma_f32_16x16x32_bf16 v[70:73], a[216:219], v[110:113], v[70:73]
    ds_read_b64_tr_b16 a[116:117], v239 offset:8192
    ds_read_b64_tr_b16 a[118:119], v239 offset:8704
    global_load_dwordx4 v[178:181], v4, s[64:65] offset:-1024 sc1
    v_mfma_f32_16x16x32_bf16 v[74:77], a[220:223], v[110:113], v[74:77]
    ds_read_b64_tr_b16 a[120:121], v240 offset:8192
    ds_read_b64_tr_b16 a[122:123], v240 offset:8704
    v_mfma_f32_16x16x32_bf16 v[78:81], a[208:211], v[114:117], v[78:81]
    ds_read_b64_tr_b16 a[124:125], v241 offset:8192
    ds_read_b64_tr_b16 a[126:127], v241 offset:8704
    v_mfma_f32_16x16x32_bf16 v[82:85], a[212:215], v[114:117], v[82:85]
    s_waitcnt vmcnt(37)
    global_load_dwordx4 v[182:185], v2, s[64:65] offset:0 sc1
    v_max3_u32 v7, v118, v119, v120
    v_mfma_f32_16x16x32_bf16 v[86:89], a[216:219], v[114:117], v[86:89]
    v_max3_u32 v8, v121, v122, v123
    v_max3_u32 v7, v7, v124, v125
    v_mfma_f32_16x16x32_bf16 v[90:93], a[220:223], v[114:117], v[90:93]
    v_max_u32 v7, v7, v8
    v_cmp_eq_u32 vcc, -1, v7
    s_cbranch_vccnz L_gslow_87
L_gback_88:
    v_mfma_f32_16x16x32_bf16 v[62:65], a[224:227], v[118:121], v[62:65]
    s_waitcnt vmcnt(17)
    v_mfma_f32_16x16x32_bf16 v[66:69], a[228:231], v[118:121], v[66:69]
    global_load_dwordx4 v[186:189], v3, s[64:65] offset:0 sc1
    ds_read_b64_tr_b16 a[128:129], v238 offset:12288
    ds_read_b64_tr_b16 a[130:131], v238 offset:12800
    v_mfma_f32_16x16x32_bf16 v[70:73], a[232:235], v[118:121], v[70:73]
    ds_read_b64_tr_b16 a[132:133], v239 offset:12288
    ds_read_b64_tr_b16 a[134:135], v239 offset:12800
    v_mfma_f32_16x16x32_bf16 v[74:77], a[236:239], v[118:121], v[74:77]
    ds_read_b64_tr_b16 a[136:137], v240 offset:12288
    ds_read_b64_tr_b16 a[138:139], v240 offset:12800
    global_load_dwordx4 v[190:193], v4, s[64:65] offset:0 sc1
    v_mfma_f32_16x16x32_bf16 v[78:81], a[224:227], v[122:125], v[78:81]
    ds_read_b64_tr_b16 a[140:141], v241 offset:12288
    ds_read_b64_tr_b16 a[142:143], v241 offset:12800
    v_mfma_f32_16x16x32_bf16 v[82:85], a[228:231], v[122:125], v[82:85]
    s_waitcnt vmcnt(38)
    v_max3_u32 v7, v126, v127, v128
    v_mfma_f32_16x16x32_bf16 v[86:89], a[232:235], v[122:125], v[86:89]
    v_max3_u32 v8, v129, v130, v131
    v_max3_u32 v7, v7, v132, v133
    v_mfma_f32_16x16x32_bf16 v[90:93], a[236:239], v[122:125], v[90:93]
    v_max_u32 v7, v7, v8
    v_cmp_eq_u32 vcc, -1, v7
    s_cbranch_vccnz L_gslow_89
L_gback_90:
    v_mfma_f32_16x16x32_bf16 v[62:65], a[240:243], v[126:129], v[62:65]
    s_waitcnt vmcnt(15)
    v_mfma_f32_16x16x32_bf16 v[66:69], a[244:247], v[126:129], v[66:69]
    ds_read_b64_tr_b16 a[144:145], v238 offset:16384
    v_mfma_f32_16x16x32_bf16 v[70:73], a[248:251], v[126:129], v[70:73]
    ds_read_b64_tr_b16 a[146:147], v238 offset:16896
    v_mfma_f32_16x16x32_bf16 v[74:77], a[252:255], v[126:129], v[74:77]
    ds_read_b64_tr_b16 a[148:149], v239 offset:16384
    v_mfma_f32_16x16x32_bf16 v[78:81], a[240:243], v[130:133], v[78:81]
    ds_read_b64_tr_b16 a[150:151], v239 offset:16896
    v_mfma_f32_16x16x32_bf16 v[82:85], a[244:247], v[130:133], v[82:85]
    ds_read_b64_tr_b16 a[152:153], v240 offset:16384
    v_mfma_f32_16x16x32_bf16 v[86:89], a[248:251], v[130:133], v[86:89]
    ds_read_b64_tr_b16 a[154:155], v240 offset:16896
    v_mfma_f32_16x16x32_bf16 v[90:93], a[252:255], v[130:133], v[90:93]
    ds_read_b64_tr_b16 a[156:157], v241 offset:16384
    ds_read_b64_tr_b16 a[158:159], v241 offset:16896
L_gdone_56:
    s_waitcnt lgkmcnt(0)
    s_barrier
    s_mul_i32 s82, s3, 32768
    s_mov_b32 m0, s82
    s_add_u32 s82, s82, 4096
    global_load_lds_dwordx4 v234, s[80:81]
    global_load_lds_dwordx4 v235, s[80:81] offset:1024
    global_load_lds_dwordx4 v236, s[80:81] offset:2048
    global_load_lds_dwordx4 v237, s[80:81] offset:3072
    s_add_u32 s80, s80, 131072
    s_addc_u32 s81, s81, 0
    ds_write_b128 v242, v[66:69] offset:0
    s_mov_b32 m0, s82
    s_add_u32 s82, s82, 4096
    global_load_lds_dwordx4 v234, s[80:81]
    global_load_lds_dwordx4 v235, s[80:81] offset:1024
    ds_write_b128 v242, v[82:85] offset:1024
    ds_write_b128 v243, v[70:73] offset:0
    ds_write_b128 v243, v[86:89] offset:1024
    ds_write_b128 v244, v[74:77] offset:0
    global_load_lds_dwordx4 v236, s[80:81] offset:2048
    global_load_lds_dwordx4 v237, s[80:81] offset:3072
    s_add_u32 s80, s80, 131072
    s_addc_u32 s81, s81, 0
    ds_write_b128 v244, v[90:93] offset:1024
    s_mul_i32 s54, s75, 276480
    v_lshl_add_u32 v11, v1, 4, s54
    v_add_u32 v5, 165888, v11
    v_add_u32 v6, 221184, v11
    s_waitcnt lgkmcnt(0)
    s_barrier
    s_mov_b32 m0, s82
    s_add_u32 s82, s82, 4096
    global_load_lds_dwordx4 v234, s[80:81]
    global_load_lds_dwordx4 v235, s[80:81] offset:1024
    ds_read_b128 v[66:69], v245 offset:0
    ds_read_b128 v[70:73], v245 offset:3072
    ds_read_b128 v[74:77], v245 offset:6144
    ds_read_b128 v[82:85], v245 offset:1024
    ds_read_b128 v[86:89], v245 offset:4096
    ds_read_b128 v[90:93], v245 offset:7168
    s_waitcnt lgkmcnt(3)
    v_pk_add_f32 v[62:63], v[62:63], v[66:67]
    v_pk_add_f32 v[70:71], v[70:71], v[74:75]
    v_pk_add_f32 v[64:65], v[64:65], v[68:69]
    v_pk_add_f32 v[72:73], v[72:73], v[76:77]
    s_waitcnt lgkmcnt(0)
    v_pk_add_f32 v[78:79], v[78:79], v[82:83]
    v_pk_add_f32 v[86:87], v[86:87], v[90:91]
    v_pk_add_f32 v[80:81], v[80:81], v[84:85]
    v_pk_add_f32 v[88:89], v[88:89], v[92:93]
    v_pk_add_f32 v[62:63], v[62:63], v[70:71]
    v_pk_add_f32 v[64:65], v[64:65], v[72:73]
    v_pk_add_f32 v[78:79], v[78:79], v[86:87]
    global_load_lds_dwordx4 v236, s[80:81] offset:2048
    global_load_lds_dwordx4 v237, s[80:81] offset:3072
    s_lshl_b32 s83, s93, 17
    s_sub_u32 s83, 131072, s83
    s_add_u32 s80, s80, s83
    s_addc_u32 s81, s81, 0
    v_pk_add_f32 v[80:81], v[80:81], v[88:89]
    v_cvt_pk_bf16_f32 v63, v62, v63
    v_cvt_pk_bf16_f32 v65, v64, v65
    v_cvt_pk_bf16_f32 v79, v78, v79
    v_cvt_pk_bf16_f32 v81, v80, v81
    v_lshlrev_b32 v62, 16, v63
    v_and_b32 v63, 0xffff0000, v63
    v_lshlrev_b32 v64, 16, v65
    v_and_b32 v65, 0xffff0000, v65
    v_lshlrev_b32 v78, 16, v79
    v_and_b32 v79, 0xffff0000, v79
    v_lshlrev_b32 v80, 16, v81
    v_and_b32 v81, 0xffff0000, v81
    v_pk_add_f32 v[62:63], v[62:63], v[250:251]
    v_pk_add_f32 v[64:65], v[64:65], v[252:253]
    v_pk_add_f32 v[78:79], v[78:79], v[250:251]
    v_pk_add_f32 v[80:81], v[80:81], v[252:253]
    v_cvt_pk_bf16_f32 v63, v62, v63
    v_cvt_pk_bf16_f32 v65, v64, v65
    v_cvt_pk_bf16_f32 v79, v78, v79
    v_cvt_pk_bf16_f32 v81, v80, v81
    v_lshlrev_b32 v62, 16, v63
    v_and_b32 v63, 0xffff0000, v63
    v_lshlrev_b32 v64, 16, v65
    v_and_b32 v65, 0xffff0000, v65
    s_mov_b32 m0, s82
    s_add_u32 s82, s82, 4096
    global_load_lds_dwordx4 v234, s[80:81]
    global_load_lds_dwordx4 v235, s[80:81] offset:1024
    v_lshlrev_b32 v78, 16, v79
    v_and_b32 v79, 0xffff0000, v79
    v_lshlrev_b32 v80, 16, v81
    v_and_b32 v81, 0xffff0000, v81
    v_pk_mul_f32 v[66:67], v[62:63], v[62:63]
    v_pk_mul_f32 v[68:69], v[64:65], v[64:65]
    v_pk_mul_f32 v[82:83], v[78:79], v[78:79]
    v_pk_mul_f32 v[84:85], v[80:81], v[80:81]
    v_pk_fma_f32 v[66:67], v[66:67], v[12:13], v[10:11] op_sel_hi:[1,0,0]
    v_pk_fma_f32 v[68:69], v[68:69], v[12:13], v[10:11] op_sel_hi:[1,0,0]
    v_pk_fma_f32 v[82:83], v[82:83], v[12:13], v[10:11] op_sel_hi:[1,0,0]
    v_pk_fma_f32 v[84:85], v[84:85], v[12:13], v[10:11] op_sel_hi:[1,0,0]
    v_pk_mul_f32 v[66:67], v[66:67], v[62:63]
    v_pk_mul_f32 v[68:69], v[68:69], v[64:65]
    v_pk_mul_f32 v[82:83], v[82:83], v[78:79]
    v_pk_mul_f32 v[84:85], v[84:85], v[80:81]
    v_exp_f32 v66, v66
    v_exp_f32 v67, v67
    v_exp_f32 v68, v68
    v_exp_f32 v69, v69
    v_exp_f32 v82, v82
    v_exp_f32 v83, v83
    v_exp_f32 v84, v84
    global_load_lds_dwordx4 v236, s[80:81] offset:2048
    global_load_lds_dwordx4 v237, s[80:81] offset:3072
    s_add_u32 s80, s80, 131072
    s_addc_u32 s81, s81, 0
    v_exp_f32 v85, v85
    v_pk_add_f32 v[66:67], v[66:67], 1.0 op_sel_hi:[1,0]
    v_pk_add_f32 v[68:69], v[68:69], 1.0 op_sel_hi:[1,0]
    v_pk_add_f32 v[82:83], v[82:83], 1.0 op_sel_hi:[1,0]
    v_pk_add_f32 v[84:85], v[84:85], 1.0 op_sel_hi:[1,0]
    v_rcp_f32 v66, v66
    v_rcp_f32 v67, v67
    v_rcp_f32 v68, v68
    v_rcp_f32 v69, v69
    v_rcp_f32 v82, v82
    v_rcp_f32 v83, v83
    v_rcp_f32 v84, v84
    v_rcp_f32 v85, v85
    v_pk_mul_f32 v[62:63], v[62:63], v[66:67]
    v_pk_mul_f32 v[64:65], v[64:65], v[68:69]
    v_pk_mul_f32 v[78:79], v[78:79], v[82:83]
    v_pk_mul_f32 v[80:81], v[80:81], v[84:85]
    v_cvt_pk_bf16_f32 v70, v62, v63
    v_cvt_pk_bf16_f32 v72, v78, v79
    global_load_dwordx4 v[194:197], v2, s[64:65] offset:1024 sc1
    v_cvt_pk_bf16_f32 v71, v64, v65
    v_cvt_pk_bf16_f32 v73, v80, v81
    v_min_u32 v70, 0xfffffffe, v70
    v_min_u32 v71, 0xfffffffe, v71
    v_min_u32 v72, 0xfffffffe, v72
    v_min_u32 v73, 0xfffffffe, v73
    s_nop 0
    v_permlane16_swap_b32 v70, v72
    v_permlane16_swap_b32 v71, v73
    global_store_dwordx4 v248, v[70:73], s[50:51] sc1
L_g2a:
    s_waitcnt vmcnt(30)
    v_max3_u32 v7, v134, v135, v136
    v_max3_u32 v8, v137, v138, v139
    v_max3_u32 v7, v7, v140, v141
    v_max3_u32 v8, v8, v142, v143
    global_load_dwordx4 v[198:201], v3, s[64:65] offset:1024 sc1
    v_max3_u32 v7, v7, v144, v145
    v_max_u32 v7, v7, v8
    v_cmp_eq_u32 vcc, -1, v7
    s_cbranch_vccnz L_gslow_92
L_gback_93:
    v_mfma_f32_16x16x32_bf16 v[14:17], v[134:137], a[0:3], 0
    s_mul_i32 s60, s78, 81920
    s_mul_i32 s61, s75, 1280
    s_add_u32 s60, s60, s61
    v_mfma_f32_16x16x32_bf16 v[18:21], v[134:137], a[4:7], 0
    v_add_u32 v9, 0, v0
    v_mul_u32_u24 v11, 820, v9
    v_lshrrev_b32 v11, 16, v11
    v_mfma_f32_16x16x32_bf16 v[22:25], v[134:137], a[8:11], 0
    global_load_dwordx4 v[202:205], v4, s[64:65] offset:1024 sc1
    v_mul_u32_u24 v13, 80, v11
    v_sub_u32 v13, v9, v13
    v_mul_u32_u24 v9, 10240, v11
    v_mfma_f32_16x16x32_bf16 v[26:29], v[134:137], a[12:15], 0
    v_lshl_add_u32 v9, v13, 4, v9
    v_add_u32 v9, s60, v9
    global_load_dwordx4 a[224:227], v9, s[14:15] sc1
    v_mfma_f32_16x16x32_bf16 v[30:33], v[138:141], a[0:3], 0
    s_waitcnt vmcnt(30)
    v_mfma_f32_16x16x32_bf16 v[34:37], v[138:141], a[4:7], 0
    v_max3_u32 v7, v146, v147, v148
    global_load_dwordx4 v[206:209], v2, s[64:65] offset:2048 sc1
    v_mfma_f32_16x16x32_bf16 v[38:41], v[138:141], a[8:11], 0
    v_max3_u32 v8, v149, v150, v151
    v_mfma_f32_16x16x32_bf16 v[42:45], v[138:141], a[12:15], 0
    v_max3_u32 v7, v7, v152, v153
    v_mfma_f32_16x16x32_bf16 v[46:49], v[142:145], a[0:3], 0
    v_max3_u32 v8, v8, v154, v155
    v_mfma_f32_16x16x32_bf16 v[50:53], v[142:145], a[4:7], 0
    v_max3_u32 v7, v7, v156, v157
    v_mfma_f32_16x16x32_bf16 v[54:57], v[142:145], a[8:11], 0
    global_load_dwordx4 v[210:213], v3, s[64:65] offset:2048 sc1
    v_max_u32 v7, v7, v8
    v_mfma_f32_16x16x32_bf16 v[58:61], v[142:145], a[12:15], 0
    v_cmp_eq_u32 vcc, -1, v7
    s_cbranch_vccnz L_gslow_94
L_gback_95:
    v_mfma_f32_16x16x32_bf16 v[14:17], v[146:149], a[16:19], v[14:17]
    v_mul_u32_u24 v9, 1408, v11
    v_lshl_add_u32 v9, v13, 1, v9
    v_add_u32 v251, 147456, v9
    v_mfma_f32_16x16x32_bf16 v[18:21], v[146:149], a[20:23], v[18:21]
    v_add_u32 v9, 256, v0
    v_mul_u32_u24 v11, 820, v9
    global_load_dwordx4 v[214:217], v4, s[64:65] offset:2048 sc1
    v_lshrrev_b32 v11, 16, v11
    v_mfma_f32_16x16x32_bf16 v[22:25], v[146:149], a[24:27], v[22:25]
    v_mul_u32_u24 v13, 80, v11
    v_sub_u32 v13, v9, v13
    v_mul_u32_u24 v9, 10240, v11
    v_mfma_f32_16x16x32_bf16 v[26:29], v[146:149], a[28:31], v[26:29]
    v_lshl_add_u32 v9, v13, 4, v9
    v_add_u32 v9, s60, v9
    global_load_dwordx4 a[228:231], v9, s[14:15] sc1
    v_mfma_f32_16x16x32_bf16 v[30:33], v[150:153], a[16:19], v[30:33]
    s_waitcnt vmcnt(31)
    v_mfma_f32_16x16x32_bf16 v[34:37], v[150:153], a[20:23], v[34:37]
    global_load_dwordx4 v[218:221], v2, s[64:65] offset:3072 sc1
    v_max3_u32 v7, v158, v159, v160
    v_mfma_f32_16x16x32_bf16 v[38:41], v[150:153], a[24:27], v[38:41]
    v_max3_u32 v8, v161, v162, v163
    v_mfma_f32_16x16x32_bf16 v[42:45], v[150:153], a[28:31], v[42:45]
    v_max3_u32 v7, v7, v164, v165
    v_mfma_f32_16x16x32_bf16 v[46:49], v[154:157], a[16:19], v[46:49]
    v_max3_u32 v8, v8, v166, v167
    v_mfma_f32_16x16x32_bf16 v[50:53], v[154:157], a[20:23], v[50:53]
    global_load_dwordx4 v[222:225], v3, s[64:65] offset:3072 sc1
    v_max3_u32 v7, v7, v168, v169
    v_mfma_f32_16x16x32_bf16 v[54:57], v[154:157], a[24:27], v[54:57]
    v_max_u32 v7, v7, v8
    v_mfma_f32_16x16x32_bf16 v[58:61], v[154:157], a[28:31], v[58:61]
    v_cmp_eq_u32 vcc, -1, v7
    s_cbranch_vccnz L_gslow_96
L_gback_97:
    v_mfma_f32_16x16x32_bf16 v[14:17], v[158:161], a[32:35], v[14:17]
    v_mul_u32_u24 v9, 1408, v11
    v_lshl_add_u32 v9, v13, 1, v9
    v_add_u32 v252, 147456, v9
    v_mfma_f32_16x16x32_bf16 v[18:21], v[158:161], a[36:39], v[18:21]
    global_load_dwordx4 v[226:229], v4, s[64:65] offset:3072 sc1
    v_add_u32 v9, 512, v0
    v_min_u32 v9, 639, v9
    v_mul_u32_u24 v11, 820, v9
    v_lshrrev_b32 v11, 16, v11
    v_mfma_f32_16x16x32_bf16 v[22:25], v[158:161], a[40:43], v[22:25]
    v_mul_u32_u24 v13, 80, v11
    v_sub_u32 v13, v9, v13
    v_mul_u32_u24 v9, 10240, v11
    v_mfma_f32_16x16x32_bf16 v[26:29], v[158:161], a[44:47], v[26:29]
    v_lshl_add_u32 v9, v13, 4, v9
    v_add_u32 v9, s60, v9
    global_load_dwordx4 a[232:235], v9, s[14:15] sc1
    global_load_dwordx4 v[230:233], v2, s[66:67] offset:-4096 sc1
    v_mfma_f32_16x16x32_bf16 v[30:33], v[162:165], a[32:35], v[30:33]
    s_waitcnt vmcnt(33)
    v_mfma_f32_16x16x32_bf16 v[34:37], v[162:165], a[36:39], v[34:37]
    v_max3_u32 v7, v170, v171, v172
    v_mfma_f32_16x16x32_bf16 v[38:41], v[162:165], a[40:43], v[38:41]
    v_max3_u32 v8, v173, v174, v175
    v_mfma_f32_16x16x32_bf16 v[42:45], v[162:165], a[44:47], v[42:45]
    v_max3_u32 v7, v7, v176, v177
    v_mfma_f32_16x16x32_bf16 v[46:49], v[166:169], a[32:35], v[46:49]
    global_load_dwordx4 v[94:97], v3, s[66:67] offset:-4096 sc1
    v_max3_u32 v8, v8, v178, v179
    v_mfma_f32_16x16x32_bf16 v[50:53], v[166:169], a[36:39], v[50:53]
    v_max3_u32 v7, v7, v180, v181
    v_mfma_f32_16x16x32_bf16 v[54:57], v[166:169], a[40:43], v[54:57]
    v_max_u32 v7, v7, v8
    v_mfma_f32_16x16x32_bf16 v[58:61], v[166:169], a[44:47], v[58:61]
    v_cmp_eq_u32 vcc, -1, v7
    s_cbranch_vccnz L_gslow_98
L_gback_99:
    v_mfma_f32_16x16x32_bf16 v[14:17], v[170:173], a[48:51], v[14:17]
    global_load_dwordx4 v[98:101], v4, s[66:67] offset:-4096 sc1
    v_mul_u32_u24 v9, 1408, v11
    v_lshl_add_u32 v9, v13, 1, v9
    v_add_u32 v253, 147456, v9
    v_mfma_f32_16x16x32_bf16 v[18:21], v[170:173], a[52:55], v[18:21]
    s_lshl_b32 s60, s3, 4
    v_and_b32 v9, 15, v1
    v_add_u32 v9, s60, v9
    s_lshl_b32 s61, s78, 7
    v_mfma_f32_16x16x32_bf16 v[22:25], v[170:173], a[56:59], v[22:25]
    v_lshl_add_u32 v11, v9, 1, s61
    global_load_ushort v250, v11, s[38:39]
    v_lshrrev_b32 v13, 4, v1
    v_mfma_f32_16x16x32_bf16 v[26:29], v[170:173], a[60:63], v[26:29]
    global_load_dwordx4 v[102:105], v2, s[66:67] offset:-3072 sc1
    v_mul_u32_u24 v11, 176, v9
    v_lshl_add_u32 v11, v13, 3, v11
    v_add_u32 v249, 147456, v11
    v_mfma_f32_16x16x32_bf16 v[30:33], v[174:177], a[48:51], v[30:33]
    s_waitcnt vmcnt(34)
    v_mfma_f32_16x16x32_bf16 v[34:37], v[174:177], a[52:55], v[34:37]
    v_max3_u32 v7, v182, v183, v184
    v_mfma_f32_16x16x32_bf16 v[38:41], v[174:177], a[56:59], v[38:41]
    v_max3_u32 v8, v185, v186, v187
    v_mfma_f32_16x16x32_bf16 v[42:45], v[174:177], a[60:63], v[42:45]
    global_load_dwordx4 v[106:109], v3, s[66:67] offset:-3072 sc1
    v_max3_u32 v7, v7, v188, v189
    v_mfma_f32_16x16x32_bf16 v[46:49], v[178:181], a[48:51], v[46:49]
    v_max3_u32 v8, v8, v190, v191
    v_mfma_f32_16x16x32_bf16 v[50:53], v[178:181], a[52:55], v[50:53]
    v_max3_u32 v7, v7, v192, v193
    v_mfma_f32_16x16x32_bf16 v[54:57], v[178:181], a[56:59], v[54:57]
    v_max_u32 v7, v7, v8
    v_mfma_f32_16x16x32_bf16 v[58:61], v[178:181], a[60:63], v[58:61]
    global_load_dwordx4 v[110:113], v4, s[66:67] offset:-3072 sc1
    v_cmp_eq_u32 vcc, -1, v7
    s_cbranch_vccnz L_gslow_100
L_gback_101:
    v_mfma_f32_16x16x32_bf16 v[14:17], v[182:185], a[64:67], v[14:17]
    v_mfma_f32_16x16x32_bf16 v[18:21], v[182:185], a[68:71], v[18:21]
    s_mul_i32 s60, s78, 81920
    s_mul_i32 s61, s75, 160
    s_add_u32 s60, s60, s61
    v_mul_u32_u24 v11, 1280, v9
    v_mfma_f32_16x16x32_bf16 v[22:25], v[182:185], a[72:75], v[22:25]
    v_lshrrev_b32 v9, 1, v13
    global_load_dwordx4 v[114:117], v2, s[66:67] offset:-2048 sc1
    v_lshl_add_u32 v11, v9, 4, v11
    v_add_u32 v11, s60, v11
    v_add_u32 v247, 64, v11
    v_mfma_f32_16x16x32_bf16 v[26:29], v[182:185], a[76:79], v[26:29]
    v_and_b32 v13, 1, v13
    v_lshl_add_u32 v246, v13, 5, v11
    v_add_u32 v248, 96, v246
    v_mfma_f32_16x16x32_bf16 v[30:33], v[186:189], a[64:67], v[30:33]
    s_waitcnt vmcnt(17)
    global_load_dwordx4 v[118:121], v3, s[66:67] offset:-2048 sc1
    global_load_dwordx4 v[122:125], v4, s[66:67] offset:-2048 sc1
    global_load_dwordx4 v[126:129], v2, s[66:67] offset:-1024 sc1
    v_mfma_f32_16x16x32_bf16 v[34:37], v[186:189], a[68:71], v[34:37]
    global_load_dwordx4 v[130:133], v3, s[66:67] offset:-1024 sc1
    v_max3_u32 v7, v194, v195, v196
    v_mfma_f32_16x16x32_bf16 v[38:41], v[186:189], a[72:75], v[38:41]
    v_max3_u32 v8, v197, v198, v199
    v_mfma_f32_16x16x32_bf16 v[42:45], v[186:189], a[76:79], v[42:45]
    v_max3_u32 v7, v7, v200, v201
    v_mfma_f32_16x16x32_bf16 v[46:49], v[190:193], a[64:67], v[46:49]
    v_max3_u32 v8, v8, v202, v203
    v_mfma_f32_16x16x32_bf16 v[50:53], v[190:193], a[68:71], v[50:53]
    global_load_dwordx4 v[134:137], v4, s[66:67] offset:-1024 sc1
    v_max3_u32 v7, v7, v204, v205
    v_mfma_f32_16x16x32_bf16 v[54:57], v[190:193], a[72:75], v[54:57]
    v_max_u32 v7, v7, v8
    v_mfma_f32_16x16x32_bf16 v[58:61], v[190:193], a[76:79], v[58:61]
    v_cmp_eq_u32 vcc, -1, v7
    s_cbranch_vccnz L_gslow_102
L_gback_103:
    v_mfma_f32_16x16x32_bf16 v[14:17], v[194:197], a[80:83], v[14:17]
    s_waitcnt vmcnt(38)
    v_mfma_f32_16x16x32_bf16 v[18:21], v[194:197], a[84:87], v[18:21]
    ds_read_b64_tr_b16 a[160:161], v238 offset:0
    global_load_dwordx4 v[138:141], v2, s[66:67] offset:0 sc1
    v_mfma_f32_16x16x32_bf16 v[22:25], v[194:197], a[88:91], v[22:25]
    ds_read_b64_tr_b16 a[162:163], v238 offset:512
    ds_read_b64_tr_b16 a[164:165], v239 offset:0
    v_mfma_f32_16x16x32_bf16 v[26:29], v[194:197], a[92:95], v[26:29]
    ds_read_b64_tr_b16 a[166:167], v239 offset:512
    v_mfma_f32_16x16x32_bf16 v[30:33], v[198:201], a[80:83], v[30:33]
    ds_read_b64_tr_b16 a[168:169], v240 offset:0
    ds_read_b64_tr_b16 a[170:171], v240 offset:512
    global_load_dwordx4 v[142:145], v3, s[66:67] offset:0 sc1
    v_mfma_f32_16x16x32_bf16 v[34:37], v[198:201], a[84:87], v[34:37]
    ds_read_b64_tr_b16 a[172:173], v241 offset:0
    v_mfma_f32_16x16x32_bf16 v[38:41], v[198:201], a[88:91], v[38:41]
    ds_read_b64_tr_b16 a[174:175], v241 offset:512
    v_mfma_f32_16x16x32_bf16 v[42:45], v[198:201], a[92:95], v[42:45]
    s_waitcnt vmcnt(20)
    v_max3_u32 v7, v206, v207, v208
    v_mfma_f32_16x16x32_bf16 v[46:49], v[202:205], a[80:83], v[46:49]
    v_max3_u32 v8, v209, v210, v211
    v_mfma_f32_16x16x32_bf16 v[50:53], v[202:205], a[84:87], v[50:53]
    global_load_dwordx4 v[146:149], v4, s[66:67] offset:0 sc1
    v_max3_u32 v7, v7, v212, v213
    v_max3_u32 v8, v8, v214, v215
    v_mfma_f32_16x16x32_bf16 v[54:57], v[202:205], a[88:91], v[54:57]
    v_max3_u32 v7, v7, v216, v217
    v_mfma_f32_16x16x32_bf16 v[58:61], v[202:205], a[92:95], v[58:61]
    v_max_u32 v7, v7, v8
    v_cmp_eq_u32 vcc, -1, v7
    s_cbranch_vccnz L_gslow_104
L_gback_105:
    v_mfma_f32_16x16x32_bf16 v[14:17], v[206:209], a[96:99], v[14:17]
    s_waitcnt vmcnt(37)
    global_load_dwordx4 v[150:153], v2, s[66:67] offset:1024 sc1
    v_mfma_f32_16x16x32_bf16 v[18:21], v[206:209], a[100:103], v[18:21]
    ds_read_b64_tr_b16 a[176:177], v238 offset:4096
    v_mfma_f32_16x16x32_bf16 v[22:25], v[206:209], a[104:107], v[22:25]
    ds_read_b64_tr_b16 a[178:179], v238 offset:4608
    ds_read_b64_tr_b16 a[180:181], v239 offset:4096
    v_mfma_f32_16x16x32_bf16 v[26:29], v[206:209], a[108:111], v[26:29]
    ds_read_b64_tr_b16 a[182:183], v239 offset:4608
    v_mfma_f32_16x16x32_bf16 v[30:33], v[210:213], a[96:99], v[30:33]
    global_load_dwordx4 v[154:157], v3, s[66:67] offset:1024 sc1
    ds_read_b64_tr_b16 a[184:185], v240 offset:4096
    ds_read_b64_tr_b16 a[186:187], v240 offset:4608
    v_mfma_f32_16x16x32_bf16 v[34:37], v[210:213], a[100:103], v[34:37]
    ds_read_b64_tr_b16 a[188:189], v241 offset:4096
    v_mfma_f32_16x16x32_bf16 v[38:41], v[210:213], a[104:107], v[38:41]
    ds_read_b64_tr_b16 a[190:191], v241 offset:4608
    v_mfma_f32_16x16x32_bf16 v[42:45], v[210:213], a[108:111], v[42:45]
    s_waitcnt vmcnt(19)
    v_max3_u32 v7, v218, v219, v220
    global_load_dwordx4 v[158:161], v4, s[66:67] offset:1024 sc1
    v_mfma_f32_16x16x32_bf16 v[46:49], v[214:217], a[96:99], v[46:49]
    v_max3_u32 v8, v221, v222, v223
    v_mfma_f32_16x16x32_bf16 v[50:53], v[214:217], a[100:103], v[50:53]
    v_max3_u32 v7, v7, v224, v225
    v_max3_u32 v8, v8, v226, v227
    v_mfma_f32_16x16x32_bf16 v[54:57], v[214:217], a[104:107], v[54:57]
    v_max3_u32 v7, v7, v228, v229
    v_mfma_f32_16x16x32_bf16 v[58:61], v[214:217], a[108:111], v[58:61]
    v_max_u32 v7, v7, v8
    v_cmp_eq_u32 vcc, -1, v7
    global_load_dwordx4 v[162:165], v5, s[64:65] offset:-4096 sc1
    s_cbranch_vccnz L_gslow_106
L_gback_107:
    v_mfma_f32_16x16x32_bf16 v[14:17], v[218:221], a[112:115], v[14:17]
    s_waitcnt vmcnt(37)
    v_mfma_f32_16x16x32_bf16 v[18:21], v[218:221], a[116:119], v[18:21]
    ds_read_b64_tr_b16 a[192:193], v238 offset:8192
    v_mfma_f32_16x16x32_bf16 v[22:25], v[218:221], a[120:123], v[22:25]
    ds_read_b64_tr_b16 a[194:195], v238 offset:8704
    ds_read_b64_tr_b16 a[196:197], v239 offset:8192
    v_mfma_f32_16x16x32_bf16 v[26:29], v[218:221], a[124:127], v[26:29]
    global_load_dwordx4 v[166:169], v6, s[64:65] offset:-4096 sc1
    ds_read_b64_tr_b16 a[198:199], v239 offset:8704
    v_mfma_f32_16x16x32_bf16 v[30:33], v[222:225], a[112:115], v[30:33]
    ds_read_b64_tr_b16 a[200:201], v240 offset:8192
    ds_read_b64_tr_b16 a[202:203], v240 offset:8704
    v_mfma_f32_16x16x32_bf16 v[34:37], v[222:225], a[116:119], v[34:37]
    ds_read_b64_tr_b16 a[204:205], v241 offset:8192
    v_mfma_f32_16x16x32_bf16 v[38:41], v[222:225], a[120:123], v[38:41]
    ds_read_b64_tr_b16 a[206:207], v241 offset:8704
    global_load_dwordx4 v[170:173], v5, s[64:65] offset:-3072 sc1
    v_mfma_f32_16x16x32_bf16 v[42:45], v[222:225], a[124:127], v[42:45]
    s_waitcnt vmcnt(19)
    v_max3_u32 v7, v230, v231, v232
    v_mfma_f32_16x16x32_bf16 v[46:49], v[226:229], a[112:115], v[46:49]
    v_max3_u32 v8, v233, v94, v95
    v_mfma_f32_16x16x32_bf16 v[50:53], v[226:229], a[116:119], v[50:53]
    v_max3_u32 v7, v7, v96, v97
    v_max3_u32 v8, v8, v98, v99
    v_mfma_f32_16x16x32_bf16 v[54:57], v[226:229], a[120:123], v[54:57]
    v_max3_u32 v7, v7, v100, v101
    global_load_dwordx4 v[174:177], v6, s[64:65] offset:-3072 sc1
    v_mfma_f32_16x16x32_bf16 v[58:61], v[226:229], a[124:127], v[58:61]
    v_max_u32 v7, v7, v8
    v_cmp_eq_u32 vcc, -1, v7
    s_cbranch_vccnz L_gslow_108
L_gback_109:
    v_mfma_f32_16x16x32_bf16 v[14:17], v[230:233], a[128:131], v[14:17]
    s_waitcnt vmcnt(36)
    v_mfma_f32_16x16x32_bf16 v[18:21], v[230:233], a[132:135], v[18:21]
    ds_read_b64_tr_b16 a[208:209], v238 offset:12288
    v_mfma_f32_16x16x32_bf16 v[22:25], v[230:233], a[136:139], v[22:25]
    ds_read_b64_tr_b16 a[210:211], v238 offset:12800
    global_load_dwordx4 v[178:181], v5, s[64:65] offset:-2048 sc1
    ds_read_b64_tr_b16 a[212:213], v239 offset:12288
    v_mfma_f32_16x16x32_bf16 v[26:29], v[230:233], a[140:143], v[26:29]
    ds_read_b64_tr_b16 a[214:215], v239 offset:12800
    v_mfma_f32_16x16x32_bf16 v[30:33], v[94:97], a[128:131], v[30:33]
    ds_read_b64_tr_b16 a[216:217], v240 offset:12288
    ds_read_b64_tr_b16 a[218:219], v240 offset:12800
    v_mfma_f32_16x16x32_bf16 v[34:37], v[94:97], a[132:135], v[34:37]
    ds_read_b64_tr_b16 a[220:221], v241 offset:12288
    global_load_dwordx4 v[182:185], v6, s[64:65] offset:-2048 sc1
    v_mfma_f32_16x16x32_bf16 v[38:41], v[94:97], a[136:139], v[38:41]
    ds_read_b64_tr_b16 a[222:223], v241 offset:12800
    v_mfma_f32_16x16x32_bf16 v[42:45], v[94:97], a[140:143], v[42:45]
    s_waitcnt vmcnt(18)
    v_max3_u32 v7, v102, v103, v104
    v_mfma_f32_16x16x32_bf16 v[46:49], v[98:101], a[128:131], v[46:49]
    v_max3_u32 v8, v105, v106, v107
    v_mfma_f32_16x16x32_bf16 v[50:53], v[98:101], a[132:135], v[50:53]
    v_max3_u32 v7, v7, v108, v109
    v_max3_u32 v8, v8, v110, v111
    global_load_dwordx4 v[186:189], v5, s[64:65] offset:-1024 sc1
    v_mfma_f32_16x16x32_bf16 v[54:57], v[98:101], a[136:139], v[54:57]
    v_max3_u32 v7, v7, v112, v113
    v_mfma_f32_16x16x32_bf16 v[58:61], v[98:101], a[140:143], v[58:61]
    v_max_u32 v7, v7, v8
    v_cmp_eq_u32 vcc, -1, v7
    s_cbranch_vccnz L_gslow_110
L_gback_111:
    v_mfma_f32_16x16x32_bf16 v[14:17], v[102:105], a[144:147], v[14:17]
    s_waitcnt lgkmcnt(0)
    v_mfma_f32_16x16x32_bf16 v[18:21], v[102:105], a[148:151], v[18:21]
    global_load_dwordx4 v[190:193], v6, s[64:65] offset:-1024 sc1
    s_waitcnt vmcnt(27)
    v_mfma_f32_16x16x32_bf16 v[22:25], v[102:105], a[152:155], v[22:25]
    ds_write_b16 v251, a224 offset:0
    ds_write_b16_d16_hi v251, a224 offset:176
    v_mfma_f32_16x16x32_bf16 v[26:29], v[102:105], a[156:159], v[26:29]
    ds_write_b16 v251, a225 offset:352
    ds_write_b16_d16_hi v251, a225 offset:528
    v_mfma_f32_16x16x32_bf16 v[30:33], v[106:109], a[144:147], v[30:33]
    ds_write_b16 v251, a226 offset:704
    global_load_dwordx4 v[194:197], v5, s[64:65] offset:0 sc1
    ds_write_b16_d16_hi v251, a226 offset:880
    v_mfma_f32_16x16x32_bf16 v[34:37], v[106:109], a[148:151], v[34:37]
    ds_write_b16 v251, a227 offset:1056
    ds_write_b16_d16_hi v251, a227 offset:1232
    s_waitcnt vmcnt(18)
    v_mfma_f32_16x16x32_bf16 v[38:41], v[106:109], a[152:155], v[38:41]
    v_max3_u32 v7, v114, v115, v116
    v_mfma_f32_16x16x32_bf16 v[42:45], v[106:109], a[156:159], v[42:45]
    v_max3_u32 v8, v117, v118, v119
    global_load_dwordx4 v[198:201], v6, s[64:65] offset:0 sc1
    v_mfma_f32_16x16x32_bf16 v[46:49], v[110:113], a[144:147], v[46:49]
    v_max3_u32 v7, v7, v120, v121
    v_mfma_f32_16x16x32_bf16 v[50:53], v[110:113], a[148:151], v[50:53]
    v_max3_u32 v8, v8, v122, v123
    v_mfma_f32_16x16x32_bf16 v[54:57], v[110:113], a[152:155], v[54:57]
    v_max3_u32 v7, v7, v124, v125
    v_mfma_f32_16x16x32_bf16 v[58:61], v[110:113], a[156:159], v[58:61]
    v_max_u32 v7, v7, v8
    v_cmp_eq_u32 vcc, -1, v7
    global_load_dwordx4 v[202:205], v5, s[64:65] offset:1024 sc1
    s_cbranch_vccnz L_gslow_112
L_gback_113:
    v_mfma_f32_16x16x32_bf16 v[14:17], v[114:117], a[160:163], v[14:17]
    ds_write_b16 v252, a228 offset:0
    ds_write_b16_d16_hi v252, a228 offset:176
    v_mfma_f32_16x16x32_bf16 v[18:21], v[114:117], a[164:167], v[18:21]
    ds_write_b16 v252, a229 offset:352
    ds_write_b16_d16_hi v252, a229 offset:528
    v_mfma_f32_16x16x32_bf16 v[22:25], v[114:117], a[168:171], v[22:25]
    ds_write_b16 v252, a230 offset:704
    global_load_dwordx4 v[206:209], v6, s[64:65] offset:1024 sc1
    ds_write_b16_d16_hi v252, a230 offset:880
    v_mfma_f32_16x16x32_bf16 v[26:29], v[114:117], a[172:175], v[26:29]
    ds_write_b16 v252, a231 offset:1056
    ds_write_b16_d16_hi v252, a231 offset:1232
    v_mfma_f32_16x16x32_bf16 v[30:33], v[118:121], a[160:163], v[30:33]
    ds_write_b16 v253, a232 offset:0
    ds_write_b16_d16_hi v253, a232 offset:176
    v_mfma_f32_16x16x32_bf16 v[34:37], v[118:121], a[164:167], v[34:37]
    global_load_dwordx4 v[210:213], v5, s[64:65] offset:2048 sc1
    s_waitcnt vmcnt(19)
    v_mfma_f32_16x16x32_bf16 v[38:41], v[118:121], a[168:171], v[38:41]
    v_max3_u32 v7, v126, v127, v128
    v_mfma_f32_16x16x32_bf16 v[42:45], v[118:121], a[172:175], v[42:45]
    v_max3_u32 v8, v129, v130, v131
    v_mfma_f32_16x16x32_bf16 v[46:49], v[122:125], a[160:163], v[46:49]
    v_max3_u32 v7, v7, v132, v133
    v_mfma_f32_16x16x32_bf16 v[50:53], v[122:125], a[164:167], v[50:53]
    v_max3_u32 v8, v8, v134, v135
    global_load_dwordx4 v[214:217], v6, s[64:65] offset:2048 sc1
    v_mfma_f32_16x16x32_bf16 v[54:57], v[122:125], a[168:171], v[54:57]
    v_max3_u32 v7, v7, v136, v137
    v_mfma_f32_16x16x32_bf16 v[58:61], v[122:125], a[172:175], v[58:61]
    v_max_u32 v7, v7, v8
    v_cmp_eq_u32 vcc, -1, v7
    s_cbranch_vccnz L_gslow_114
L_gback_115:
    v_mfma_f32_16x16x32_bf16 v[14:17], v[126:129], a[176:179], v[14:17]
    ds_write_b16 v253, a233 offset:352
    ds_write_b16_d16_hi v253, a233 offset:528
    v_mfma_f32_16x16x32_bf16 v[18:21], v[126:129], a[180:183], v[18:21]
    global_load_dwordx4 v[218:221], v5, s[64:65] offset:3072 sc1
    ds_write_b16 v253, a234 offset:704
    ds_write_b16_d16_hi v253, a234 offset:880
    v_mfma_f32_16x16x32_bf16 v[22:25], v[126:129], a[184:187], v[22:25]
    ds_write_b16 v253, a235 offset:1056
    ds_write_b16_d16_hi v253, a235 offset:1232
    v_mfma_f32_16x16x32_bf16 v[26:29], v[126:129], a[188:191], v[26:29]
    s_waitcnt vmcnt(30)
    v_lshlrev_b32 v250, 16, v250
    v_mfma_f32_16x16x32_bf16 v[30:33], v[130:133], a[176:179], v[30:33]
    global_load_dwordx4 v[222:225], v6, s[64:65] offset:3072 sc1
    s_waitcnt vmcnt(19)
    v_mfma_f32_16x16x32_bf16 v[34:37], v[130:133], a[180:183], v[34:37]
    v_max3_u32 v7, v138, v139, v140
    v_mfma_f32_16x16x32_bf16 v[38:41], v[130:133], a[184:187], v[38:41]
    v_max3_u32 v8, v141, v142, v143
    v_mfma_f32_16x16x32_bf16 v[42:45], v[130:133], a[188:191], v[42:45]
    v_max3_u32 v7, v7, v144, v145
    v_mfma_f32_16x16x32_bf16 v[46:49], v[134:137], a[176:179], v[46:49]
    global_load_dwordx4 v[226:229], v5, s[66:67] offset:-4096 sc1
    v_max3_u32 v8, v8, v146, v147
    v_mfma_f32_16x16x32_bf16 v[50:53], v[134:137], a[180:183], v[50:53]
    v_max3_u32 v7, v7, v148, v149
    v_mfma_f32_16x16x32_bf16 v[54:57], v[134:137], a[184:187], v[54:57]
    v_max_u32 v7, v7, v8
    v_mfma_f32_16x16x32_bf16 v[58:61], v[134:137], a[188:191], v[58:61]
    v_cmp_eq_u32 vcc, -1, v7
    s_cbranch_vccnz L_gslow_116
L_gback_117:
    v_mfma_f32_16x16x32_bf16 v[14:17], v[138:141], a[192:195], v[14:17]
    v_mfma_f32_16x16x32_bf16 v[18:21], v[138:141], a[196:199], v[18:21]
    global_load_dwordx4 v[230:233], v6, s[66:67] offset:-4096 sc1
    s_waitcnt vmcnt(18)
    v_mfma_f32_16x16x32_bf16 v[22:25], v[138:141], a[200:203], v[22:25]
    v_max3_u32 v7, v150, v151, v152
    v_mfma_f32_16x16x32_bf16 v[26:29], v[138:141], a[204:207], v[26:29]
    v_mfma_f32_16x16x32_bf16 v[30:33], v[142:145], a[192:195], v[30:33]
    v_max3_u32 v8, v153, v154, v155
    v_mfma_f32_16x16x32_bf16 v[34:37], v[142:145], a[196:199], v[34:37]
    global_load_dwordx4 v[94:97], v5, s[66:67] offset:-3072 sc1
    v_max3_u32 v7, v7, v156, v157
    v_mfma_f32_16x16x32_bf16 v[38:41], v[142:145], a[200:203], v[38:41]
    v_mfma_f32_16x16x32_bf16 v[42:45], v[142:145], a[204:207], v[42:45]
    v_max3_u32 v8, v8, v158, v159
    v_mfma_f32_16x16x32_bf16 v[46:49], v[146:149], a[192:195], v[46:49]
    v_max3_u32 v7, v7, v160, v161
    v_mfma_f32_16x16x32_bf16 v[50:53], v[146:149], a[196:199], v[50:53]
    global_load_dwordx4 v[98:101], v6, s[66:67] offset:-3072 sc1
    v_mfma_f32_16x16x32_bf16 v[54:57], v[146:149], a[200:203], v[54:57]
    v_max_u32 v7, v7, v8
    v_mfma_f32_16x16x32_bf16 v[58:61], v[146:149], a[204:207], v[58:61]
    v_cmp_eq_u32 vcc, -1, v7
    s_cmp_eq_u32 s93, 1
    s_cbranch_scc1 L_gdone_91
    s_cbranch_vccnz L_gslow_118
L_gback_119:
    v_mfma_f32_16x16x32_bf16 v[14:17], v[150:153], a[208:211], v[14:17]
    v_mfma_f32_16x16x32_bf16 v[18:21], v[150:153], a[212:215], v[18:21]
    v_mfma_f32_16x16x32_bf16 v[22:25], v[150:153], a[216:219], v[22:25]
    v_mfma_f32_16x16x32_bf16 v[26:29], v[150:153], a[220:223], v[26:29]
    v_mfma_f32_16x16x32_bf16 v[30:33], v[154:157], a[208:211], v[30:33]
    v_mfma_f32_16x16x32_bf16 v[34:37], v[154:157], a[212:215], v[34:37]
    v_mfma_f32_16x16x32_bf16 v[38:41], v[154:157], a[216:219], v[38:41]
    v_mfma_f32_16x16x32_bf16 v[42:45], v[154:157], a[220:223], v[42:45]
    v_mfma_f32_16x16x32_bf16 v[46:49], v[158:161], a[208:211], v[46:49]
    v_mfma_f32_16x16x32_bf16 v[50:53], v[158:161], a[212:215], v[50:53]
    v_mfma_f32_16x16x32_bf16 v[54:57], v[158:161], a[216:219], v[54:57]
    v_mfma_f32_16x16x32_bf16 v[58:61], v[158:161], a[220:223], v[58:61]
L_gdone_91:
    global_load_dwordx4 v[102:105], v5, s[66:67] offset:-2048 sc1
    global_load_dwordx4 v[106:109], v6, s[66:67] offset:-2048 sc1
    global_load_dwordx4 v[110:113], v5, s[66:67] offset:-1024 sc1
    s_waitcnt vmcnt(21)
    v_max3_u32 v7, v162, v163, v164
    v_max3_u32 v8, v165, v166, v167
    v_max3_u32 v7, v7, v168, v169
    v_max_u32 v7, v7, v8
    v_cmp_eq_u32 vcc, -1, v7
    s_cbranch_vccnz L_gslow_121
L_gback_122:
    global_load_dwordx4 v[114:117], v6, s[66:67] offset:-1024 sc1
    v_mfma_f32_16x16x32_bf16 v[62:65], v[162:165], a[0:3], 0
    s_waitcnt lgkmcnt(0)
    s_barrier
    global_load_dwordx4 v[118:121], v5, s[66:67] offset:0 sc1
    v_mfma_f32_16x16x32_bf16 v[66:69], v[162:165], a[4:7], 0
    ds_write_b128 v242, v[18:21] offset:0
    ds_write_b128 v242, v[34:37] offset:1024
    global_load_dwordx4 v[122:125], v6, s[66:67] offset:0 sc1
    v_mfma_f32_16x16x32_bf16 v[70:73], v[162:165], a[8:11], 0
    ds_write_b128 v242, v[50:53] offset:2048
    ds_write_b128 v243, v[22:25] offset:0
    global_load_dwordx4 v[126:129], v5, s[66:67] offset:1024 sc1
    v_mfma_f32_16x16x32_bf16 v[74:77], v[162:165], a[12:15], 0
    ds_write_b128 v243, v[38:41] offset:1024
    ds_write_b128 v243, v[54:57] offset:2048
    global_load_dwordx4 v[130:133], v6, s[66:67] offset:1024 sc1
    v_mfma_f32_16x16x32_bf16 v[78:81], v[166:169], a[0:3], 0
    ds_write_b128 v244, v[26:29] offset:0
    ds_write_b128 v244, v[42:45] offset:1024
    v_mfma_f32_16x16x32_bf16 v[82:85], v[166:169], a[4:7], 0
    s_waitcnt vmcnt(24)
    v_max3_u32 v7, v170, v171, v172
    v_mfma_f32_16x16x32_bf16 v[86:89], v[166:169], a[8:11], 0
    v_max3_u32 v8, v173, v174, v175
    v_max3_u32 v7, v7, v176, v177
    v_mfma_f32_16x16x32_bf16 v[90:93], v[166:169], a[12:15], 0
    v_max_u32 v7, v7, v8
    v_cmp_eq_u32 vcc, -1, v7
    s_cbranch_vccnz L_gslow_123
L_gback_124:
    v_mfma_f32_16x16x32_bf16 v[62:65], v[170:173], a[16:19], v[62:65]
    ds_write_b128 v244, v[58:61] offset:2048
    s_waitcnt lgkmcnt(0)
    s_barrier
    v_mfma_f32_16x16x32_bf16 v[66:69], v[170:173], a[20:23], v[66:69]
    ds_read_b128 v[18:21], v245 offset:0
    ds_read_b128 v[22:25], v245 offset:3072
    v_mfma_f32_16x16x32_bf16 v[70:73], v[170:173], a[24:27], v[70:73]
    ds_read_b128 v[26:29], v245 offset:6144
    ds_read_b128 v[34:37], v245 offset:1024
    v_mfma_f32_16x16x32_bf16 v[74:77], v[170:173], a[28:31], v[74:77]
    ds_read_b128 v[38:41], v245 offset:4096
    ds_read_b128 v[42:45], v245 offset:7168
    v_mfma_f32_16x16x32_bf16 v[78:81], v[174:177], a[16:19], v[78:81]
    ds_read_b128 v[50:53], v245 offset:2048
    ds_read_b128 v[54:57], v245 offset:5120
    v_mfma_f32_16x16x32_bf16 v[82:85], v[174:177], a[20:23], v[82:85]
    s_waitcnt vmcnt(22)
    v_max3_u32 v7, v178, v179, v180
    v_mfma_f32_16x16x32_bf16 v[86:89], v[174:177], a[24:27], v[86:89]
    v_max3_u32 v8, v181, v182, v183
    v_max3_u32 v7, v7, v184, v185
    v_mfma_f32_16x16x32_bf16 v[90:93], v[174:177], a[28:31], v[90:93]
    v_max_u32 v7, v7, v8
    v_cmp_eq_u32 vcc, -1, v7
    s_cbranch_vccnz L_gslow_125
L_gback_126:
    v_mfma_f32_16x16x32_bf16 v[62:65], v[178:181], a[32:35], v[62:65]
    ds_read_b128 v[58:61], v245 offset:8192
    s_waitcnt lgkmcnt(6)
    v_mfma_f32_16x16x32_bf16 v[66:69], v[178:181], a[36:39], v[66:69]
    v_pk_add_f32 v[14:15], v[14:15], v[18:19]
    v_pk_add_f32 v[22:23], v[22:23], v[26:27]
    v_mfma_f32_16x16x32_bf16 v[70:73], v[178:181], a[40:43], v[70:73]
    v_pk_add_f32 v[16:17], v[16:17], v[20:21]
    v_pk_add_f32 v[24:25], v[24:25], v[28:29]
    v_mfma_f32_16x16x32_bf16 v[74:77], v[178:181], a[44:47], v[74:77]
    s_waitcnt lgkmcnt(3)
    v_pk_add_f32 v[30:31], v[30:31], v[34:35]
    v_mfma_f32_16x16x32_bf16 v[78:81], v[182:185], a[32:35], v[78:81]
    v_pk_add_f32 v[38:39], v[38:39], v[42:43]
    v_pk_add_f32 v[32:33], v[32:33], v[36:37]
    v_mfma_f32_16x16x32_bf16 v[82:85], v[182:185], a[36:39], v[82:85]
    s_waitcnt vmcnt(20)
    v_max3_u32 v7, v186, v187, v188
    v_mfma_f32_16x16x32_bf16 v[86:89], v[182:185], a[40:43], v[86:89]
    v_max3_u32 v8, v189, v190, v191
    v_max3_u32 v7, v7, v192, v193
    v_mfma_f32_16x16x32_bf16 v[90:93], v[182:185], a[44:47], v[90:93]
    v_max_u32 v7, v7, v8
    v_cmp_eq_u32 vcc, -1, v7
    s_cbranch_vccnz L_gslow_127
L_gback_128:
    v_mfma_f32_16x16x32_bf16 v[62:65], v[186:189], a[48:51], v[62:65]
    v_pk_add_f32 v[40:41], v[40:41], v[44:45]
    s_waitcnt lgkmcnt(0)
    v_mfma_f32_16x16x32_bf16 v[66:69], v[186:189], a[52:55], v[66:69]
    v_pk_add_f32 v[46:47], v[46:47], v[50:51]
    v_pk_add_f32 v[54:55], v[54:55], v[58:59]
    v_mfma_f32_16x16x32_bf16 v[70:73], v[186:189], a[56:59], v[70:73]
    v_pk_add_f32 v[48:49], v[48:49], v[52:53]
    v_pk_add_f32 v[56:57], v[56:57], v[60:61]
    v_mfma_f32_16x16x32_bf16 v[74:77], v[186:189], a[60:63], v[74:77]
    ds_read_b64 v[26:27], v249 offset:0
    ds_read_b64 v[42:43], v249 offset:32
    v_mfma_f32_16x16x32_bf16 v[78:81], v[190:193], a[48:51], v[78:81]
    ds_read_b64 v[58:59], v249 offset:64
    v_pk_add_f32 v[14:15], v[14:15], v[22:23]
    v_mfma_f32_16x16x32_bf16 v[82:85], v[190:193], a[52:55], v[82:85]
    s_waitcnt vmcnt(18)
    v_max3_u32 v7, v194, v195, v196
    v_mfma_f32_16x16x32_bf16 v[86:89], v[190:193], a[56:59], v[86:89]
    v_max3_u32 v8, v197, v198, v199
    v_max3_u32 v7, v7, v200, v201
    v_mfma_f32_16x16x32_bf16 v[90:93], v[190:193], a[60:63], v[90:93]
    v_max_u32 v7, v7, v8
    v_cmp_eq_u32 vcc, -1, v7
    s_cbranch_vccnz L_gslow_129
L_gback_130:
    v_mfma_f32_16x16x32_bf16 v[62:65], v[194:197], a[64:67], v[62:65]
    v_pk_add_f32 v[16:17], v[16:17], v[24:25]
    v_pk_add_f32 v[30:31], v[30:31], v[38:39]
    v_mfma_f32_16x16x32_bf16 v[66:69], v[194:197], a[68:71], v[66:69]
    v_pk_add_f32 v[32:33], v[32:33], v[40:41]
    v_pk_add_f32 v[46:47], v[46:47], v[54:55]
    v_mfma_f32_16x16x32_bf16 v[70:73], v[194:197], a[72:75], v[70:73]
    v_pk_add_f32 v[48:49], v[48:49], v[56:57]
    v_cvt_pk_bf16_f32 v15, v14, v15
    v_mfma_f32_16x16x32_bf16 v[74:77], v[194:197], a[76:79], v[74:77]
    v_cvt_pk_bf16_f32 v17, v16, v17
    v_cvt_pk_bf16_f32 v31, v30, v31
    v_mfma_f32_16x16x32_bf16 v[78:81], v[198:201], a[64:67], v[78:81]
    v_cvt_pk_bf16_f32 v33, v32, v33
    v_cvt_pk_bf16_f32 v47, v46, v47
    v_mfma_f32_16x16x32_bf16 v[82:85], v[198:201], a[68:71], v[82:85]
    s_waitcnt vmcnt(16)
    v_max3_u32 v7, v202, v203, v204
    v_mfma_f32_16x16x32_bf16 v[86:89], v[198:201], a[72:75], v[86:89]
    v_max3_u32 v8, v205, v206, v207
    v_max3_u32 v7, v7, v208, v209
    v_mfma_f32_16x16x32_bf16 v[90:93], v[198:201], a[76:79], v[90:93]
    v_max_u32 v7, v7, v8
    v_cmp_eq_u32 vcc, -1, v7
    s_cbranch_vccnz L_gslow_131
L_gback_132:
    v_mfma_f32_16x16x32_bf16 v[62:65], v[202:205], a[80:83], v[62:65]
    v_cvt_pk_bf16_f32 v49, v48, v49
    v_lshlrev_b32 v14, 16, v15
    v_mfma_f32_16x16x32_bf16 v[66:69], v[202:205], a[84:87], v[66:69]
    v_and_b32 v15, 0xffff0000, v15
    v_lshlrev_b32 v16, 16, v17
    v_mfma_f32_16x16x32_bf16 v[70:73], v[202:205], a[88:91], v[70:73]
    v_and_b32 v17, 0xffff0000, v17
    v_lshlrev_b32 v30, 16, v31
    v_mfma_f32_16x16x32_bf16 v[74:77], v[202:205], a[92:95], v[74:77]
    v_and_b32 v31, 0xffff0000, v31
    v_lshlrev_b32 v32, 16, v33
    v_mfma_f32_16x16x32_bf16 v[78:81], v[206:209], a[80:83], v[78:81]
    v_and_b32 v33, 0xffff0000, v33
    v_lshlrev_b32 v46, 16, v47
    v_mfma_f32_16x16x32_bf16 v[82:85], v[206:209], a[84:87], v[82:85]
    s_waitcnt vmcnt(14)
    v_max3_u32 v7, v210, v211, v212
    v_mfma_f32_16x16x32_bf16 v[86:89], v[206:209], a[88:91], v[86:89]
    v_max3_u32 v8, v213, v214, v215
    v_max3_u32 v7, v7, v216, v217
    v_mfma_f32_16x16x32_bf16 v[90:93], v[206:209], a[92:95], v[90:93]
    v_max_u32 v7, v7, v8
    v_cmp_eq_u32 vcc, -1, v7
    s_cbranch_vccnz L_gslow_133
L_gback_134:
    v_mfma_f32_16x16x32_bf16 v[62:65], v[210:213], a[96:99], v[62:65]
    v_and_b32 v47, 0xffff0000, v47
    v_lshlrev_b32 v48, 16, v49
    v_mfma_f32_16x16x32_bf16 v[66:69], v[210:213], a[100:103], v[66:69]
    v_and_b32 v49, 0xffff0000, v49
    v_pk_add_f32 v[14:15], v[14:15], v[250:251] op_sel_hi:[1,0]
    v_mfma_f32_16x16x32_bf16 v[70:73], v[210:213], a[104:107], v[70:73]
    v_pk_add_f32 v[16:17], v[16:17], v[250:251] op_sel_hi:[1,0]
    v_pk_add_f32 v[30:31], v[30:31], v[250:251] op_sel_hi:[1,0]
    v_mfma_f32_16x16x32_bf16 v[74:77], v[210:213], a[108:111], v[74:77]
    v_pk_add_f32 v[32:33], v[32:33], v[250:251] op_sel_hi:[1,0]
    v_pk_add_f32 v[46:47], v[46:47], v[250:251] op_sel_hi:[1,0]
    v_mfma_f32_16x16x32_bf16 v[78:81], v[214:217], a[96:99], v[78:81]
    v_pk_add_f32 v[48:49], v[48:49], v[250:251] op_sel_hi:[1,0]
    v_cvt_pk_bf16_f32 v15, v14, v15
    v_mfma_f32_16x16x32_bf16 v[82:85], v[214:217], a[100:103], v[82:85]
    s_waitcnt vmcnt(12)
    v_max3_u32 v7, v218, v219, v220
    v_mfma_f32_16x16x32_bf16 v[86:89], v[214:217], a[104:107], v[86:89]
    v_max3_u32 v8, v221, v222, v223
    v_max3_u32 v7, v7, v224, v225
    v_mfma_f32_16x16x32_bf16 v[90:93], v[214:217], a[108:111], v[90:93]
    v_max_u32 v7, v7, v8
    v_cmp_eq_u32 vcc, -1, v7
    s_cbranch_vccnz L_gslow_135
L_gback_136:
    v_mfma_f32_16x16x32_bf16 v[62:65], v[218:221], a[112:115], v[62:65]
    v_cvt_pk_bf16_f32 v17, v16, v17
    v_cvt_pk_bf16_f32 v31, v30, v31
    v_mfma_f32_16x16x32_bf16 v[66:69], v[218:221], a[116:119], v[66:69]
    v_cvt_pk_bf16_f32 v33, v32, v33
    v_cvt_pk_bf16_f32 v47, v46, v47
    v_mfma_f32_16x16x32_bf16 v[70:73], v[218:221], a[120:123], v[70:73]
    v_cvt_pk_bf16_f32 v49, v48, v49
    v_lshlrev_b32 v14, 16, v15
    v_mfma_f32_16x16x32_bf16 v[74:77], v[218:221], a[124:127], v[74:77]
    v_and_b32 v15, 0xffff0000, v15
    v_lshlrev_b32 v16, 16, v17
    v_mfma_f32_16x16x32_bf16 v[78:81], v[222:225], a[112:115], v[78:81]
    v_and_b32 v17, 0xffff0000, v17
    v_lshlrev_b32 v30, 16, v31
    v_mfma_f32_16x16x32_bf16 v[82:85], v[222:225], a[116:119], v[82:85]
    s_waitcnt vmcnt(10)
    v_max3_u32 v7, v226, v227, v228
    v_mfma_f32_16x16x32_bf16 v[86:89], v[222:225], a[120:123], v[86:89]
    v_max3_u32 v8, v229, v230, v231
    v_max3_u32 v7, v7, v232, v233
    v_mfma_f32_16x16x32_bf16 v[90:93], v[222:225], a[124:127], v[90:93]
    v_max_u32 v7, v7, v8
    v_cmp_eq_u32 vcc, -1, v7
    s_cbranch_vccnz L_gslow_137
L_gback_138:
    v_mfma_f32_16x16x32_bf16 v[62:65], v[226:229], a[128:131], v[62:65]
    v_and_b32 v31, 0xffff0000, v31
    v_lshlrev_b32 v32, 16, v33
    v_mfma_f32_16x16x32_bf16 v[66:69], v[226:229], a[132:135], v[66:69]
    v_and_b32 v33, 0xffff0000, v33
    v_lshlrev_b32 v46, 16, v47
    v_mfma_f32_16x16x32_bf16 v[70:73], v[226:229], a[136:139], v[70:73]
    v_and_b32 v47, 0xffff0000, v47
    v_lshlrev_b32 v48, 16, v49
    v_mfma_f32_16x16x32_bf16 v[74:77], v[226:229], a[140:143], v[74:77]
    v_and_b32 v49, 0xffff0000, v49
    s_waitcnt lgkmcnt(0)
    v_mfma_f32_16x16x32_bf16 v[78:81], v[230:233], a[128:131], v[78:81]
    v_lshlrev_b32 v18, 16, v26
    v_and_b32 v19, 0xffff0000, v26
    v_mfma_f32_16x16x32_bf16 v[82:85], v[230:233], a[132:135], v[82:85]
    s_waitcnt vmcnt(8)
    v_max3_u32 v7, v94, v95, v96
    v_mfma_f32_16x16x32_bf16 v[86:89], v[230:233], a[136:139], v[86:89]
    v_max3_u32 v8, v97, v98, v99
    v_max3_u32 v7, v7, v100, v101
    v_mfma_f32_16x16x32_bf16 v[90:93], v[230:233], a[140:143], v[90:93]
    v_max_u32 v7, v7, v8
    v_cmp_eq_u32 vcc, -1, v7
    s_cbranch_vccnz L_gslow_139
L_gback_140:
    v_mfma_f32_16x16x32_bf16 v[62:65], v[94:97], a[144:147], v[62:65]
    v_lshlrev_b32 v20, 16, v27
    v_and_b32 v21, 0xffff0000, v27
    v_mfma_f32_16x16x32_bf16 v[66:69], v[94:97], a[148:151], v[66:69]
    v_lshlrev_b32 v34, 16, v42
    v_and_b32 v35, 0xffff0000, v42
    v_mfma_f32_16x16x32_bf16 v[70:73], v[94:97], a[152:155], v[70:73]
    v_lshlrev_b32 v36, 16, v43
    v_and_b32 v37, 0xffff0000, v43
    v_mfma_f32_16x16x32_bf16 v[74:77], v[94:97], a[156:159], v[74:77]
    v_lshlrev_b32 v50, 16, v58
    v_and_b32 v51, 0xffff0000, v58
    v_mfma_f32_16x16x32_bf16 v[78:81], v[98:101], a[144:147], v[78:81]
    v_lshlrev_b32 v52, 16, v59
    v_and_b32 v53, 0xffff0000, v59
    v_mfma_f32_16x16x32_bf16 v[82:85], v[98:101], a[148:151], v[82:85]
    s_waitcnt vmcnt(6)
    v_max3_u32 v7, v102, v103, v104
    v_mfma_f32_16x16x32_bf16 v[86:89], v[98:101], a[152:155], v[86:89]
    v_max3_u32 v8, v105, v106, v107
    v_max3_u32 v7, v7, v108, v109
    v_mfma_f32_16x16x32_bf16 v[90:93], v[98:101], a[156:159], v[90:93]
    v_max_u32 v7, v7, v8
    v_cmp_eq_u32 vcc, -1, v7
    s_cbranch_vccnz L_gslow_141
L_gback_142:
    v_mfma_f32_16x16x32_bf16 v[62:65], v[102:105], a[160:163], v[62:65]
    v_pk_add_f32 v[14:15], v[14:15], v[18:19]
    v_pk_add_f32 v[16:17], v[16:17], v[20:21]
    v_mfma_f32_16x16x32_bf16 v[66:69], v[102:105], a[164:167], v[66:69]
    v_pk_add_f32 v[30:31], v[30:31], v[34:35]
    v_pk_add_f32 v[32:33], v[32:33], v[36:37]
    v_mfma_f32_16x16x32_bf16 v[70:73], v[102:105], a[168:171], v[70:73]
    v_pk_add_f32 v[46:47], v[46:47], v[50:51]
    v_pk_add_f32 v[48:49], v[48:49], v[52:53]
    v_mfma_f32_16x16x32_bf16 v[74:77], v[102:105], a[172:175], v[74:77]
    v_cvt_pk_bf16_f32 v22, v14, v15
    v_cvt_pk_bf16_f32 v24, v30, v31
    v_mfma_f32_16x16x32_bf16 v[78:81], v[106:109], a[160:163], v[78:81]
    v_cvt_pk_bf16_f32 v23, v16, v17
    v_cvt_pk_bf16_f32 v25, v32, v33
    v_mfma_f32_16x16x32_bf16 v[82:85], v[106:109], a[164:167], v[82:85]
    s_waitcnt vmcnt(4)
    v_max3_u32 v7, v110, v111, v112
    v_mfma_f32_16x16x32_bf16 v[86:89], v[106:109], a[168:171], v[86:89]
    v_max3_u32 v8, v113, v114, v115
    v_max3_u32 v7, v7, v116, v117
    v_mfma_f32_16x16x32_bf16 v[90:93], v[106:109], a[172:175], v[90:93]
    v_max_u32 v7, v7, v8
    v_cmp_eq_u32 vcc, -1, v7
    s_cbranch_vccnz L_gslow_143
L_gback_144:
    v_mfma_f32_16x16x32_bf16 v[62:65], v[110:113], a[176:179], v[62:65]
    v_cvt_pk_bf16_f32 v54, v46, v47
    v_cvt_pk_bf16_f32 v56, v46, v47
    v_mfma_f32_16x16x32_bf16 v[66:69], v[110:113], a[180:183], v[66:69]
    v_cvt_pk_bf16_f32 v55, v48, v49
    v_cvt_pk_bf16_f32 v57, v48, v49
    v_mfma_f32_16x16x32_bf16 v[70:73], v[110:113], a[184:187], v[70:73]
    v_permlane16_swap_b32 v22, v24
    v_permlane16_swap_b32 v23, v25
    v_mfma_f32_16x16x32_bf16 v[74:77], v[110:113], a[188:191], v[74:77]
    v_permlane16_swap_b32 v54, v56
    v_permlane16_swap_b32 v55, v57
    v_mfma_f32_16x16x32_bf16 v[78:81], v[114:117], a[176:179], v[78:81]
    global_store_dwordx4 v246, v[22:25], s[40:41] sc1
    global_store_dwordx4 v247, v[54:57], s[40:41] sc1
    v_mfma_f32_16x16x32_bf16 v[82:85], v[114:117], a[180:183], v[82:85]
    s_waitcnt vmcnt(4)
    v_max3_u32 v7, v118, v119, v120
    v_mfma_f32_16x16x32_bf16 v[86:89], v[114:117], a[184:187], v[86:89]
    v_max3_u32 v8, v121, v122, v123
    v_max3_u32 v7, v7, v124, v125
    v_mfma_f32_16x16x32_bf16 v[90:93], v[114:117], a[188:191], v[90:93]
    v_max_u32 v7, v7, v8
    v_cmp_eq_u32 vcc, -1, v7
    s_cbranch_vccnz L_gslow_145
L_gback_146:
    v_mfma_f32_16x16x32_bf16 v[62:65], v[118:121], a[192:195], v[62:65]
    v_mfma_f32_16x16x32_bf16 v[66:69], v[118:121], a[196:199], v[66:69]
    s_waitcnt vmcnt(2)
    v_mfma_f32_16x16x32_bf16 v[70:73], v[118:121], a[200:203], v[70:73]
    v_max3_u32 v7, v126, v127, v128
    v_mfma_f32_16x16x32_bf16 v[74:77], v[118:121], a[204:207], v[74:77]
    v_max3_u32 v8, v129, v130, v131
    v_mfma_f32_16x16x32_bf16 v[78:81], v[122:125], a[192:195], v[78:81]
    v_mfma_f32_16x16x32_bf16 v[82:85], v[122:125], a[196:199], v[82:85]
    v_max3_u32 v7, v7, v132, v133
    v_mfma_f32_16x16x32_bf16 v[86:89], v[122:125], a[200:203], v[86:89]
    v_max_u32 v7, v7, v8
    v_mfma_f32_16x16x32_bf16 v[90:93], v[122:125], a[204:207], v[90:93]
    v_cmp_eq_u32 vcc, -1, v7
    s_cmp_eq_u32 s93, 1
    s_cbranch_scc1 L_gdone_120
    s_cbranch_vccnz L_gslow_147
L_gback_148:
    v_mfma_f32_16x16x32_bf16 v[62:65], v[126:129], a[208:211], v[62:65]
    v_mfma_f32_16x16x32_bf16 v[66:69], v[126:129], a[212:215], v[66:69]
    v_mfma_f32_16x16x32_bf16 v[70:73], v[126:129], a[216:219], v[70:73]
    v_mfma_f32_16x16x32_bf16 v[74:77], v[126:129], a[220:223], v[74:77]
    v_mfma_f32_16x16x32_bf16 v[78:81], v[130:133], a[208:211], v[78:81]
    v_mfma_f32_16x16x32_bf16 v[82:85], v[130:133], a[212:215], v[82:85]
    v_mfma_f32_16x16x32_bf16 v[86:89], v[130:133], a[216:219], v[86:89]
    v_mfma_f32_16x16x32_bf16 v[90:93], v[130:133], a[220:223], v[90:93]
L_gdone_120:
    s_waitcnt lgkmcnt(0)
    s_barrier
    ds_write_b128 v242, v[66:69] offset:0
    s_nop 2
    ds_write_b128 v242, v[82:85] offset:1024
    ds_write_b128 v243, v[70:73] offset:0
    ds_write_b128 v243, v[86:89] offset:1024
    ds_write_b128 v244, v[74:77] offset:0
    ds_write_b128 v244, v[90:93] offset:1024
    s_waitcnt lgkmcnt(0)
    s_barrier
    ds_read_b128 v[66:69], v245 offset:0
    ds_read_b128 v[70:73], v245 offset:3072
    ds_read_b128 v[74:77], v245 offset:6144
    ds_read_b128 v[82:85], v245 offset:1024
    ds_read_b128 v[86:89], v245 offset:4096
    ds_read_b128 v[90:93], v245 offset:7168
    s_waitcnt lgkmcnt(3)
    v_pk_add_f32 v[62:63], v[62:63], v[66:67]
    v_pk_add_f32 v[70:71], v[70:71], v[74:75]
    v_pk_add_f32 v[64:65], v[64:65], v[68:69]
    v_pk_add_f32 v[72:73], v[72:73], v[76:77]
    s_waitcnt lgkmcnt(0)
    v_pk_add_f32 v[78:79], v[78:79], v[82:83]
    v_pk_add_f32 v[86:87], v[86:87], v[90:91]
    v_pk_add_f32 v[80:81], v[80:81], v[84:85]
    v_pk_add_f32 v[88:89], v[88:89], v[92:93]
    ds_read_b64 v[74:75], v249 offset:96
    ds_read_b64 v[90:91], v249 offset:128
    v_pk_add_f32 v[62:63], v[62:63], v[70:71]
    v_pk_add_f32 v[64:65], v[64:65], v[72:73]
    v_pk_add_f32 v[78:79], v[78:79], v[86:87]
    v_pk_add_f32 v[80:81], v[80:81], v[88:89]
    v_cvt_pk_bf16_f32 v63, v62, v63
    v_cvt_pk_bf16_f32 v65, v64, v65
    v_cvt_pk_bf16_f32 v79, v78, v79
    v_cvt_pk_bf16_f32 v81, v80, v81
    v_lshlrev_b32 v62, 16, v63
    v_and_b32 v63, 0xffff0000, v63
    v_lshlrev_b32 v64, 16, v65
    v_and_b32 v65, 0xffff0000, v65
    v_lshlrev_b32 v78, 16, v79
    v_and_b32 v79, 0xffff0000, v79
    v_lshlrev_b32 v80, 16, v81
    v_and_b32 v81, 0xffff0000, v81
    v_pk_add_f32 v[62:63], v[62:63], v[250:251] op_sel_hi:[1,0]
    v_pk_add_f32 v[64:65], v[64:65], v[250:251] op_sel_hi:[1,0]
    v_pk_add_f32 v[78:79], v[78:79], v[250:251] op_sel_hi:[1,0]
    v_pk_add_f32 v[80:81], v[80:81], v[250:251] op_sel_hi:[1,0]
    v_cvt_pk_bf16_f32 v63, v62, v63
    v_cvt_pk_bf16_f32 v65, v64, v65
    v_cvt_pk_bf16_f32 v79, v78, v79
    v_cvt_pk_bf16_f32 v81, v80, v81
    v_lshlrev_b32 v62, 16, v63
    v_and_b32 v63, 0xffff0000, v63
    v_lshlrev_b32 v64, 16, v65
    v_and_b32 v65, 0xffff0000, v65
    v_lshlrev_b32 v78, 16, v79
    v_and_b32 v79, 0xffff0000, v79
    v_lshlrev_b32 v80, 16, v81
    v_and_b32 v81, 0xffff0000, v81
    s_waitcnt lgkmcnt(0)
    v_lshlrev_b32 v66, 16, v74
    v_and_b32 v67, 0xffff0000, v74
    v_lshlrev_b32 v68, 16, v75
    v_and_b32 v69, 0xffff0000, v75
    v_lshlrev_b32 v82, 16, v90
    v_and_b32 v83, 0xffff0000, v90
    v_lshlrev_b32 v84, 16, v91
    v_and_b32 v85, 0xffff0000, v91
    v_pk_add_f32 v[62:63], v[62:63], v[66:67]
    v_pk_add_f32 v[64:65], v[64:65], v[68:69]
    v_pk_add_f32 v[78:79], v[78:79], v[82:83]
    v_pk_add_f32 v[80:81], v[80:81], v[84:85]
    v_cvt_pk_bf16_f32 v70, v62, v63
    v_cvt_pk_bf16_f32 v72, v78, v79
    v_cvt_pk_bf16_f32 v71, v64, v65
    v_cvt_pk_bf16_f32 v73, v80, v81
    v_permlane16_swap_b32 v70, v72
    s_nop 0
    v_permlane16_swap_b32 v71, v73
    global_store_dwordx4 v248, v[70:73], s[40:41] sc1
    s_or_b32 s54, s2, s3
    s_cmp_lg_u32 s54, 0
    s_cbranch_scc1 L_nn_149
    v_mov_b32 v2, 0
    v_mov_b32 v3, s10
    s_mov_b64 exec, 1
    global_store_dword v2, v3, s[44:45]
L_nn_149:
L_end:
    s_endpgm
L_helper:
    s_lshl_b32 s54, s6, 7
    s_lshl_b32 s55, s3, 2
    s_add_u32 s54, s54, s55
    v_mov_b32 v2, s54
    v_mov_b32 v3, s10
    s_waitcnt vmcnt(0)
    s_mov_b64 exec, 1
    global_store_dword v2, v3, s[52:53] sc1
    s_mov_b64 exec, -1
    global_load_dword v254, v231, s[32:33]
    v_add_u32 v231, 884736, v231
    s_sub_u32 s60, s5, 27
    s_lshl_b32 s60, s60, 2
    s_add_u32 s60, s60, s3
    v_mov_b32 v20, -1
    v_mov_b32 v21, -1
    v_mov_b32 v22, -1
    v_mov_b32 v23, -1
    v_lshrrev_b32 v5, 3, v1
    v_and_b32 v6, 7, v1
    s_lshr_b32 s62, s4, 1
    s_mul_i32 s61, s4, 393216
    s_lshl_b32 s63, s60, 10
    s_add_u32 s61, s61, s63
    v_lshl_add_u32 v7, v1, 4, s61
    s_mov_b32 s63, s60
L_poi_150:
    global_store_dwordx4 v7, v[20:23], s[46:47] sc1
    v_add_u32 v7, 20480, v7
    s_add_u32 s63, s63, 20
    s_cmp_lt_u32 s63, 324
    s_cbranch_scc1 L_poi_150
    s_lshl_b32 s54, s6, 7
    s_add_u32 s54, s54, 32768
    s_lshl_b32 s55, s3, 2
    s_add_u32 s54, s54, s55
    v_mov_b32 v2, s54
    v_mov_b32 v3, s10
    s_waitcnt vmcnt(0)
    s_mov_b64 exec, 1
    global_store_dword v2, v3, s[52:53] sc1
    s_mov_b64 exec, -1
    s_sub_u32 s66, s5, 27
    s_add_u32 s66, s66, s92
    s_lshl_b32 s66, s66, 5
    v_lshrrev_b32 v10, 2, v1
    v_add_u32 v10, s66, v10
    v_and_b32 v12, 3, v1
    s_lshl_b32 s67, s4, 9
    v_lshl_add_u32 v12, v12, 7, s67
    v_add_u32 v11, 160, v10
    v_min_u32 v11, 1727, v11
    v_lshl_add_u32 v11, v11, 12, v12
    global_load_dword v254, v11, s[36:37]
    v_add_u32 v11, 176, v10
    v_min_u32 v11, 1727, v11
    v_lshl_add_u32 v11, v11, 12, v12
    global_load_dword v254, v11, s[36:37]
    v_add_u32 v11, 320, v10
    v_min_u32 v11, 1727, v11
    v_lshl_add_u32 v11, v11, 12, v12
    global_load_dword v254, v11, s[36:37]
    v_add_u32 v11, 336, v10
    v_min_u32 v11, 1727, v11
    v_lshl_add_u32 v11, v11, 12, v12
    global_load_dword v254, v11, s[36:37]
    s_mul_i32 s61, s4, 327680
    s_lshl_b32 s63, s60, 10
    s_add_u32 s61, s61, s63
    v_lshl_add_u32 v7, v1, 4, s61
    s_mov_b32 s63, s60
L_poi_151:
    global_store_dwordx4 v7, v[20:23], s[48:49] sc1
    v_add_u32 v7, 20480, v7
    s_add_u32 s63, s63, 20
    s_cmp_lt_u32 s63, 320
    s_cbranch_scc1 L_poi_151
    s_lshl_b32 s54, s6, 7
    s_add_u32 s54, s54, 131072
    s_lshl_b32 s55, s3, 2
    s_add_u32 s54, s54, s55
    v_mov_b32 v2, s54
    v_mov_b32 v3, s10
    s_waitcnt vmcnt(0)
    s_mov_b64 exec, 1
    global_store_dword v2, v3, s[52:53] sc1
    s_mov_b64 exec, -1
    global_load_dword v254, v231, s[32:33]
    global_load_dword v254, v232, s[36:37]
    global_load_dword v193, v233, s[52:53] sc1
    s_mov_b32 s69, 0
    s_waitcnt vmcnt(0)
L_pdpoll_152:
    v_cmp_ne_u32 vcc, s10, v193
    s_cbranch_vccz L_pdok_153
    s_add_u32 s69, s69, 1
    s_cmp_gt_u32 s69, 200000
    s_cbranch_scc1 L_pdok_153
    s_sleep 4
    global_load_dword v193, v233, s[52:53] sc1
    s_waitcnt vmcnt(0)
    s_branch L_pdpoll_152
L_pdok_153:
    s_branch L_win2
L_nog1_21:
    s_mul_i32 s82, s3, 32768
    s_mov_b32 s83, 5
L_dma_154:
    s_mov_b32 m0, s82
    s_add_u32 s82, s82, 4096
    global_load_lds_dwordx4 v234, s[80:81] offset:0
    global_load_lds_dwordx4 v235, s[80:81] offset:1024
    global_load_lds_dwordx4 v236, s[80:81] offset:2048
    global_load_lds_dwordx4 v237, s[80:81] offset:3072
    s_add_u32 s80, s80, 131072
    s_addc_u32 s81, s81, 0
    s_sub_u32 s83, s83, 1
    s_cmp_gt_i32 s83, 0
    s_cbranch_scc1 L_dma_154
    s_lshl_b32 s54, s6, 7
    s_add_u32 s54, s54, 65536
    s_lshl_b32 s55, s3, 2
    s_add_u32 s54, s54, s55
    v_mov_b32 v2, s54
    v_mov_b32 v3, s10
    s_waitcnt vmcnt(20)
    s_mov_b64 exec, 1
    global_store_dword v2, v3, s[52:53] sc1
    s_mov_b64 exec, -1
    s_waitcnt vmcnt(0)
    ds_read_b64_tr_b16 a[0:1], v238 offset:0
    ds_read_b64_tr_b16 a[2:3], v238 offset:512
    ds_read_b64_tr_b16 a[4:5], v239 offset:0
    ds_read_b64_tr_b16 a[6:7], v239 offset:512
    ds_read_b64_tr_b16 a[8:9], v240 offset:0
    ds_read_b64_tr_b16 a[10:11], v240 offset:512
    ds_read_b64_tr_b16 a[12:13], v241 offset:0
    ds_read_b64_tr_b16 a[14:15], v241 offset:512
    ds_read_b64_tr_b16 a[16:17], v238 offset:4096
    ds_read_b64_tr_b16 a[18:19], v238 offset:4608
    ds_read_b64_tr_b16 a[20:21], v239 offset:4096
    ds_read_b64_tr_b16 a[22:23], v239 offset:4608
    ds_read_b64_tr_b16 a[24:25], v240 offset:4096
    ds_read_b64_tr_b16 a[26:27], v240 offset:4608
    ds_read_b64_tr_b16 a[28:29], v241 offset:4096
    ds_read_b64_tr_b16 a[30:31], v241 offset:4608
    ds_read_b64_tr_b16 a[32:33], v238 offset:8192
    ds_read_b64_tr_b16 a[34:35], v238 offset:8704
    ds_read_b64_tr_b16 a[36:37], v239 offset:8192
    ds_read_b64_tr_b16 a[38:39], v239 offset:8704
    ds_read_b64_tr_b16 a[40:41], v240 offset:8192
    ds_read_b64_tr_b16 a[42:43], v240 offset:8704
    ds_read_b64_tr_b16 a[44:45], v241 offset:8192
    ds_read_b64_tr_b16 a[46:47], v241 offset:8704
    ds_read_b64_tr_b16 a[48:49], v238 offset:12288
    ds_read_b64_tr_b16 a[50:51], v238 offset:12800
    ds_read_b64_tr_b16 a[52:53], v239 offset:12288
    ds_read_b64_tr_b16 a[54:55], v239 offset:12800
    ds_read_b64_tr_b16 a[56:57], v240 offset:12288
    ds_read_b64_tr_b16 a[58:59], v240 offset:12800
    ds_read_b64_tr_b16 a[60:61], v241 offset:12288
    ds_read_b64_tr_b16 a[62:63], v241 offset:12800
    ds_read_b64_tr_b16 a[64:65], v238 offset:16384
    ds_read_b64_tr_b16 a[66:67], v238 offset:16896
    ds_read_b64_tr_b16 a[68:69], v239 offset:16384
    ds_read_b64_tr_b16 a[70:71], v239 offset:16896
    ds_read_b64_tr_b16 a[72:73], v240 offset:16384
    ds_read_b64_tr_b16 a[74:75], v240 offset:16896
    ds_read_b64_tr_b16 a[76:77], v241 offset:16384
    ds_read_b64_tr_b16 a[78:79], v241 offset:16896
    s_waitcnt lgkmcnt(0)
    s_mul_i32 s82, s3, 32768
    s_mov_b32 s83, 5
L_dma_155:
    s_mov_b32 m0, s82
    s_add_u32 s82, s82, 4096
    global_load_lds_dwordx4 v234, s[80:81] offset:0
    global_load_lds_dwordx4 v235, s[80:81] offset:1024
    global_load_lds_dwordx4 v236, s[80:81] offset:2048
    global_load_lds_dwordx4 v237, s[80:81] offset:3072
    s_add_u32 s80, s80, 131072
    s_addc_u32 s81, s81, 0
    s_sub_u32 s83, s83, 1
    s_cmp_gt_i32 s83, 0
    s_cbranch_scc1 L_dma_155
    v_bfe_u32 v9, v1, 2, 3
    s_lshl_b32 s54, s78, 3
    v_add_u32 v9, s54, v9
    v_lshlrev_b32 v9, 7, v9
    v_and_b32 v13, 3, v1
    v_lshl_add_u32 v9, v13, 2, v9
    v_add_u32 v9, 0x10000, v9
    s_mul_i32 s54, s75, 3456
    s_add_u32 s54, s54, 0x18000
    v_and_b32 v11, 31, v1
    v_min_u32 v11, 26, v11
    v_lshl_add_u32 v11, v11, 7, s54
    v_cmp_lt_u32 s[62:63], 31, v1
    s_nop 1
    v_cndmask_b32 v9, v9, v11, s[62:63]
    s_waitcnt vmcnt(0)
    ds_read_b64_tr_b16 a[80:81], v238 offset:0
    ds_read_b64_tr_b16 a[82:83], v238 offset:512
    ds_read_b64_tr_b16 a[84:85], v239 offset:0
    ds_read_b64_tr_b16 a[86:87], v239 offset:512
    ds_read_b64_tr_b16 a[88:89], v240 offset:0
    ds_read_b64_tr_b16 a[90:91], v240 offset:512
    ds_read_b64_tr_b16 a[92:93], v241 offset:0
    ds_read_b64_tr_b16 a[94:95], v241 offset:512
    ds_read_b64_tr_b16 a[96:97], v238 offset:4096
    ds_read_b64_tr_b16 a[98:99], v238 offset:4608
    ds_read_b64_tr_b16 a[100:101], v239 offset:4096
    ds_read_b64_tr_b16 a[102:103], v239 offset:4608
    ds_read_b64_tr_b16 a[104:105], v240 offset:4096
    ds_read_b64_tr_b16 a[106:107], v240 offset:4608
    ds_read_b64_tr_b16 a[108:109], v241 offset:4096
    ds_read_b64_tr_b16 a[110:111], v241 offset:4608
    ds_read_b64_tr_b16 a[112:113], v238 offset:8192
    ds_read_b64_tr_b16 a[114:115], v238 offset:8704
    ds_read_b64_tr_b16 a[116:117], v239 offset:8192
    ds_read_b64_tr_b16 a[118:119], v239 offset:8704
    ds_read_b64_tr_b16 a[120:121], v240 offset:8192
    ds_read_b64_tr_b16 a[122:123], v240 offset:8704
    ds_read_b64_tr_b16 a[124:125], v241 offset:8192
    ds_read_b64_tr_b16 a[126:127], v241 offset:8704
    ds_read_b64_tr_b16 a[128:129], v238 offset:12288
    ds_read_b64_tr_b16 a[130:131], v238 offset:12800
    ds_read_b64_tr_b16 a[132:133], v239 offset:12288
    ds_read_b64_tr_b16 a[134:135], v239 offset:12800
    ds_read_b64_tr_b16 a[136:137], v240 offset:12288
    ds_read_b64_tr_b16 a[138:139], v240 offset:12800
    ds_read_b64_tr_b16 a[140:141], v241 offset:12288
    ds_read_b64_tr_b16 a[142:143], v241 offset:12800
    ds_read_b64_tr_b16 a[144:145], v238 offset:16384
    ds_read_b64_tr_b16 a[146:147], v238 offset:16896
    ds_read_b64_tr_b16 a[148:149], v239 offset:16384
    ds_read_b64_tr_b16 a[150:151], v239 offset:16896
    ds_read_b64_tr_b16 a[152:153], v240 offset:16384
    ds_read_b64_tr_b16 a[154:155], v240 offset:16896
    ds_read_b64_tr_b16 a[156:157], v241 offset:16384
    ds_read_b64_tr_b16 a[158:159], v241 offset:16896
    s_sleep 110
    global_load_dword v249, v9, s[52:53] sc1
    s_mov_b32 s69, 0
    s_waitcnt vmcnt(0) lgkmcnt(0)
L_h2poll_156:
    v_cmp_ne_u32 vcc, s10, v249
    s_cbranch_vccz L_h2ok_157
    s_add_u32 s69, s69, 1
    s_cmp_gt_u32 s69, 200000
    s_cbranch_scc1 L_h2ok_157
    s_sleep 8
    global_load_dword v249, v9, s[52:53] sc1
    s_waitcnt vmcnt(0)
    s_branch L_h2poll_156
L_h2ok_157:
    s_mul_i32 s54, s75, 276480
    v_lshl_add_u32 v11, v1, 4, s54
    v_add_u32 v2, 0, v11
    v_add_u32 v3, 55296, v11
    v_add_u32 v4, 110592, v11
    v_add_u32 v5, 165888, v11
    v_add_u32 v6, 221184, v11
    s_lshl_b32 s54, s92, 10
    s_add_u32 s54, s54, 4096
    s_add_u32 s64, s50, s54
    s_addc_u32 s65, s51, 0
    s_add_u32 s66, s64, 8192
    s_addc_u32 s67, s65, 0
    s_mul_i32 s82, s3, 32768
    s_mov_b32 m0, s82
    s_add_u32 s82, s82, 4096
    global_load_lds_dwordx4 v234, s[80:81]
    global_load_lds_dwordx4 v235, s[80:81] offset:1024
    global_load_lds_dwordx4 v236, s[80:81] offset:2048
    global_load_lds_dwordx4 v237, s[80:81] offset:3072
    s_add_u32 s80, s80, 131072
    s_addc_u32 s81, s81, 0
    s_mov_b32 m0, s82
    s_add_u32 s82, s82, 4096
    global_load_lds_dwordx4 v234, s[80:81]
    global_load_lds_dwordx4 v235, s[80:81] offset:1024
    global_load_lds_dwordx4 v236, s[80:81] offset:2048
    global_load_lds_dwordx4 v237, s[80:81] offset:3072
    s_add_u32 s80, s80, 131072
    s_addc_u32 s81, s81, 0
    s_mov_b32 m0, s82
    s_add_u32 s82, s82, 4096
    global_load_lds_dwordx4 v234, s[80:81]
    global_load_lds_dwordx4 v235, s[80:81] offset:1024
    global_load_lds_dwordx4 v236, s[80:81] offset:2048
    global_load_lds_dwordx4 v237, s[80:81] offset:3072
    s_lshl_b32 s83, s93, 17
    s_sub_u32 s83, 131072, s83
    s_add_u32 s80, s80, s83
    s_addc_u32 s81, s81, 0
    s_mov_b32 m0, s82
    s_add_u32 s82, s82, 4096
    global_load_lds_dwordx4 v234, s[80:81]
    global_load_lds_dwordx4 v235, s[80:81] offset:1024
    global_load_lds_dwordx4 v236, s[80:81] offset:2048
    global_load_lds_dwordx4 v237, s[80:81] offset:3072
    s_add_u32 s80, s80, 131072
    s_addc_u32 s81, s81, 0
    s_sleep 30
    global_load_dwordx4 v[134:137], v2, s[64:65] offset:-4096 sc1
    global_load_dwordx4 v[138:141], v3, s[64:65] offset:-4096 sc1
    global_load_dwordx4 v[142:145], v4, s[64:65] offset:-4096 sc1
    global_load_dwordx4 v[146:149], v2, s[64:65] offset:-3072 sc1
    global_load_dwordx4 v[150:153], v3, s[64:65] offset:-3072 sc1
    global_load_dwordx4 v[154:157], v4, s[64:65] offset:-3072 sc1
    global_load_dwordx4 v[158:161], v2, s[64:65] offset:-2048 sc1
    global_load_dwordx4 v[162:165], v3, s[64:65] offset:-2048 sc1
    global_load_dwordx4 v[166:169], v4, s[64:65] offset:-2048 sc1
    global_load_dwordx4 v[170:173], v2, s[64:65] offset:-1024 sc1
    global_load_dwordx4 v[174:177], v3, s[64:65] offset:-1024 sc1
    global_load_dwordx4 v[178:181], v4, s[64:65] offset:-1024 sc1
    global_load_dwordx4 v[182:185], v2, s[64:65] offset:0 sc1
    global_load_dwordx4 v[186:189], v3, s[64:65] offset:0 sc1
    global_load_dwordx4 v[190:193], v4, s[64:65] offset:0 sc1
    global_load_dwordx4 v[194:197], v2, s[64:65] offset:1024 sc1
    s_waitcnt vmcnt(0)
    s_branch L_g2a
L_codeend:
L_gslow_23:
    s_add_u32 s69, s69, 1
    s_cmp_gt_u32 s69, 200000
    s_cbranch_scc1 L_gback_24
    s_sleep 2
    global_load_dwordx4 v[94:97], v2, s[84:85] offset:-4096 sc1
    global_load_dwordx4 v[98:101], v3, s[84:85] offset:-4096 sc1
    global_load_dwordx4 v[102:105], v4, s[84:85] offset:-4096 sc1
    s_waitcnt vmcnt(0)
    v_max3_u32 v7, v94, v95, v96
    v_max3_u32 v8, v97, v98, v99
    v_max3_u32 v7, v7, v100, v101
    v_max3_u32 v8, v8, v102, v103
    v_max3_u32 v7, v7, v104, v105
    v_max_u32 v7, v7, v8
    v_cmp_eq_u32 vcc, -1, v7
    s_cbranch_vccnz L_gslow_23
    s_branch L_gback_24
L_gslow_25:
    s_add_u32 s69, s69, 1
    s_cmp_gt_u32 s69, 200000
    s_cbranch_scc1 L_gback_26
    s_sleep 2
    global_load_dwordx4 v[106:109], v2, s[84:85] offset:-3072 sc1
    global_load_dwordx4 v[110:113], v3, s[84:85] offset:-3072 sc1
    global_load_dwordx4 v[114:117], v4, s[84:85] offset:-3072 sc1
    s_waitcnt vmcnt(0)
    v_max3_u32 v7, v106, v107, v108
    v_max3_u32 v8, v109, v110, v111
    v_max3_u32 v7, v7, v112, v113
    v_max3_u32 v8, v8, v114, v115
    v_max3_u32 v7, v7, v116, v117
    v_max_u32 v7, v7, v8
    v_cmp_eq_u32 vcc, -1, v7
    s_cbranch_vccnz L_gslow_25
    s_branch L_gback_26
L_gslow_27:
    s_add_u32 s69, s69, 1
    s_cmp_gt_u32 s69, 200000
    s_cbranch_scc1 L_gback_28
    s_sleep 2
    global_load_dwordx4 v[118:121], v2, s[84:85] offset:-2048 sc1
    global_load_dwordx4 v[122:125], v3, s[84:85] offset:-2048 sc1
    global_load_dwordx4 v[126:129], v4, s[84:85] offset:-2048 sc1
    s_waitcnt vmcnt(0)
    v_max3_u32 v7, v118, v119, v120
    v_max3_u32 v8, v121, v122, v123
    v_max3_u32 v7, v7, v124, v125
    v_max3_u32 v8, v8, v126, v127
    v_max3_u32 v7, v7, v128, v129
    v_max_u32 v7, v7, v8
    v_cmp_eq_u32 vcc, -1, v7
    s_cbranch_vccnz L_gslow_27
    s_branch L_gback_28
L_gslow_29:
    s_add_u32 s69, s69, 1
    s_cmp_gt_u32 s69, 200000
    s_cbranch_scc1 L_gback_30
    s_sleep 2
    global_load_dwordx4 v[130:133], v2, s[84:85] offset:-1024 sc1
    global_load_dwordx4 v[134:137], v3, s[84:85] offset:-1024 sc1
    global_load_dwordx4 v[138:141], v4, s[84:85] offset:-1024 sc1
    s_waitcnt vmcnt(0)
    v_max3_u32 v7, v130, v131, v132
    v_max3_u32 v8, v133, v134, v135
    v_max3_u32 v7, v7, v136, v137
    v_max3_u32 v8, v8, v138, v139
    v_max3_u32 v7, v7, v140, v141
    v_max_u32 v7, v7, v8
    v_cmp_eq_u32 vcc, -1, v7
    s_cbranch_vccnz L_gslow_29
    s_branch L_gback_30
L_gslow_31:
    s_add_u32 s69, s69, 1
    s_cmp_gt_u32 s69, 200000
    s_cbranch_scc1 L_gback_32
    s_sleep 2
    global_load_dwordx4 v[142:145], v2, s[84:85] offset:0 sc1
    global_load_dwordx4 v[146:149], v3, s[84:85] offset:0 sc1
    global_load_dwordx4 v[150:153], v4, s[84:85] offset:0 sc1
    s_waitcnt vmcnt(0)
    v_max3_u32 v7, v142, v143, v144
    v_max3_u32 v8, v145, v146, v147
    v_max3_u32 v7, v7, v148, v149
    v_max3_u32 v8, v8, v150, v151
    v_max3_u32 v7, v7, v152, v153
    v_max_u32 v7, v7, v8
    v_cmp_eq_u32 vcc, -1, v7
    s_cbranch_vccnz L_gslow_31
    s_branch L_gback_32
L_gslow_33:
    s_add_u32 s69, s69, 1
    s_cmp_gt_u32 s69, 200000
    s_cbranch_scc1 L_gback_34
    s_sleep 2
    global_load_dwordx4 v[154:157], v2, s[84:85] offset:1024 sc1
    global_load_dwordx4 v[158:161], v3, s[84:85] offset:1024 sc1
    global_load_dwordx4 v[162:165], v4, s[84:85] offset:1024 sc1
    s_waitcnt vmcnt(0)
    v_max3_u32 v7, v154, v155, v156
    v_max3_u32 v8, v157, v158, v159
    v_max3_u32 v7, v7, v160, v161
    v_max3_u32 v8, v8, v162, v163
    v_max3_u32 v7, v7, v164, v165
    v_max_u32 v7, v7, v8
    v_cmp_eq_u32 vcc, -1, v7
    s_cbranch_vccnz L_gslow_33
    s_branch L_gback_34
L_gslow_35:
    s_add_u32 s69, s69, 1
    s_cmp_gt_u32 s69, 200000
    s_cbranch_scc1 L_gback_36
    s_sleep 2
    global_load_dwordx4 v[166:169], v2, s[84:85] offset:2048 sc1
    global_load_dwordx4 v[170:173], v3, s[84:85] offset:2048 sc1
    global_load_dwordx4 v[174:177], v4, s[84:85] offset:2048 sc1
    s_waitcnt vmcnt(0)
    v_max3_u32 v7, v166, v167, v168
    v_max3_u32 v8, v169, v170, v171
    v_max3_u32 v7, v7, v172, v173
    v_max3_u32 v8, v8, v174, v175
    v_max3_u32 v7, v7, v176, v177
    v_max_u32 v7, v7, v8
    v_cmp_eq_u32 vcc, -1, v7
    s_cbranch_vccnz L_gslow_35
    s_branch L_gback_36
L_gslow_37:
    s_add_u32 s69, s69, 1
    s_cmp_gt_u32 s69, 200000
    s_cbranch_scc1 L_gback_38
    s_sleep 2
    global_load_dwordx4 v[178:181], v2, s[84:85] offset:3072 sc1
    global_load_dwordx4 v[182:185], v3, s[84:85] offset:3072 sc1
    global_load_dwordx4 v[186:189], v4, s[84:85] offset:3072 sc1
    s_waitcnt vmcnt(0)
    v_max3_u32 v7, v178, v179, v180
    v_max3_u32 v8, v181, v182, v183
    v_max3_u32 v7, v7, v184, v185
    v_max3_u32 v8, v8, v186, v187
    v_max3_u32 v7, v7, v188, v189
    v_max_u32 v7, v7, v8
    v_cmp_eq_u32 vcc, -1, v7
    s_cbranch_vccnz L_gslow_37
    s_branch L_gback_38
L_gslow_39:
    s_add_u32 s69, s69, 1
    s_cmp_gt_u32 s69, 200000
    s_cbranch_scc1 L_gback_40
    s_sleep 2
    global_load_dwordx4 v[190:193], v2, s[86:87] offset:-4096 sc1
    global_load_dwordx4 v[194:197], v3, s[86:87] offset:-4096 sc1
    global_load_dwordx4 v[198:201], v4, s[86:87] offset:-4096 sc1
    s_waitcnt vmcnt(0)
    v_max3_u32 v7, v190, v191, v192
    v_max3_u32 v8, v193, v194, v195
    v_max3_u32 v7, v7, v196, v197
    v_max3_u32 v8, v8, v198, v199
    v_max3_u32 v7, v7, v200, v201
    v_max_u32 v7, v7, v8
    v_cmp_eq_u32 vcc, -1, v7
    s_cbranch_vccnz L_gslow_39
    s_branch L_gback_40
L_gslow_41:
    s_add_u32 s69, s69, 1
    s_cmp_gt_u32 s69, 200000
    s_cbranch_scc1 L_gback_42
    s_sleep 2
    global_load_dwordx4 v[202:205], v2, s[86:87] offset:-3072 sc1
    global_load_dwordx4 v[206:209], v3, s[86:87] offset:-3072 sc1
    global_load_dwordx4 v[210:213], v4, s[86:87] offset:-3072 sc1
    s_waitcnt vmcnt(0)
    v_max3_u32 v7, v202, v203, v204
    v_max3_u32 v8, v205, v206, v207
    v_max3_u32 v7, v7, v208, v209
    v_max3_u32 v8, v8, v210, v211
    v_max3_u32 v7, v7, v212, v213
    v_max_u32 v7, v7, v8
    v_cmp_eq_u32 vcc, -1, v7
    s_cbranch_vccnz L_gslow_41
    s_branch L_gback_42
L_gslow_43:
    s_add_u32 s69, s69, 1
    s_cmp_gt_u32 s69, 200000
    s_cbranch_scc1 L_gback_44
    s_sleep 2
    global_load_dwordx4 v[214:217], v2, s[86:87] offset:-2048 sc1
    global_load_dwordx4 v[218:221], v3, s[86:87] offset:-2048 sc1
    global_load_dwordx4 v[222:225], v4, s[86:87] offset:-2048 sc1
    s_waitcnt vmcnt(0)
    v_max3_u32 v7, v214, v215, v216
    v_max3_u32 v8, v217, v218, v219
    v_max3_u32 v7, v7, v220, v221
    v_max3_u32 v8, v8, v222, v223
    v_max3_u32 v7, v7, v224, v225
    v_max_u32 v7, v7, v8
    v_cmp_eq_u32 vcc, -1, v7
    s_cbranch_vccnz L_gslow_43
    s_branch L_gback_44
L_gslow_45:
    s_add_u32 s69, s69, 1
    s_cmp_gt_u32 s69, 200000
    s_cbranch_scc1 L_gback_46
    s_sleep 2
    global_load_dwordx4 v[226:229], v2, s[86:87] offset:-1024 sc1
    global_load_dwordx4 v[230:233], v3, s[86:87] offset:-1024 sc1
    global_load_dwordx4 v[94:97], v4, s[86:87] offset:-1024 sc1
    s_waitcnt vmcnt(0)
    v_max3_u32 v7, v226, v227, v228
    v_max3_u32 v8, v229, v230, v231
    v_max3_u32 v7, v7, v232, v233
    v_max3_u32 v8, v8, v94, v95
    v_max3_u32 v7, v7, v96, v97
    v_max_u32 v7, v7, v8
    v_cmp_eq_u32 vcc, -1, v7
    s_cbranch_vccnz L_gslow_45
    s_branch L_gback_46
L_gslow_47:
    s_add_u32 s69, s69, 1
    s_cmp_gt_u32 s69, 200000
    s_cbranch_scc1 L_gback_48
    s_sleep 2
    global_load_dwordx4 v[98:101], v2, s[86:87] offset:0 sc1
    global_load_dwordx4 v[102:105], v3, s[86:87] offset:0 sc1
    global_load_dwordx4 v[106:109], v4, s[86:87] offset:0 sc1
    s_waitcnt vmcnt(0)
    v_max3_u32 v7, v98, v99, v100
    v_max3_u32 v8, v101, v102, v103
    v_max3_u32 v7, v7, v104, v105
    v_max3_u32 v8, v8, v106, v107
    v_max3_u32 v7, v7, v108, v109
    v_max_u32 v7, v7, v8
    v_cmp_eq_u32 vcc, -1, v7
    s_cbranch_vccnz L_gslow_47
    s_branch L_gback_48
L_gslow_49:
    s_add_u32 s69, s69, 1
    s_cmp_gt_u32 s69, 200000
    s_cbranch_scc1 L_gback_50
    s_sleep 2
    global_load_dwordx4 v[110:113], v2, s[86:87] offset:1024 sc1
    global_load_dwordx4 v[114:117], v3, s[86:87] offset:1024 sc1
    global_load_dwordx4 v[118:121], v4, s[86:87] offset:1024 sc1
    s_waitcnt vmcnt(0)
    v_max3_u32 v7, v110, v111, v112
    v_max3_u32 v8, v113, v114, v115
    v_max3_u32 v7, v7, v116, v117
    v_max3_u32 v8, v8, v118, v119
    v_max3_u32 v7, v7, v120, v121
    v_max_u32 v7, v7, v8
    v_cmp_eq_u32 vcc, -1, v7
    s_cbranch_vccnz L_gslow_49
    s_branch L_gback_50
L_gslow_51:
    s_add_u32 s69, s69, 1
    s_cmp_gt_u32 s69, 200000
    s_cbranch_scc1 L_gback_52
    s_sleep 2
    global_load_dwordx4 v[122:125], v2, s[86:87] offset:2048 sc1
    global_load_dwordx4 v[126:129], v3, s[86:87] offset:2048 sc1
    global_load_dwordx4 v[130:133], v4, s[86:87] offset:2048 sc1
    s_waitcnt vmcnt(0)
    v_max3_u32 v7, v122, v123, v124
    v_max3_u32 v8, v125, v126, v127
    v_max3_u32 v7, v7, v128, v129
    v_max3_u32 v8, v8, v130, v131
    v_max3_u32 v7, v7, v132, v133
    v_max_u32 v7, v7, v8
    v_cmp_eq_u32 vcc, -1, v7
    s_cbranch_vccnz L_gslow_51
    s_branch L_gback_52
L_gslow_53:
    s_add_u32 s69, s69, 1
    s_cmp_gt_u32 s69, 200000
    s_cbranch_scc1 L_gback_54
    s_sleep 2
    global_load_dwordx4 v[134:137], v2, s[86:87] offset:3072 sc1
    global_load_dwordx4 v[138:141], v3, s[86:87] offset:3072 sc1
    global_load_dwordx4 v[142:145], v4, s[86:87] offset:3072 sc1
    s_waitcnt vmcnt(0)
    v_max3_u32 v7, v134, v135, v136
    v_max3_u32 v8, v137, v138, v139
    v_max3_u32 v7, v7, v140, v141
    v_max3_u32 v8, v8, v142, v143
    v_max3_u32 v7, v7, v144, v145
    v_max_u32 v7, v7, v8
    v_cmp_eq_u32 vcc, -1, v7
    s_cbranch_vccnz L_gslow_53
    s_branch L_gback_54
L_gslow_57:
    s_add_u32 s69, s69, 1
    s_cmp_gt_u32 s69, 200000
    s_cbranch_scc1 L_gback_58
    s_sleep 2
    global_load_dwordx4 v[146:149], v5, s[84:85] offset:-4096 sc1
    global_load_dwordx4 v[150:153], v6, s[84:85] offset:-4096 sc1
    s_waitcnt vmcnt(0)
    v_max3_u32 v7, v146, v147, v148
    v_max3_u32 v8, v149, v150, v151
    v_max3_u32 v7, v7, v152, v153
    v_max_u32 v7, v7, v8
    v_cmp_eq_u32 vcc, -1, v7
    s_cbranch_vccnz L_gslow_57
    s_branch L_gback_58
L_gslow_59:
    s_add_u32 s69, s69, 1
    s_cmp_gt_u32 s69, 200000
    s_cbranch_scc1 L_gback_60
    s_sleep 2
    global_load_dwordx4 v[154:157], v5, s[84:85] offset:-3072 sc1
    global_load_dwordx4 v[158:161], v6, s[84:85] offset:-3072 sc1
    s_waitcnt vmcnt(0)
    v_max3_u32 v7, v154, v155, v156
    v_max3_u32 v8, v157, v158, v159
    v_max3_u32 v7, v7, v160, v161
    v_max_u32 v7, v7, v8
    v_cmp_eq_u32 vcc, -1, v7
    s_cbranch_vccnz L_gslow_59
    s_branch L_gback_60
L_gslow_61:
    s_add_u32 s69, s69, 1
    s_cmp_gt_u32 s69, 200000
    s_cbranch_scc1 L_gback_62
    s_sleep 2
    global_load_dwordx4 v[162:165], v5, s[84:85] offset:-2048 sc1
    global_load_dwordx4 v[166:169], v6, s[84:85] offset:-2048 sc1
    s_waitcnt vmcnt(0)
    v_max3_u32 v7, v162, v163, v164
    v_max3_u32 v8, v165, v166, v167
    v_max3_u32 v7, v7, v168, v169
    v_max_u32 v7, v7, v8
    v_cmp_eq_u32 vcc, -1, v7
    s_cbranch_vccnz L_gslow_61
    s_branch L_gback_62
L_gslow_63:
    s_add_u32 s69, s69, 1
    s_cmp_gt_u32 s69, 200000
    s_cbranch_scc1 L_gback_64
    s_sleep 2
    global_load_dwordx4 v[170:173], v5, s[84:85] offset:-1024 sc1
    global_load_dwordx4 v[174:177], v6, s[84:85] offset:-1024 sc1
    s_waitcnt vmcnt(0)
    v_max3_u32 v7, v170, v171, v172
    v_max3_u32 v8, v173, v174, v175
    v_max3_u32 v7, v7, v176, v177
    v_max_u32 v7, v7, v8
    v_cmp_eq_u32 vcc, -1, v7
    s_cbranch_vccnz L_gslow_63
    s_branch L_gback_64
L_gslow_65:
    s_add_u32 s69, s69, 1
    s_cmp_gt_u32 s69, 200000
    s_cbranch_scc1 L_gback_66
    s_sleep 2
    global_load_dwordx4 v[178:181], v5, s[84:85] offset:0 sc1
    global_load_dwordx4 v[182:185], v6, s[84:85] offset:0 sc1
    s_waitcnt vmcnt(0)
    v_max3_u32 v7, v178, v179, v180
    v_max3_u32 v8, v181, v182, v183
    v_max3_u32 v7, v7, v184, v185
    v_max_u32 v7, v7, v8
    v_cmp_eq_u32 vcc, -1, v7
    s_cbranch_vccnz L_gslow_65
    s_branch L_gback_66
L_gslow_67:
    s_add_u32 s69, s69, 1
    s_cmp_gt_u32 s69, 200000
    s_cbranch_scc1 L_gback_68
    s_sleep 2
    global_load_dwordx4 v[186:189], v5, s[84:85] offset:1024 sc1
    global_load_dwordx4 v[190:193], v6, s[84:85] offset:1024 sc1
    s_waitcnt vmcnt(0)
    v_max3_u32 v7, v186, v187, v188
    v_max3_u32 v8, v189, v190, v191
    v_max3_u32 v7, v7, v192, v193
    v_max_u32 v7, v7, v8
    v_cmp_eq_u32 vcc, -1, v7
    s_cbranch_vccnz L_gslow_67
    s_branch L_gback_68
L_gslow_69:
    s_add_u32 s69, s69, 1
    s_cmp_gt_u32 s69, 200000
    s_cbranch_scc1 L_gback_70
    s_sleep 2
    global_load_dwordx4 v[194:197], v5, s[84:85] offset:2048 sc1
    global_load_dwordx4 v[198:201], v6, s[84:85] offset:2048 sc1
    s_waitcnt vmcnt(0)
    v_max3_u32 v7, v194, v195, v196
    v_max3_u32 v8, v197, v198, v199
    v_max3_u32 v7, v7, v200, v201
    v_max_u32 v7, v7, v8
    v_cmp_eq_u32 vcc, -1, v7
    s_cbranch_vccnz L_gslow_69
    s_branch L_gback_70
L_gslow_71:
    s_add_u32 s69, s69, 1
    s_cmp_gt_u32 s69, 200000
    s_cbranch_scc1 L_gback_72
    s_sleep 2
    global_load_dwordx4 v[202:205], v5, s[84:85] offset:3072 sc1
    global_load_dwordx4 v[206:209], v6, s[84:85] offset:3072 sc1
    s_waitcnt vmcnt(0)
    v_max3_u32 v7, v202, v203, v204
    v_max3_u32 v8, v205, v206, v207
    v_max3_u32 v7, v7, v208, v209
    v_max_u32 v7, v7, v8
    v_cmp_eq_u32 vcc, -1, v7
    s_cbranch_vccnz L_gslow_71
    s_branch L_gback_72
L_gslow_73:
    s_add_u32 s69, s69, 1
    s_cmp_gt_u32 s69, 200000
    s_cbranch_scc1 L_gback_74
    s_sleep 2
    global_load_dwordx4 v[210:213], v5, s[86:87] offset:-4096 sc1
    global_load_dwordx4 v[214:217], v6, s[86:87] offset:-4096 sc1
    s_waitcnt vmcnt(0)
    v_max3_u32 v7, v210, v211, v212
    v_max3_u32 v8, v213, v214, v215
    v_max3_u32 v7, v7, v216, v217
    v_max_u32 v7, v7, v8
    v_cmp_eq_u32 vcc, -1, v7
    s_cbranch_vccnz L_gslow_73
    s_branch L_gback_74
L_gslow_77:
    s_add_u32 s69, s69, 1
    s_cmp_gt_u32 s69, 200000
    s_cbranch_scc1 L_gback_78
    s_sleep 2
    global_load_dwordx4 v[218:221], v5, s[86:87] offset:-3072 sc1
    global_load_dwordx4 v[222:225], v6, s[86:87] offset:-3072 sc1
    s_waitcnt vmcnt(0)
    v_max3_u32 v7, v218, v219, v220
    v_max3_u32 v8, v221, v222, v223
    v_max3_u32 v7, v7, v224, v225
    v_max_u32 v7, v7, v8
    v_cmp_eq_u32 vcc, -1, v7
    s_cbranch_vccnz L_gslow_77
    s_branch L_gback_78
L_gslow_79:
    s_add_u32 s69, s69, 1
    s_cmp_gt_u32 s69, 200000
    s_cbranch_scc1 L_gback_80
    s_sleep 2
    global_load_dwordx4 v[226:229], v5, s[86:87] offset:-2048 sc1
    global_load_dwordx4 v[230:233], v6, s[86:87] offset:-2048 sc1
    s_waitcnt vmcnt(0)
    v_max3_u32 v7, v226, v227, v228
    v_max3_u32 v8, v229, v230, v231
    v_max3_u32 v7, v7, v232, v233
    v_max_u32 v7, v7, v8
    v_cmp_eq_u32 vcc, -1, v7
    s_cbranch_vccnz L_gslow_79
    s_branch L_gback_80
L_gslow_81:
    s_add_u32 s69, s69, 1
    s_cmp_gt_u32 s69, 200000
    s_cbranch_scc1 L_gback_82
    s_sleep 2
    global_load_dwordx4 v[94:97], v5, s[86:87] offset:-1024 sc1
    global_load_dwordx4 v[98:101], v6, s[86:87] offset:-1024 sc1
    s_waitcnt vmcnt(0)
    v_max3_u32 v7, v94, v95, v96
    v_max3_u32 v8, v97, v98, v99
    v_max3_u32 v7, v7, v100, v101
    v_max_u32 v7, v7, v8
    v_cmp_eq_u32 vcc, -1, v7
    s_cbranch_vccnz L_gslow_81
    s_branch L_gback_82
L_gslow_83:
    s_add_u32 s69, s69, 1
    s_cmp_gt_u32 s69, 200000
    s_cbranch_scc1 L_gback_84
    s_sleep 2
    global_load_dwordx4 v[102:105], v5, s[86:87] offset:0 sc1
    global_load_dwordx4 v[106:109], v6, s[86:87] offset:0 sc1
    s_waitcnt vmcnt(0)
    v_max3_u32 v7, v102, v103, v104
    v_max3_u32 v8, v105, v106, v107
    v_max3_u32 v7, v7, v108, v109
    v_max_u32 v7, v7, v8
    v_cmp_eq_u32 vcc, -1, v7
    s_cbranch_vccnz L_gslow_83
    s_branch L_gback_84
L_gslow_85:
    s_add_u32 s69, s69, 1
    s_cmp_gt_u32 s69, 200000
    s_cbranch_scc1 L_gback_86
    s_sleep 2
    global_load_dwordx4 v[110:113], v5, s[86:87] offset:1024 sc1
    global_load_dwordx4 v[114:117], v6, s[86:87] offset:1024 sc1
    s_waitcnt vmcnt(0)
    v_max3_u32 v7, v110, v111, v112
    v_max3_u32 v8, v113, v114, v115
    v_max3_u32 v7, v7, v116, v117
    v_max_u32 v7, v7, v8
    v_cmp_eq_u32 vcc, -1, v7
    s_cbranch_vccnz L_gslow_85
    s_branch L_gback_86
L_gslow_87:
    s_add_u32 s69, s69, 1
    s_cmp_gt_u32 s69, 200000
    s_cbranch_scc1 L_gback_88
    s_sleep 2
    global_load_dwordx4 v[118:121], v5, s[86:87] offset:2048 sc1
    global_load_dwordx4 v[122:125], v6, s[86:87] offset:2048 sc1
    s_waitcnt vmcnt(0)
    v_max3_u32 v7, v118, v119, v120
    v_max3_u32 v8, v121, v122, v123
    v_max3_u32 v7, v7, v124, v125
    v_max_u32 v7, v7, v8
    v_cmp_eq_u32 vcc, -1, v7
    s_cbranch_vccnz L_gslow_87
    s_branch L_gback_88
L_gslow_89:
    s_add_u32 s69, s69, 1
    s_cmp_gt_u32 s69, 200000
    s_cbranch_scc1 L_gback_90
    s_sleep 2
    global_load_dwordx4 v[126:129], v5, s[86:87] offset:3072 sc1
    global_load_dwordx4 v[130:133], v6, s[86:87] offset:3072 sc1
    s_waitcnt vmcnt(0)
    v_max3_u32 v7, v126, v127, v128
    v_max3_u32 v8, v129, v130, v131
    v_max3_u32 v7, v7, v132, v133
    v_max_u32 v7, v7, v8
    v_cmp_eq_u32 vcc, -1, v7
    s_cbranch_vccnz L_gslow_89
    s_branch L_gback_90
L_gslow_92:
    s_add_u32 s69, s69, 1
    s_cmp_gt_u32 s69, 200000
    s_cbranch_scc1 L_gback_93
    s_sleep 2
    global_load_dwordx4 v[134:137], v2, s[64:65] offset:-4096 sc1
    global_load_dwordx4 v[138:141], v3, s[64:65] offset:-4096 sc1
    global_load_dwordx4 v[142:145], v4, s[64:65] offset:-4096 sc1
    s_waitcnt vmcnt(0)
    v_max3_u32 v7, v134, v135, v136
    v_max3_u32 v8, v137, v138, v139
    v_max3_u32 v7, v7, v140, v141
    v_max3_u32 v8, v8, v142, v143
    v_max3_u32 v7, v7, v144, v145
    v_max_u32 v7, v7, v8
    v_cmp_eq_u32 vcc, -1, v7
    s_cbranch_vccnz L_gslow_92
    s_branch L_gback_93
L_gslow_94:
    s_add_u32 s69, s69, 1
    s_cmp_gt_u32 s69, 200000
    s_cbranch_scc1 L_gback_95
    s_sleep 2
    global_load_dwordx4 v[146:149], v2, s[64:65] offset:-3072 sc1
    global_load_dwordx4 v[150:153], v3, s[64:65] offset:-3072 sc1
    global_load_dwordx4 v[154:157], v4, s[64:65] offset:-3072 sc1
    s_waitcnt vmcnt(0)
    v_max3_u32 v7, v146, v147, v148
    v_max3_u32 v8, v149, v150, v151
    v_max3_u32 v7, v7, v152, v153
    v_max3_u32 v8, v8, v154, v155
    v_max3_u32 v7, v7, v156, v157
    v_max_u32 v7, v7, v8
    v_cmp_eq_u32 vcc, -1, v7
    s_cbranch_vccnz L_gslow_94
    s_branch L_gback_95
L_gslow_96:
    s_add_u32 s69, s69, 1
    s_cmp_gt_u32 s69, 200000
    s_cbranch_scc1 L_gback_97
    s_sleep 2
    global_load_dwordx4 v[158:161], v2, s[64:65] offset:-2048 sc1
    global_load_dwordx4 v[162:165], v3, s[64:65] offset:-2048 sc1
    global_load_dwordx4 v[166:169], v4, s[64:65] offset:-2048 sc1
    s_waitcnt vmcnt(0)
    v_max3_u32 v7, v158, v159, v160
    v_max3_u32 v8, v161, v162, v163
    v_max3_u32 v7, v7, v164, v165
    v_max3_u32 v8, v8, v166, v167
    v_max3_u32 v7, v7, v168, v169
    v_max_u32 v7, v7, v8
    v_cmp_eq_u32 vcc, -1, v7
    s_cbranch_vccnz L_gslow_96
    s_branch L_gback_97
L_gslow_98:
    s_add_u32 s69, s69, 1
    s_cmp_gt_u32 s69, 200000
    s_cbranch_scc1 L_gback_99
    s_sleep 2
    global_load_dwordx4 v[170:173], v2, s[64:65] offset:-1024 sc1
    global_load_dwordx4 v[174:177], v3, s[64:65] offset:-1024 sc1
    global_load_dwordx4 v[178:181], v4, s[64:65] offset:-1024 sc1
    s_waitcnt vmcnt(0)
    v_max3_u32 v7, v170, v171, v172
    v_max3_u32 v8, v173, v174, v175
    v_max3_u32 v7, v7, v176, v177
    v_max3_u32 v8, v8, v178, v179
    v_max3_u32 v7, v7, v180, v181
    v_max_u32 v7, v7, v8
    v_cmp_eq_u32 vcc, -1, v7
    s_cbranch_vccnz L_gslow_98
    s_branch L_gback_99
L_gslow_100:
    s_add_u32 s69, s69, 1
    s_cmp_gt_u32 s69, 200000
    s_cbranch_scc1 L_gback_101
    s_sleep 2
    global_load_dwordx4 v[182:185], v2, s[64:65] offset:0 sc1
    global_load_dwordx4 v[186:189], v3, s[64:65] offset:0 sc1
    global_load_dwordx4 v[190:193], v4, s[64:65] offset:0 sc1
    s_waitcnt vmcnt(0)
    v_max3_u32 v7, v182, v183, v184
    v_max3_u32 v8, v185, v186, v187
    v_max3_u32 v7, v7, v188, v189
    v_max3_u32 v8, v8, v190, v191
    v_max3_u32 v7, v7, v192, v193
    v_max_u32 v7, v7, v8
    v_cmp_eq_u32 vcc, -1, v7
    s_cbranch_vccnz L_gslow_100
    s_branch L_gback_101
L_gslow_102:
    s_add_u32 s69, s69, 1
    s_cmp_gt_u32 s69, 200000
    s_cbranch_scc1 L_gback_103
    s_sleep 2
    global_load_dwordx4 v[194:197], v2, s[64:65] offset:1024 sc1
    global_load_dwordx4 v[198:201], v3, s[64:65] offset:1024 sc1
    global_load_dwordx4 v[202:205], v4, s[64:65] offset:1024 sc1
    s_waitcnt vmcnt(0)
    v_max3_u32 v7, v194, v195, v196
    v_max3_u32 v8, v197, v198, v199
    v_max3_u32 v7, v7, v200, v201
    v_max3_u32 v8, v8, v202, v203
    v_max3_u32 v7, v7, v204, v205
    v_max_u32 v7, v7, v8
    v_cmp_eq_u32 vcc, -1, v7
    s_cbranch_vccnz L_gslow_102
    s_branch L_gback_103
L_gslow_104:
    s_add_u32 s69, s69, 1
    s_cmp_gt_u32 s69, 200000
    s_cbranch_scc1 L_gback_105
    s_sleep 2
    global_load_dwordx4 v[206:209], v2, s[64:65] offset:2048 sc1
    global_load_dwordx4 v[210:213], v3, s[64:65] offset:2048 sc1
    global_load_dwordx4 v[214:217], v4, s[64:65] offset:2048 sc1
    s_waitcnt vmcnt(0)
    v_max3_u32 v7, v206, v207, v208
    v_max3_u32 v8, v209, v210, v211
    v_max3_u32 v7, v7, v212, v213
    v_max3_u32 v8, v8, v214, v215
    v_max3_u32 v7, v7, v216, v217
    v_max_u32 v7, v7, v8
    v_cmp_eq_u32 vcc, -1, v7
    s_cbranch_vccnz L_gslow_104
    s_branch L_gback_105
L_gslow_106:
    s_add_u32 s69, s69, 1
    s_cmp_gt_u32 s69, 200000
    s_cbranch_scc1 L_gback_107
    s_sleep 2
    global_load_dwordx4 v[218:221], v2, s[64:65] offset:3072 sc1
    global_load_dwordx4 v[222:225], v3, s[64:65] offset:3072 sc1
    global_load_dwordx4 v[226:229], v4, s[64:65] offset:3072 sc1
    s_waitcnt vmcnt(0)
    v_max3_u32 v7, v218, v219, v220
    v_max3_u32 v8, v221, v222, v223
    v_max3_u32 v7, v7, v224, v225
    v_max3_u32 v8, v8, v226, v227
    v_max3_u32 v7, v7, v228, v229
    v_max_u32 v7, v7, v8
    v_cmp_eq_u32 vcc, -1, v7
    s_cbranch_vccnz L_gslow_106
    s_branch L_gback_107
L_gslow_108:
    s_add_u32 s69, s69, 1
    s_cmp_gt_u32 s69, 200000
    s_cbranch_scc1 L_gback_109
    s_sleep 2
    global_load_dwordx4 v[230:233], v2, s[66:67] offset:-4096 sc1
    global_load_dwordx4 v[94:97], v3, s[66:67] offset:-4096 sc1
    global_load_dwordx4 v[98:101], v4, s[66:67] offset:-4096 sc1
    s_waitcnt vmcnt(0)
    v_max3_u32 v7, v230, v231, v232
    v_max3_u32 v8, v233, v94, v95
    v_max3_u32 v7, v7, v96, v97
    v_max3_u32 v8, v8, v98, v99
    v_max3_u32 v7, v7, v100, v101
    v_max_u32 v7, v7, v8
    v_cmp_eq_u32 vcc, -1, v7
    s_cbranch_vccnz L_gslow_108
    s_branch L_gback_109
L_gslow_110:
    s_add_u32 s69, s69, 1
    s_cmp_gt_u32 s69, 200000
    s_cbranch_scc1 L_gback_111
    s_sleep 2
    global_load_dwordx4 v[102:105], v2, s[66:67] offset:-3072 sc1
    global_load_dwordx4 v[106:109], v3, s[66:67] offset:-3072 sc1
    global_load_dwordx4 v[110:113], v4, s[66:67] offset:-3072 sc1
    s_waitcnt vmcnt(0)
    v_max3_u32 v7, v102, v103, v104
    v_max3_u32 v8, v105, v106, v107
    v_max3_u32 v7, v7, v108, v109
    v_max3_u32 v8, v8, v110, v111
    v_max3_u32 v7, v7, v112, v113
    v_max_u32 v7, v7, v8
    v_cmp_eq_u32 vcc, -1, v7
    s_cbranch_vccnz L_gslow_110
    s_branch L_gback_111
L_gslow_112:
    s_add_u32 s69, s69, 1
    s_cmp_gt_u32 s69, 200000
    s_cbranch_scc1 L_gback_113
    s_sleep 2
    global_load_dwordx4 v[114:117], v2, s[66:67] offset:-2048 sc1
    global_load_dwordx4 v[118:121], v3, s[66:67] offset:-2048 sc1
    global_load_dwordx4 v[122:125], v4, s[66:67] offset:-2048 sc1
    s_waitcnt vmcnt(0)
    v_max3_u32 v7, v114, v115, v116
    v_max3_u32 v8, v117, v118, v119
    v_max3_u32 v7, v7, v120, v121
    v_max3_u32 v8, v8, v122, v123
    v_max3_u32 v7, v7, v124, v125
    v_max_u32 v7, v7, v8
    v_cmp_eq_u32 vcc, -1, v7
    s_cbranch_vccnz L_gslow_112
    s_branch L_gback_113
L_gslow_114:
    s_add_u32 s69, s69, 1
    s_cmp_gt_u32 s69, 200000
    s_cbranch_scc1 L_gback_115
    s_sleep 2
    global_load_dwordx4 v[126:129], v2, s[66:67] offset:-1024 sc1
    global_load_dwordx4 v[130:133], v3, s[66:67] offset:-1024 sc1
    global_load_dwordx4 v[134:137], v4, s[66:67] offset:-1024 sc1
    s_waitcnt vmcnt(0)
    v_max3_u32 v7, v126, v127, v128
    v_max3_u32 v8, v129, v130, v131
    v_max3_u32 v7, v7, v132, v133
    v_max3_u32 v8, v8, v134, v135
    v_max3_u32 v7, v7, v136, v137
    v_max_u32 v7, v7, v8
    v_cmp_eq_u32 vcc, -1, v7
    s_cbranch_vccnz L_gslow_114
    s_branch L_gback_115
L_gslow_116:
    s_add_u32 s69, s69, 1
    s_cmp_gt_u32 s69, 200000
    s_cbranch_scc1 L_gback_117
    s_sleep 2
    global_load_dwordx4 v[138:141], v2, s[66:67] offset:0 sc1
    global_load_dwordx4 v[142:145], v3, s[66:67] offset:0 sc1
    global_load_dwordx4 v[146:149], v4, s[66:67] offset:0 sc1
    s_waitcnt vmcnt(0)
    v_max3_u32 v7, v138, v139, v140
    v_max3_u32 v8, v141, v142, v143
    v_max3_u32 v7, v7, v144, v145
    v_max3_u32 v8, v8, v146, v147
    v_max3_u32 v7, v7, v148, v149
    v_max_u32 v7, v7, v8
    v_cmp_eq_u32 vcc, -1, v7
    s_cbranch_vccnz L_gslow_116
    s_branch L_gback_117
L_gslow_118:
    s_add_u32 s69, s69, 1
    s_cmp_gt_u32 s69, 200000
    s_cbranch_scc1 L_gback_119
    s_sleep 2
    global_load_dwordx4 v[150:153], v2, s[66:67] offset:1024 sc1
    global_load_dwordx4 v[154:157], v3, s[66:67] offset:1024 sc1
    global_load_dwordx4 v[158:161], v4, s[66:67] offset:1024 sc1
    s_waitcnt vmcnt(0)
    v_max3_u32 v7, v150, v151, v152
    v_max3_u32 v8, v153, v154, v155
    v_max3_u32 v7, v7, v156, v157
    v_max3_u32 v8, v8, v158, v159
    v_max3_u32 v7, v7, v160, v161
    v_max_u32 v7, v7, v8
    v_cmp_eq_u32 vcc, -1, v7
    s_cbranch_vccnz L_gslow_118
    s_branch L_gback_119
L_gslow_121:
    s_add_u32 s69, s69, 1
    s_cmp_gt_u32 s69, 200000
    s_cbranch_scc1 L_gback_122
    s_sleep 2
    global_load_dwordx4 v[162:165], v5, s[64:65] offset:-4096 sc1
    global_load_dwordx4 v[166:169], v6, s[64:65] offset:-4096 sc1
    s_waitcnt vmcnt(0)
    v_max3_u32 v7, v162, v163, v164
    v_max3_u32 v8, v165, v166, v167
    v_max3_u32 v7, v7, v168, v169
    v_max_u32 v7, v7, v8
    v_cmp_eq_u32 vcc, -1, v7
    s_cbranch_vccnz L_gslow_121
    s_branch L_gback_122
L_gslow_123:
    s_add_u32 s69, s69, 1
    s_cmp_gt_u32 s69, 200000
    s_cbranch_scc1 L_gback_124
    s_sleep 2
    global_load_dwordx4 v[170:173], v5, s[64:65] offset:-3072 sc1
    global_load_dwordx4 v[174:177], v6, s[64:65] offset:-3072 sc1
    s_waitcnt vmcnt(0)
    v_max3_u32 v7, v170, v171, v172
    v_max3_u32 v8, v173, v174, v175
    v_max3_u32 v7, v7, v176, v177
    v_max_u32 v7, v7, v8
    v_cmp_eq_u32 vcc, -1, v7
    s_cbranch_vccnz L_gslow_123
    s_branch L_gback_124
L_gslow_125:
    s_add_u32 s69, s69, 1
    s_cmp_gt_u32 s69, 200000
    s_cbranch_scc1 L_gback_126
    s_sleep 2
    global_load_dwordx4 v[178:181], v5, s[64:65] offset:-2048 sc1
    global_load_dwordx4 v[182:185], v6, s[64:65] offset:-2048 sc1
    s_waitcnt vmcnt(0)
    v_max3_u32 v7, v178, v179, v180
    v_max3_u32 v8, v181, v182, v183
    v_max3_u32 v7, v7, v184, v185
    v_max_u32 v7, v7, v8
    v_cmp_eq_u32 vcc, -1, v7
    s_cbranch_vccnz L_gslow_125
    s_branch L_gback_126
L_gslow_127:
    s_add_u32 s69, s69, 1
    s_cmp_gt_u32 s69, 200000
    s_cbranch_scc1 L_gback_128
    s_sleep 2
    global_load_dwordx4 v[186:189], v5, s[64:65] offset:-1024 sc1
    global_load_dwordx4 v[190:193], v6, s[64:65] offset:-1024 sc1
    s_waitcnt vmcnt(0)
    v_max3_u32 v7, v186, v187, v188
    v_max3_u32 v8, v189, v190, v191
    v_max3_u32 v7, v7, v192, v193
    v_max_u32 v7, v7, v8
    v_cmp_eq_u32 vcc, -1, v7
    s_cbranch_vccnz L_gslow_127
    s_branch L_gback_128
L_gslow_129:
    s_add_u32 s69, s69, 1
    s_cmp_gt_u32 s69, 200000
    s_cbranch_scc1 L_gback_130
    s_sleep 2
    global_load_dwordx4 v[194:197], v5, s[64:65] offset:0 sc1
    global_load_dwordx4 v[198:201], v6, s[64:65] offset:0 sc1
    s_waitcnt vmcnt(0)
    v_max3_u32 v7, v194, v195, v196
    v_max3_u32 v8, v197, v198, v199
    v_max3_u32 v7, v7, v200, v201
    v_max_u32 v7, v7, v8
    v_cmp_eq_u32 vcc, -1, v7
    s_cbranch_vccnz L_gslow_129
    s_branch L_gback_130
L_gslow_131:
    s_add_u32 s69, s69, 1
    s_cmp_gt_u32 s69, 200000
    s_cbranch_scc1 L_gback_132
    s_sleep 2
    global_load_dwordx4 v[202:205], v5, s[64:65] offset:1024 sc1
    global_load_dwordx4 v[206:209], v6, s[64:65] offset:1024 sc1
    s_waitcnt vmcnt(0)
    v_max3_u32 v7, v202, v203, v204
    v_max3_u32 v8, v205, v206, v207
    v_max3_u32 v7, v7, v208, v209
    v_max_u32 v7, v7, v8
    v_cmp_eq_u32 vcc, -1, v7
    s_cbranch_vccnz L_gslow_131
    s_branch L_gback_132
L_gslow_133:
    s_add_u32 s69, s69, 1
    s_cmp_gt_u32 s69, 200000
    s_cbranch_scc1 L_gback_134
    s_sleep 2
    global_load_dwordx4 v[210:213], v5, s[64:65] offset:2048 sc1
    global_load_dwordx4 v[214:217], v6, s[64:65] offset:2048 sc1
    s_waitcnt vmcnt(0)
    v_max3_u32 v7, v210, v211, v212
    v_max3_u32 v8, v213, v214, v215
    v_max3_u32 v7, v7, v216, v217
    v_max_u32 v7, v7, v8
    v_cmp_eq_u32 vcc, -1, v7
    s_cbranch_vccnz L_gslow_133
    s_branch L_gback_134
L_gslow_135:
    s_add_u32 s69, s69, 1
    s_cmp_gt_u32 s69, 200000
    s_cbranch_scc1 L_gback_136
    s_sleep 2
    global_load_dwordx4 v[218:221], v5, s[64:65] offset:3072 sc1
    global_load_dwordx4 v[222:225], v6, s[64:65] offset:3072 sc1
    s_waitcnt vmcnt(0)
    v_max3_u32 v7, v218, v219, v220
    v_max3_u32 v8, v221, v222, v223
    v_max3_u32 v7, v7, v224, v225
    v_max_u32 v7, v7, v8
    v_cmp_eq_u32 vcc, -1, v7
    s_cbranch_vccnz L_gslow_135
    s_branch L_gback_136
L_gslow_137:
    s_add_u32 s69, s69, 1
    s_cmp_gt_u32 s69, 200000
    s_cbranch_scc1 L_gback_138
    s_sleep 2
    global_load_dwordx4 v[226:229], v5, s[66:67] offset:-4096 sc1
    global_load_dwordx4 v[230:233], v6, s[66:67] offset:-4096 sc1
    s_waitcnt vmcnt(0)
    v_max3_u32 v7, v226, v227, v228
    v_max3_u32 v8, v229, v230, v231
    v_max3_u32 v7, v7, v232, v233
    v_max_u32 v7, v7, v8
    v_cmp_eq_u32 vcc, -1, v7
    s_cbranch_vccnz L_gslow_137
    s_branch L_gback_138
L_gslow_139:
    s_add_u32 s69, s69, 1
    s_cmp_gt_u32 s69, 200000
    s_cbranch_scc1 L_gback_140
    s_sleep 2
    global_load_dwordx4 v[94:97], v5, s[66:67] offset:-3072 sc1
    global_load_dwordx4 v[98:101], v6, s[66:67] offset:-3072 sc1
    s_waitcnt vmcnt(0)
    v_max3_u32 v7, v94, v95, v96
    v_max3_u32 v8, v97, v98, v99
    v_max3_u32 v7, v7, v100, v101
    v_max_u32 v7, v7, v8
    v_cmp_eq_u32 vcc, -1, v7
    s_cbranch_vccnz L_gslow_139
    s_branch L_gback_140
L_gslow_141:
    s_add_u32 s69, s69, 1
    s_cmp_gt_u32 s69, 200000
    s_cbranch_scc1 L_gback_142
    s_sleep 2
    global_load_dwordx4 v[102:105], v5, s[66:67] offset:-2048 sc1
    global_load_dwordx4 v[106:109], v6, s[66:67] offset:-2048 sc1
    s_waitcnt vmcnt(0)
    v_max3_u32 v7, v102, v103, v104
    v_max3_u32 v8, v105, v106, v107
    v_max3_u32 v7, v7, v108, v109
    v_max_u32 v7, v7, v8
    v_cmp_eq_u32 vcc, -1, v7
    s_cbranch_vccnz L_gslow_141
    s_branch L_gback_142
L_gslow_143:
    s_add_u32 s69, s69, 1
    s_cmp_gt_u32 s69, 200000
    s_cbranch_scc1 L_gback_144
    s_sleep 2
    global_load_dwordx4 v[110:113], v5, s[66:67] offset:-1024 sc1
    global_load_dwordx4 v[114:117], v6, s[66:67] offset:-1024 sc1
    s_waitcnt vmcnt(0)
    v_max3_u32 v7, v110, v111, v112
    v_max3_u32 v8, v113, v114, v115
    v_max3_u32 v7, v7, v116, v117
    v_max_u32 v7, v7, v8
    v_cmp_eq_u32 vcc, -1, v7
    s_cbranch_vccnz L_gslow_143
    s_branch L_gback_144
L_gslow_145:
    s_add_u32 s69, s69, 1
    s_cmp_gt_u32 s69, 200000
    s_cbranch_scc1 L_gback_146
    s_sleep 2
    global_load_dwordx4 v[118:121], v5, s[66:67] offset:0 sc1
    global_load_dwordx4 v[122:125], v6, s[66:67] offset:0 sc1
    s_waitcnt vmcnt(0)
    v_max3_u32 v7, v118, v119, v120
    v_max3_u32 v8, v121, v122, v123
    v_max3_u32 v7, v7, v124, v125
    v_max_u32 v7, v7, v8
    v_cmp_eq_u32 vcc, -1, v7
    s_cbranch_vccnz L_gslow_145
    s_branch L_gback_146
L_gslow_147:
    s_add_u32 s69, s69, 1
    s_cmp_gt_u32 s69, 200000
    s_cbranch_scc1 L_gback_148
    s_sleep 2
    global_load_dwordx4 v[126:129], v5, s[66:67] offset:1024 sc1
    global_load_dwordx4 v[130:133], v6, s[66:67] offset:1024 sc1
    s_waitcnt vmcnt(0)
    v_max3_u32 v7, v126, v127, v128
    v_max3_u32 v8, v129, v130, v131
    v_max3_u32 v7, v7, v132, v133
    v_max_u32 v7, v7, v8
    v_cmp_eq_u32 vcc, -1, v7
    s_cbranch_vccnz L_gslow_147
    s_branch L_gback_148
    s_endpgm
.section .rodata,"a"
.p2align 6
.amdhsa_kernel sequential_preLN__ssm_conv_s4d__mixer_token_mlp__prompt_kernel
  .amdhsa_next_free_vgpr 512
  .amdhsa_next_free_sgpr 102
  .amdhsa_accum_offset 256
  .amdhsa_group_segment_fixed_size 0
  .amdhsa_kernarg_size 120
  .amdhsa_user_sgpr_count 2
  .amdhsa_user_sgpr_kernarg_segment_ptr 1
  .amdhsa_system_sgpr_workgroup_id_x 1
.end_amdhsa_kernel
```
